```python
import torch

def _softmax(x, axis=-1):
    return torch.softmax(x, dim=axis)
def _gelu(x):
    return torch.nn.functional.gelu(x, approximate="tanh")
def _silu(x):
    return torch.nn.functional.silu(x)
def _sigmoid(x):
    return torch.sigmoid(x)
def _layernorm(x, axis=-1, eps=1e-5):
    m = x.mean(dim=axis, keepdim=True)
    v = x.var(dim=axis, keepdim=True, unbiased=False)
    return (x - m) / torch.sqrt(v + eps)
def _scatter_add(tgt, idx, src, axis=0):
    return tgt.clone().index_add_(axis, idx, src)
def _segment_sum(src, seg, n):
    out = torch.zeros((n,) + src.shape[1:], dtype=src.dtype)
    return out.index_add_(0, seg, src)
def _pad(x, pw):
    flat = tuple(v for pair in reversed(pw) for v in pair)
    return torch.nn.functional.pad(x, flat)

kernel_name = 'recurrent_scan__grouped_kv_mqa__glu_gated_geglu__prompt'

def setup_inputs():

    _w = (lambda a: (lambda t: t.to(torch.bfloat16) if t.is_floating_point() else t)(torch.as_tensor(a)))
    def _A_setup():
        B, S, D, H = 1, 2048, 512, 32
        Dh = D // H
        return {
            "x": _w((lambda *s: torch.randn(*s, dtype=torch.bfloat16) * 0.05)(B, S, D)),
            "wq": _w((lambda *s: torch.randn(*s, dtype=torch.bfloat16) * 0.2)(D, H * Dh)),
            "wk": _w((lambda *s: torch.randn(*s, dtype=torch.bfloat16) * 0.2)(D, Dh)),
            "wv": _w((lambda *s: torch.randn(*s, dtype=torch.bfloat16) * 0.2)(D, Dh)),
            "wo": _w((lambda *s: torch.randn(*s, dtype=torch.bfloat16) * 0.2)(H * Dh, D)),
        }
    _A_in = _A_setup()

    def _B_setup():
        B, S, Dm, Df = 1, 2048, 512, 1792
        return {
            "x": _w((lambda *s: torch.randn(*s, dtype=torch.bfloat16) * 0.05)(B, S, Dm)),
            "w_gate": _w((lambda *s: torch.randn(*s, dtype=torch.bfloat16) * 0.1)(Dm, Df) * (Dm ** -0.5)),
            "w_up": _w((lambda *s: torch.randn(*s, dtype=torch.bfloat16) * 0.1)(Dm, Df) * (Dm ** -0.5)),
            "w_down": _w((lambda *s: torch.randn(*s, dtype=torch.bfloat16) * 0.1)(Df, Dm) * (Df ** -0.5)),
        }
    _B_in = _B_setup()

    return {
        "A_x": _A_in["x"],
        "A_wq": _A_in["wq"],
        "A_wk": _A_in["wk"],
        "A_wv": _A_in["wv"],
        "A_wo": _A_in["wo"],
        "B_x": _B_in["x"],
        "B_w_gate": _B_in["w_gate"],
        "B_w_up": _B_in["w_up"],
        "B_w_down": _B_in["w_down"],
    }

def reference(A_x, A_wq, A_wk, A_wv, A_wo, B_x, B_w_gate, B_w_up, B_w_down):
    def _A_ref(x, wq, wk, wv, wo):
        B, S, D = x.shape
        H = 32
        Dh = D // H
        q = (lambda x, *d: x.permute(*d))((x @ wq).reshape(B, S, H, Dh), 0, 2, 1, 3)
        k = x @ wk
        v = x @ wv
        scores = torch.einsum("bhqd,bkd->bhqk", q, k) * (Dh ** -0.5)
        p = _softmax(scores, axis=-1)
        o = torch.einsum("bhqk,bkd->bhqd", p, v)
        return (lambda x, *d: x.permute(*d))(o, 0, 2, 1, 3).reshape(B, S, H * Dh) @ wo

    def _B_ref(x, w_gate, w_up, w_down):
        g = torch.einsum("bsd,df->bsf", x, w_gate)
        u = torch.einsum("bsd,df->bsf", x, w_up)
        h = _gelu(g) * u
        return torch.einsum("bsf,fd->bsd", h, w_down)

    x = A_x
    xn = _layernorm(x, axis=-1)
    s = _A_ref(xn, A_wq, A_wk, A_wv, A_wo)
    g = _silu(_B_ref(xn, B_w_gate, B_w_up, B_w_down))
    return x + s * g
```

```asm
; @launch grid=(256,1,1) block=(512,1,1) lds=163840
.amdgcn_target "amdgcn-amd-amdhsa--gfx950"
.text
.globl recurrent_scan__grouped_kv_mqa__glu_gated_geglu__prompt_kernel
.p2align 12
.p2align 8
.type recurrent_scan__grouped_kv_mqa__glu_gated_geglu__prompt_kernel,@function
recurrent_scan__grouped_kv_mqa__glu_gated_geglu__prompt_kernel:
    s_cmp_ge_u32 s2, 256
    s_cbranch_scc1 L_done
    s_load_dwordx2 s[32:33], s[0:1], 0
    s_load_dwordx8 s[8:15], s[0:1], 0
    s_load_dwordx16 s[16:31], s[0:1], 32
    v_lshrrev_b32 v3, 6, v0
    v_and_b32 v0, 63, v0
    v_readfirstlane_b32 s3, v3
    v_lshrrev_b32 v1, 3, v0
    v_and_b32 v2, 7, v0
    v_lshlrev_b32 v3, 10, v1
    v_lshl_add_u32 v3, v2, 4, v3
    s_mov_b32 s34, 2097152
    s_mov_b32 s35, 0x00020000
    s_lshl2_add_u32 s60, s2, s2
    s_bfe_u32 s60, s60, 0x20001
    s_bfe_u32 s96, s2, 0x30003
    s_lshl3_add_u32 s6, s60, s96
    s_lshl_b32 s60, s6, 16
    s_lshl_b32 s61, s3, 13
    s_add_u32 s60, s60, s61
    s_waitcnt lgkmcnt(0)
    buffer_load_dwordx4 v[64:67], v3, s[32:35], s60 offen offset:0
    buffer_load_dwordx4 v[68:71], v3, s[32:35], s60 offen offset:128
    buffer_load_dwordx4 v[72:75], v3, s[32:35], s60 offen offset:256
    buffer_load_dwordx4 v[76:79], v3, s[32:35], s60 offen offset:384
    buffer_load_dwordx4 v[80:83], v3, s[32:35], s60 offen offset:512
    buffer_load_dwordx4 v[84:87], v3, s[32:35], s60 offen offset:640
    buffer_load_dwordx4 v[88:91], v3, s[32:35], s60 offen offset:768
    buffer_load_dwordx4 v[92:95], v3, s[32:35], s60 offen offset:896
    s_lshr_b32 s79, s2, 7
    s_bfe_u32 s60, s2, 0x10000
    s_bfe_u32 s61, s2, 0x10006
    s_lshl1_add_u32 s5, s60, s61
    s_lshl2_add_u32 s7, s79, s5
    s_and_b32 s18, s6, 0x1b
    s_and_b32 s60, s2, 1
    s_lshl2_add_u32 s18, s60, s18
    s_lshr_b32 s7, s2, 5
    s_and_b32 s54, s7, 3
    s_lshr_b32 s5, s2, 6
    s_and_b32 s79, s2, 1
    s_xor_b32 s78, s79, 1
    s_and_b32 s48, s3, 3
    s_and_b32 s50, s3, 1
    s_bfe_u32 s51, s3, 0x10001
    s_mov_b32 s40, s30
    s_mov_b32 s41, s31
    s_mov_b32 s42, 0x10000000
    s_mov_b32 s43, 0x00020000
    s_mul_i32 s97, s5, 7
    s_lshl2_add_u32 s97, s79, s97
    s_add_u32 s97, s97, 1
    s_and_b32 s96, s96, 6
    s_lshl_b32 s60, s50, 2
    s_lshl_b32 s61, s3, 10
    s_lshl_b32 s62, s96, 13
    s_sub_u32 s61, s61, s62
    v_lshrrev_b32 v5, 1, v1
    v_or_b32 v5, s60, v5
    v_xor_b32 v5, v5, v2
    v_lshlrev_b32 v5, 4, v5
    v_lshl_add_u32 v5, v1, 7, v5
    v_add_u32 v5, s61, v5
    s_mov_b32 s61, 0xffff
    v_and_b32 v40, s61, v5
    v_add_u32 v5, 8192, v5
    v_and_b32 v41, s61, v5
    v_add_u32 v5, 8192, v5
    v_and_b32 v42, s61, v5
    v_add_u32 v5, 8192, v5
    v_and_b32 v43, s61, v5
    v_add_u32 v5, 8192, v5
    v_and_b32 v44, s61, v5
    v_add_u32 v5, 8192, v5
    v_and_b32 v45, s61, v5
    v_add_u32 v5, 8192, v5
    v_and_b32 v46, s61, v5
    v_add_u32 v5, 8192, v5
    v_and_b32 v47, s61, v5
    s_mov_b32 s59, 0xffff0000
    s_mov_b32 s75, 0x3f803f80
    s_mov_b32 s76, 0x3b000000
    s_mov_b32 s77, 0x3727c5ac
    v_mov_b32 v8, 0
    v_mov_b32 v9, 0
    v_lshlrev_b32 v6, 4, v0
    v_mov_b32 v11, 0
    v_mov_b32 v13, 0
    s_cmp_ge_u32 s3, 4
    s_cbranch_scc1 L_c
    s_cmp_eq_u32 s51, 0
    s_cselect_b32 s44, s20, s22
    s_cselect_b32 s45, s21, s23
    s_mov_b32 s46, 1835008
    s_mov_b32 s47, 0x00020000
    s_mov_b32 s73, 1792
    v_and_b32 v4, 2, v1
    v_xor_b32 v4, v4, v2
    v_lshlrev_b32 v4, 4, v4
    s_add_u32 s61, s97, s50
    s_lshl_b32 s61, s61, 7
    v_mul_u32_u24 v52, 3584, v1
    v_add3_u32 v52, v52, v4, s61
    v_xor_b32 v55, 64, v52
    v_add_u32 v53, 27648, v55
    v_add_u32 v54, 55296, v52
    v_add_u32 v55, 82944, v55
    s_lshl_b32 s58, s48, 12
    s_add_u32 s58, s58, 65536
    s_cmp_gt_u32 s50, s79
    s_cbranch_scc1 L_hq
    s_mov_b32 s36, s44
    s_mov_b32 s37, s45
    s_mov_b32 s38, 1835008
    s_mov_b32 s72, 1792
    s_add_u32 s60, s79, 1
    s_lshl_b32 s60, s60, 7
    v_subrev_u32 v48, s60, v52
    v_subrev_u32 v49, s60, v53
    v_subrev_u32 v50, s60, v54
    v_subrev_u32 v51, s60, v55
    s_branch L_hw
L_hq:
    s_mov_b32 s36, s10
    s_mov_b32 s37, s11
    s_mov_b32 s38, 524288
    s_mov_b32 s72, 512
    s_lshl_b32 s60, s5, 8
    s_lshl_b32 s61, s51, 7
    s_add_u32 s60, s60, s61
    v_lshlrev_b32 v48, 10, v1
    v_add3_u32 v48, v48, v4, s60
    v_xor_b32 v51, 64, v48
    v_add_u32 v49, 7168, v51
    v_add_u32 v50, 14336, v48
    v_add_u32 v51, 21504, v51
L_hw:
    s_mov_b32 s39, 0x00020000
    s_lshl_b32 s57, s96, 7
    s_mov_b32 s8, s28
    s_mov_b32 s9, s29
    s_mov_b32 s10, 0x100
    s_mov_b32 s11, 0x00020000
    s_mov_b64 exec, 0
    s_cmp_eq_u32 s48, 0
    s_cbranch_scc1 L_pad_x47
    s_cmp_eq_u32 s48, 1
    s_cbranch_scc1 L_pad_x254
    s_cmp_eq_u32 s48, 2
    s_cbranch_scc1 L_pad_x438
    s_cmp_eq_u32 s48, 3
    s_cbranch_scc1 L_pad_x592
    s_branch L_warmed_h
L_ret_x47:
    s_branch L_warmed_h
L_ret_x254:
    s_branch L_warmed_h
L_ret_x438:
    s_branch L_warmed_h
L_ret_x592:
    s_branch L_warmed_h
L_warmed_h:
    s_mov_b64 exec, -1
    s_waitcnt vmcnt(7)
    v_dot2c_f32_bf16 v8, s75, v64
    v_dot2c_f32_bf16 v9, v64, v64
    v_dot2c_f32_bf16 v8, s75, v65
    v_dot2c_f32_bf16 v9, v65, v65
    v_dot2c_f32_bf16 v8, s75, v66
    v_dot2c_f32_bf16 v9, v66, v66
    v_dot2c_f32_bf16 v8, s75, v67
    v_dot2c_f32_bf16 v9, v67, v67
    s_waitcnt vmcnt(6)
    v_dot2c_f32_bf16 v8, s75, v68
    v_dot2c_f32_bf16 v9, v68, v68
    v_dot2c_f32_bf16 v8, s75, v69
    v_dot2c_f32_bf16 v9, v69, v69
    v_dot2c_f32_bf16 v8, s75, v70
    v_dot2c_f32_bf16 v9, v70, v70
    v_dot2c_f32_bf16 v8, s75, v71
    v_dot2c_f32_bf16 v9, v71, v71
    s_waitcnt vmcnt(5)
    v_dot2c_f32_bf16 v8, s75, v72
    v_dot2c_f32_bf16 v9, v72, v72
    v_dot2c_f32_bf16 v8, s75, v73
    v_dot2c_f32_bf16 v9, v73, v73
    v_dot2c_f32_bf16 v8, s75, v74
    v_dot2c_f32_bf16 v9, v74, v74
    v_dot2c_f32_bf16 v8, s75, v75
    v_dot2c_f32_bf16 v9, v75, v75
    s_waitcnt vmcnt(4)
    v_dot2c_f32_bf16 v8, s75, v76
    v_dot2c_f32_bf16 v9, v76, v76
    v_dot2c_f32_bf16 v8, s75, v77
    v_dot2c_f32_bf16 v9, v77, v77
    v_dot2c_f32_bf16 v8, s75, v78
    v_dot2c_f32_bf16 v9, v78, v78
    v_dot2c_f32_bf16 v8, s75, v79
    v_dot2c_f32_bf16 v9, v79, v79
    s_waitcnt vmcnt(3)
    v_dot2c_f32_bf16 v8, s75, v80
    v_dot2c_f32_bf16 v9, v80, v80
    v_dot2c_f32_bf16 v8, s75, v81
    v_dot2c_f32_bf16 v9, v81, v81
    v_dot2c_f32_bf16 v8, s75, v82
    v_dot2c_f32_bf16 v9, v82, v82
    v_dot2c_f32_bf16 v8, s75, v83
    v_dot2c_f32_bf16 v9, v83, v83
    s_add_u32 m0, s58, 0
    s_mul_i32 s56, s57, s72
    buffer_load_dwordx4 v48, s[36:39], s56 offen offset:0 lds
    s_waitcnt vmcnt(3)
    v_dot2c_f32_bf16 v8, s75, v84
    v_dot2c_f32_bf16 v9, v84, v84
    v_dot2c_f32_bf16 v8, s75, v85
    v_dot2c_f32_bf16 v9, v85, v85
    v_dot2c_f32_bf16 v8, s75, v86
    v_dot2c_f32_bf16 v9, v86, v86
    v_dot2c_f32_bf16 v8, s75, v87
    v_dot2c_f32_bf16 v9, v87, v87
    buffer_load_dwordx4 v49, s[36:39], s56 offen offset:1024 lds
    s_waitcnt vmcnt(3)
    v_dot2c_f32_bf16 v8, s75, v88
    v_dot2c_f32_bf16 v9, v88, v88
    v_dot2c_f32_bf16 v8, s75, v89
    v_dot2c_f32_bf16 v9, v89, v89
    v_dot2c_f32_bf16 v8, s75, v90
    v_dot2c_f32_bf16 v9, v90, v90
    v_dot2c_f32_bf16 v8, s75, v91
    v_dot2c_f32_bf16 v9, v91, v91
    buffer_load_dwordx4 v50, s[36:39], s56 offen offset:2048 lds
    s_waitcnt vmcnt(3)
    v_dot2c_f32_bf16 v8, s75, v92
    v_dot2c_f32_bf16 v9, v92, v92
    v_dot2c_f32_bf16 v8, s75, v93
    v_dot2c_f32_bf16 v9, v93, v93
    v_dot2c_f32_bf16 v8, s75, v94
    v_dot2c_f32_bf16 v9, v94, v94
    v_dot2c_f32_bf16 v8, s75, v95
    v_dot2c_f32_bf16 v9, v95, v95
    buffer_load_dwordx4 v51, s[36:39], s56 offen offset:3072 lds
    s_add_u32 s57, s57, 64
    s_and_b32 s57, s57, 0x3c0
    s_nop 2
    v_add_f32_dpp v8, v8, v8 quad_perm:[1,0,3,2] row_mask:0xf bank_mask:0xf
    v_add_f32_dpp v9, v9, v9 quad_perm:[1,0,3,2] row_mask:0xf bank_mask:0xf
    s_nop 0
    v_add_f32_dpp v8, v8, v8 quad_perm:[2,3,0,1] row_mask:0xf bank_mask:0xf
    v_add_f32_dpp v9, v9, v9 quad_perm:[2,3,0,1] row_mask:0xf bank_mask:0xf
    s_nop 0
    v_add_f32_dpp v8, v8, v8 row_half_mirror row_mask:0xf bank_mask:0xf
    v_add_f32_dpp v9, v9, v9 row_half_mirror row_mask:0xf bank_mask:0xf
    s_nop 0
    v_mul_f32 v8, s76, v8
    v_mul_f32 v10, v8, v8
    v_fma_f32 v10, v9, s76, -v10
    v_max_f32 v10, 0, v10
    v_add_f32 v10, s77, v10
    v_rsq_f32 v16, v10
    s_nop 0
    v_mul_f32 v17, v8, v16
    v_lshlrev_b32 v32, 16, v64
    v_and_b32 v33, s59, v64
    v_lshlrev_b32 v34, 16, v65
    v_and_b32 v35, s59, v65
    v_lshlrev_b32 v36, 16, v66
    v_and_b32 v37, s59, v66
    v_lshlrev_b32 v38, 16, v67
    v_and_b32 v39, s59, v67
    s_add_u32 m0, s58, 16384
    s_mul_i32 s56, s57, s72
    buffer_load_dwordx4 v48, s[36:39], s56 offen offset:0 lds
    v_pk_fma_f32 v[32:33], v[32:33], v[16:17], v[16:17] op_sel:[0,0,1] op_sel_hi:[1,0,1] neg_lo:[0,0,1] neg_hi:[0,0,1]
    v_pk_fma_f32 v[34:35], v[34:35], v[16:17], v[16:17] op_sel:[0,0,1] op_sel_hi:[1,0,1] neg_lo:[0,0,1] neg_hi:[0,0,1]
    v_pk_fma_f32 v[36:37], v[36:37], v[16:17], v[16:17] op_sel:[0,0,1] op_sel_hi:[1,0,1] neg_lo:[0,0,1] neg_hi:[0,0,1]
    v_pk_fma_f32 v[38:39], v[38:39], v[16:17], v[16:17] op_sel:[0,0,1] op_sel_hi:[1,0,1] neg_lo:[0,0,1] neg_hi:[0,0,1]
    v_cvt_pk_bf16_f32 v64, v32, v33
    v_cvt_pk_bf16_f32 v65, v34, v35
    v_cvt_pk_bf16_f32 v66, v36, v37
    v_cvt_pk_bf16_f32 v67, v38, v39
    ds_write_b128 v40, v[64:67]
    buffer_load_dwordx4 v49, s[36:39], s56 offen offset:1024 lds
    v_lshlrev_b32 v32, 16, v68
    v_and_b32 v33, s59, v68
    v_lshlrev_b32 v34, 16, v69
    v_and_b32 v35, s59, v69
    v_lshlrev_b32 v36, 16, v70
    v_and_b32 v37, s59, v70
    v_lshlrev_b32 v38, 16, v71
    v_and_b32 v39, s59, v71
    buffer_load_dwordx4 v50, s[36:39], s56 offen offset:2048 lds
    v_pk_fma_f32 v[32:33], v[32:33], v[16:17], v[16:17] op_sel:[0,0,1] op_sel_hi:[1,0,1] neg_lo:[0,0,1] neg_hi:[0,0,1]
    v_pk_fma_f32 v[34:35], v[34:35], v[16:17], v[16:17] op_sel:[0,0,1] op_sel_hi:[1,0,1] neg_lo:[0,0,1] neg_hi:[0,0,1]
    v_pk_fma_f32 v[36:37], v[36:37], v[16:17], v[16:17] op_sel:[0,0,1] op_sel_hi:[1,0,1] neg_lo:[0,0,1] neg_hi:[0,0,1]
    v_pk_fma_f32 v[38:39], v[38:39], v[16:17], v[16:17] op_sel:[0,0,1] op_sel_hi:[1,0,1] neg_lo:[0,0,1] neg_hi:[0,0,1]
    v_cvt_pk_bf16_f32 v68, v32, v33
    v_cvt_pk_bf16_f32 v69, v34, v35
    v_cvt_pk_bf16_f32 v70, v36, v37
    v_cvt_pk_bf16_f32 v71, v38, v39
    ds_write_b128 v41, v[68:71]
    buffer_load_dwordx4 v51, s[36:39], s56 offen offset:3072 lds
    s_add_u32 s57, s57, 64
    s_and_b32 s57, s57, 0x3c0
    v_lshlrev_b32 v32, 16, v72
    v_and_b32 v33, s59, v72
    v_lshlrev_b32 v34, 16, v73
    v_and_b32 v35, s59, v73
    v_lshlrev_b32 v36, 16, v74
    v_and_b32 v37, s59, v74
    v_lshlrev_b32 v38, 16, v75
    v_and_b32 v39, s59, v75
    s_add_u32 m0, s58, 32768
    s_mul_i32 s56, s57, s72
    buffer_load_dwordx4 v48, s[36:39], s56 offen offset:0 lds
    v_pk_fma_f32 v[32:33], v[32:33], v[16:17], v[16:17] op_sel:[0,0,1] op_sel_hi:[1,0,1] neg_lo:[0,0,1] neg_hi:[0,0,1]
    v_pk_fma_f32 v[34:35], v[34:35], v[16:17], v[16:17] op_sel:[0,0,1] op_sel_hi:[1,0,1] neg_lo:[0,0,1] neg_hi:[0,0,1]
    v_pk_fma_f32 v[36:37], v[36:37], v[16:17], v[16:17] op_sel:[0,0,1] op_sel_hi:[1,0,1] neg_lo:[0,0,1] neg_hi:[0,0,1]
    v_pk_fma_f32 v[38:39], v[38:39], v[16:17], v[16:17] op_sel:[0,0,1] op_sel_hi:[1,0,1] neg_lo:[0,0,1] neg_hi:[0,0,1]
    v_cvt_pk_bf16_f32 v72, v32, v33
    v_cvt_pk_bf16_f32 v73, v34, v35
    v_cvt_pk_bf16_f32 v74, v36, v37
    v_cvt_pk_bf16_f32 v75, v38, v39
    ds_write_b128 v42, v[72:75]
    buffer_load_dwordx4 v49, s[36:39], s56 offen offset:1024 lds
    v_lshlrev_b32 v32, 16, v76
    v_and_b32 v33, s59, v76
    v_lshlrev_b32 v34, 16, v77
    v_and_b32 v35, s59, v77
    v_lshlrev_b32 v36, 16, v78
    v_and_b32 v37, s59, v78
    v_lshlrev_b32 v38, 16, v79
    v_and_b32 v39, s59, v79
    buffer_load_dwordx4 v50, s[36:39], s56 offen offset:2048 lds
    v_pk_fma_f32 v[32:33], v[32:33], v[16:17], v[16:17] op_sel:[0,0,1] op_sel_hi:[1,0,1] neg_lo:[0,0,1] neg_hi:[0,0,1]
    v_pk_fma_f32 v[34:35], v[34:35], v[16:17], v[16:17] op_sel:[0,0,1] op_sel_hi:[1,0,1] neg_lo:[0,0,1] neg_hi:[0,0,1]
    v_pk_fma_f32 v[36:37], v[36:37], v[16:17], v[16:17] op_sel:[0,0,1] op_sel_hi:[1,0,1] neg_lo:[0,0,1] neg_hi:[0,0,1]
    v_pk_fma_f32 v[38:39], v[38:39], v[16:17], v[16:17] op_sel:[0,0,1] op_sel_hi:[1,0,1] neg_lo:[0,0,1] neg_hi:[0,0,1]
    v_cvt_pk_bf16_f32 v76, v32, v33
    v_cvt_pk_bf16_f32 v77, v34, v35
    v_cvt_pk_bf16_f32 v78, v36, v37
    v_cvt_pk_bf16_f32 v79, v38, v39
    ds_write_b128 v43, v[76:79]
    buffer_load_dwordx4 v51, s[36:39], s56 offen offset:3072 lds
    s_add_u32 s57, s57, 64
    s_and_b32 s57, s57, 0x3c0
    v_lshlrev_b32 v32, 16, v80
    v_and_b32 v33, s59, v80
    v_lshlrev_b32 v34, 16, v81
    v_and_b32 v35, s59, v81
    v_lshlrev_b32 v36, 16, v82
    v_and_b32 v37, s59, v82
    v_lshlrev_b32 v38, 16, v83
    v_and_b32 v39, s59, v83
    s_add_u32 m0, s58, 49152
    s_mul_i32 s56, s57, s72
    buffer_load_dwordx4 v48, s[36:39], s56 offen offset:0 lds
    v_pk_fma_f32 v[32:33], v[32:33], v[16:17], v[16:17] op_sel:[0,0,1] op_sel_hi:[1,0,1] neg_lo:[0,0,1] neg_hi:[0,0,1]
    v_pk_fma_f32 v[34:35], v[34:35], v[16:17], v[16:17] op_sel:[0,0,1] op_sel_hi:[1,0,1] neg_lo:[0,0,1] neg_hi:[0,0,1]
    v_pk_fma_f32 v[36:37], v[36:37], v[16:17], v[16:17] op_sel:[0,0,1] op_sel_hi:[1,0,1] neg_lo:[0,0,1] neg_hi:[0,0,1]
    v_pk_fma_f32 v[38:39], v[38:39], v[16:17], v[16:17] op_sel:[0,0,1] op_sel_hi:[1,0,1] neg_lo:[0,0,1] neg_hi:[0,0,1]
    v_cvt_pk_bf16_f32 v80, v32, v33
    v_cvt_pk_bf16_f32 v81, v34, v35
    v_cvt_pk_bf16_f32 v82, v36, v37
    v_cvt_pk_bf16_f32 v83, v38, v39
    ds_write_b128 v44, v[80:83]
    buffer_load_dwordx4 v49, s[36:39], s56 offen offset:1024 lds
    v_lshlrev_b32 v32, 16, v84
    v_and_b32 v33, s59, v84
    v_lshlrev_b32 v34, 16, v85
    v_and_b32 v35, s59, v85
    v_lshlrev_b32 v36, 16, v86
    v_and_b32 v37, s59, v86
    v_lshlrev_b32 v38, 16, v87
    v_and_b32 v39, s59, v87
    buffer_load_dwordx4 v50, s[36:39], s56 offen offset:2048 lds
    v_pk_fma_f32 v[32:33], v[32:33], v[16:17], v[16:17] op_sel:[0,0,1] op_sel_hi:[1,0,1] neg_lo:[0,0,1] neg_hi:[0,0,1]
    v_pk_fma_f32 v[34:35], v[34:35], v[16:17], v[16:17] op_sel:[0,0,1] op_sel_hi:[1,0,1] neg_lo:[0,0,1] neg_hi:[0,0,1]
    v_pk_fma_f32 v[36:37], v[36:37], v[16:17], v[16:17] op_sel:[0,0,1] op_sel_hi:[1,0,1] neg_lo:[0,0,1] neg_hi:[0,0,1]
    v_pk_fma_f32 v[38:39], v[38:39], v[16:17], v[16:17] op_sel:[0,0,1] op_sel_hi:[1,0,1] neg_lo:[0,0,1] neg_hi:[0,0,1]
    v_cvt_pk_bf16_f32 v84, v32, v33
    v_cvt_pk_bf16_f32 v85, v34, v35
    v_cvt_pk_bf16_f32 v86, v36, v37
    v_cvt_pk_bf16_f32 v87, v38, v39
    ds_write_b128 v45, v[84:87]
    buffer_load_dwordx4 v51, s[36:39], s56 offen offset:3072 lds
    s_add_u32 s57, s57, 64
    s_and_b32 s57, s57, 0x3c0
    v_lshlrev_b32 v32, 16, v88
    v_and_b32 v33, s59, v88
    v_lshlrev_b32 v34, 16, v89
    v_and_b32 v35, s59, v89
    v_lshlrev_b32 v36, 16, v90
    v_and_b32 v37, s59, v90
    v_lshlrev_b32 v38, 16, v91
    v_and_b32 v39, s59, v91
    v_pk_fma_f32 v[32:33], v[32:33], v[16:17], v[16:17] op_sel:[0,0,1] op_sel_hi:[1,0,1] neg_lo:[0,0,1] neg_hi:[0,0,1]
    v_pk_fma_f32 v[34:35], v[34:35], v[16:17], v[16:17] op_sel:[0,0,1] op_sel_hi:[1,0,1] neg_lo:[0,0,1] neg_hi:[0,0,1]
    v_pk_fma_f32 v[36:37], v[36:37], v[16:17], v[16:17] op_sel:[0,0,1] op_sel_hi:[1,0,1] neg_lo:[0,0,1] neg_hi:[0,0,1]
    v_pk_fma_f32 v[38:39], v[38:39], v[16:17], v[16:17] op_sel:[0,0,1] op_sel_hi:[1,0,1] neg_lo:[0,0,1] neg_hi:[0,0,1]
    v_cvt_pk_bf16_f32 v88, v32, v33
    v_cvt_pk_bf16_f32 v89, v34, v35
    v_cvt_pk_bf16_f32 v90, v36, v37
    v_cvt_pk_bf16_f32 v91, v38, v39
    ds_write_b128 v46, v[88:91]
    v_lshlrev_b32 v32, 16, v92
    v_and_b32 v33, s59, v92
    v_lshlrev_b32 v34, 16, v93
    v_and_b32 v35, s59, v93
    v_lshlrev_b32 v36, 16, v94
    v_and_b32 v37, s59, v94
    v_lshlrev_b32 v38, 16, v95
    v_and_b32 v39, s59, v95
    v_pk_fma_f32 v[32:33], v[32:33], v[16:17], v[16:17] op_sel:[0,0,1] op_sel_hi:[1,0,1] neg_lo:[0,0,1] neg_hi:[0,0,1]
    v_pk_fma_f32 v[34:35], v[34:35], v[16:17], v[16:17] op_sel:[0,0,1] op_sel_hi:[1,0,1] neg_lo:[0,0,1] neg_hi:[0,0,1]
    v_pk_fma_f32 v[36:37], v[36:37], v[16:17], v[16:17] op_sel:[0,0,1] op_sel_hi:[1,0,1] neg_lo:[0,0,1] neg_hi:[0,0,1]
    v_pk_fma_f32 v[38:39], v[38:39], v[16:17], v[16:17] op_sel:[0,0,1] op_sel_hi:[1,0,1] neg_lo:[0,0,1] neg_hi:[0,0,1]
    v_cvt_pk_bf16_f32 v92, v32, v33
    v_cvt_pk_bf16_f32 v93, v34, v35
    v_cvt_pk_bf16_f32 v94, v36, v37
    v_cvt_pk_bf16_f32 v95, v38, v39
    ds_write_b128 v47, v[92:95]
    s_setprio 2
    s_waitcnt lgkmcnt(0)
    s_waitcnt vmcnt(12)
    s_barrier
    s_add_u32 m0, s58, 65536
    s_mul_i32 s56, s57, s72
    buffer_load_dwordx4 v48, s[36:39], s56 offen offset:0 lds
    buffer_load_dwordx4 v49, s[36:39], s56 offen offset:1024 lds
    buffer_load_dwordx4 v50, s[36:39], s56 offen offset:2048 lds
    buffer_load_dwordx4 v51, s[36:39], s56 offen offset:3072 lds
    s_add_u32 s57, s57, 64
    s_and_b32 s57, s57, 0x3c0
    s_waitcnt vmcnt(12)
    s_barrier
    s_add_u32 m0, s58, 0
    s_mul_i32 s56, s57, s72
    buffer_load_dwordx4 v48, s[36:39], s56 offen offset:0 lds
    buffer_load_dwordx4 v49, s[36:39], s56 offen offset:1024 lds
    buffer_load_dwordx4 v50, s[36:39], s56 offen offset:2048 lds
    buffer_load_dwordx4 v51, s[36:39], s56 offen offset:3072 lds
    s_add_u32 s57, s57, 64
    s_and_b32 s57, s57, 0x3c0
    s_waitcnt vmcnt(12)
    s_barrier
    s_add_u32 m0, s58, 16384
    s_mul_i32 s56, s57, s72
    buffer_load_dwordx4 v48, s[36:39], s56 offen offset:0 lds
    v_lshrrev_b32 v12, 1, v0
    v_and_b32 v13, 1, v0
    buffer_load_dwordx4 v49, s[36:39], s56 offen offset:1024 lds
    v_lshlrev_b32 v12, 7, v12
    v_lshl_add_u32 v12, v13, 4, v12
    buffer_load_dwordx4 v50, s[36:39], s56 offen offset:2048 lds
    s_lshl1_add_u32 s49, s18, s50
    s_lshl_b32 s49, s49, 5
    buffer_load_dwordx4 v51, s[36:39], s56 offen offset:3072 lds
    s_add_u32 s57, s57, 64
    s_and_b32 s57, s57, 0x3c0
    s_waitcnt vmcnt(12)
    s_barrier
    s_add_u32 m0, s58, 32768
    s_mul_i32 s56, s57, s72
    buffer_load_dwordx4 v48, s[36:39], s56 offen offset:0 lds
    s_lshl2_add_u32 s49, s7, s49
    s_lshl1_add_u32 s49, s51, s49
    buffer_load_dwordx4 v49, s[36:39], s56 offen offset:1024 lds
    s_lshl_b32 s49, s49, 10
    s_mul_i32 s64, s48, 10240
    buffer_load_dwordx4 v50, s[36:39], s56 offen offset:2048 lds
    s_mov_b32 s66, 4784128
    s_mov_b32 s67, 4194304
    buffer_load_dwordx4 v51, s[36:39], s56 offen offset:3072 lds
    s_add_u32 s57, s57, 64
    s_and_b32 s57, s57, 0x3c0
    s_waitcnt vmcnt(12)
    s_barrier
    s_add_u32 m0, s58, 49152
    s_mul_i32 s56, s57, s72
    buffer_load_dwordx4 v48, s[36:39], s56 offen offset:0 lds
    s_mov_b32 s69, 4198528
    s_and_b32 s60, s7, 6
    buffer_load_dwordx4 v49, s[36:39], s56 offen offset:1024 lds
    s_add_u32 s60, s60, s51
    s_lshl_b32 s65, s18, 7
    buffer_load_dwordx4 v50, s[36:39], s56 offen offset:2048 lds
    s_lshl2_add_u32 s65, s60, s65
    s_add_u32 s65, s65, 4792320
    buffer_load_dwordx4 v51, s[36:39], s56 offen offset:3072 lds
    s_add_u32 s57, s57, 64
    s_and_b32 s57, s57, 0x3c0
    s_waitcnt vmcnt(12)
    s_barrier
    s_add_u32 m0, s58, 65536
    s_mul_i32 s56, s57, s72
    buffer_load_dwordx4 v48, s[36:39], s56 offen offset:0 lds
    v_and_b32 v8, 31, v0
    v_lshrrev_b32 v14, 5, v0
    buffer_load_dwordx4 v49, s[36:39], s56 offen offset:1024 lds
    v_lshlrev_b32 v14, 8, v14
    v_lshl_add_u32 v14, v8, 4, v14
    buffer_load_dwordx4 v50, s[36:39], s56 offen offset:2048 lds
    v_and_b32 v15, 27, v8
    v_cmp_eq_u32 vcc, 16, v15
    buffer_load_dwordx4 v51, s[36:39], s56 offen offset:3072 lds
    s_add_u32 s57, s57, 64
    s_and_b32 s57, s57, 0x3c0
    s_waitcnt vmcnt(12)
    s_barrier
    s_add_u32 m0, s58, 0
    s_mul_i32 s56, s57, s72
    buffer_load_dwordx4 v48, s[36:39], s56 offen offset:0 lds
    v_mov_b32 v15, 528
    v_mov_b32 v13, 512
    buffer_load_dwordx4 v49, s[36:39], s56 offen offset:1024 lds
    v_cndmask_b32 v15, v15, v13, vcc
    v_cmp_gt_u32 vcc, 16, v8
    buffer_load_dwordx4 v50, s[36:39], s56 offen offset:2048 lds
    v_mov_b32 v2, 0xdddddddd
    s_mov_b32 s52, 0
    buffer_load_dwordx4 v51, s[36:39], s56 offen offset:3072 lds
    s_add_u32 s57, s57, 64
    s_and_b32 s57, s57, 0x3c0
    s_waitcnt vmcnt(12)
    s_barrier
    s_add_u32 m0, s58, 16384
    s_mul_i32 s56, s57, s72
    buffer_load_dwordx4 v48, s[36:39], s56 offen offset:0 lds
    v_cndmask_b32 v5, v15, v14, vcc
    v_add_u32 v5, 1024, v5
    buffer_load_dwordx4 v49, s[36:39], s56 offen offset:1024 lds
    v_mov_b32 v14, 163824
    v_mov_b32 v1, 1
    buffer_load_dwordx4 v50, s[36:39], s56 offen offset:2048 lds
    v_mov_b32 v7, 0
    v_mov_b32 v192, 0
    buffer_load_dwordx4 v51, s[36:39], s56 offen offset:3072 lds
    s_add_u32 s57, s57, 64
    s_and_b32 s57, s57, 0x3c0
    s_waitcnt vmcnt(12)
    s_barrier
    s_add_u32 m0, s58, 32768
    s_mul_i32 s56, s57, s72
    buffer_load_dwordx4 v48, s[36:39], s56 offen offset:0 lds
    v_mov_b32 v193, 0
    v_mov_b32 v194, 0
    buffer_load_dwordx4 v49, s[36:39], s56 offen offset:1024 lds
    v_mov_b32 v195, 0
    v_mov_b32 v196, 0
    buffer_load_dwordx4 v50, s[36:39], s56 offen offset:2048 lds
    v_mov_b32 v197, 0
    v_mov_b32 v198, 0
    buffer_load_dwordx4 v51, s[36:39], s56 offen offset:3072 lds
    s_add_u32 s57, s57, 64
    s_and_b32 s57, s57, 0x3c0
    s_waitcnt vmcnt(12)
    s_barrier
    s_add_u32 m0, s58, 49152
    s_mul_i32 s56, s57, s72
    buffer_load_dwordx4 v48, s[36:39], s56 offen offset:0 lds
    v_mov_b32 v199, 0
    v_mov_b32 v200, 0
    buffer_load_dwordx4 v49, s[36:39], s56 offen offset:1024 lds
    v_mov_b32 v201, 0
    v_mov_b32 v202, 0
    buffer_load_dwordx4 v50, s[36:39], s56 offen offset:2048 lds
    v_mov_b32 v203, 0
    v_mov_b32 v204, 0
    buffer_load_dwordx4 v51, s[36:39], s56 offen offset:3072 lds
    s_add_u32 s57, s57, 64
    s_and_b32 s57, s57, 0x3c0
    s_waitcnt vmcnt(12)
    s_barrier
    s_add_u32 m0, s58, 65536
    s_mul_i32 s56, s57, s72
    buffer_load_dwordx4 v48, s[36:39], s56 offen offset:0 lds
    v_mov_b32 v205, 0
    v_mov_b32 v206, 0
    buffer_load_dwordx4 v49, s[36:39], s56 offen offset:1024 lds
    v_mov_b32 v207, 0
    v_mov_b32 v208, 0
    buffer_load_dwordx4 v50, s[36:39], s56 offen offset:2048 lds
    v_mov_b32 v209, 0
    v_mov_b32 v210, 0
    buffer_load_dwordx4 v51, s[36:39], s56 offen offset:3072 lds
    s_add_u32 s57, s57, 64
    s_and_b32 s57, s57, 0x3c0
    s_waitcnt vmcnt(12)
    s_barrier
    s_add_u32 m0, s58, 0
    s_mul_i32 s56, s57, s72
    buffer_load_dwordx4 v48, s[36:39], s56 offen offset:0 lds
    v_mov_b32 v211, 0
    v_mov_b32 v212, 0
    buffer_load_dwordx4 v49, s[36:39], s56 offen offset:1024 lds
    v_mov_b32 v213, 0
    v_mov_b32 v214, 0
    buffer_load_dwordx4 v50, s[36:39], s56 offen offset:2048 lds
    v_mov_b32 v215, 0
    v_mov_b32 v216, 0
    buffer_load_dwordx4 v51, s[36:39], s56 offen offset:3072 lds
    s_add_u32 s57, s57, 64
    s_and_b32 s57, s57, 0x3c0
L_pad_x47:
    s_cbranch_execz L_ret_x47
    s_waitcnt vmcnt(12)
    s_barrier
    s_add_u32 m0, s58, 16384
    s_mul_i32 s56, s57, s73
    buffer_load_dwordx4 v52, s[44:47], s56 offen offset:0 lds
    v_mov_b32 v217, 0
    v_mov_b32 v218, 0
    buffer_load_dwordx4 v53, s[44:47], s56 offen offset:1024 lds
    v_mov_b32 v219, 0
    v_mov_b32 v220, 0
    buffer_load_dwordx4 v54, s[44:47], s56 offen offset:2048 lds
    v_mov_b32 v221, 0
    v_mov_b32 v222, 0
    buffer_load_dwordx4 v55, s[44:47], s56 offen offset:3072 lds
    s_add_u32 s57, s57, 64
    s_and_b32 s57, s57, 0x3c0
    s_waitcnt vmcnt(12)
    s_barrier
    s_add_u32 m0, s58, 32768
    s_mul_i32 s56, s57, s73
    buffer_load_dwordx4 v52, s[44:47], s56 offen offset:0 lds
    v_mov_b32 v223, 0
    buffer_load_dwordx4 v53, s[44:47], s56 offen offset:1024 lds
    buffer_load_dwordx4 v54, s[44:47], s56 offen offset:2048 lds
    buffer_load_dwordx4 v55, s[44:47], s56 offen offset:3072 lds
    s_add_u32 s57, s57, 64
    s_and_b32 s57, s57, 0x3c0
    s_waitcnt vmcnt(12)
    s_barrier
    s_add_u32 m0, s58, 49152
    s_mul_i32 s56, s57, s73
    buffer_load_dwordx4 v52, s[44:47], s56 offen offset:0 lds
    buffer_load_dwordx4 v53, s[44:47], s56 offen offset:1024 lds
    buffer_load_dwordx4 v54, s[44:47], s56 offen offset:2048 lds
    buffer_load_dwordx4 v55, s[44:47], s56 offen offset:3072 lds
    s_add_u32 s57, s57, 64
    s_and_b32 s57, s57, 0x3c0
    s_waitcnt vmcnt(12)
    s_barrier
    s_add_u32 m0, s58, 65536
    s_mul_i32 s56, s57, s73
    buffer_load_dwordx4 v52, s[44:47], s56 offen offset:0 lds
    buffer_load_dwordx4 v53, s[44:47], s56 offen offset:1024 lds
    buffer_load_dwordx4 v54, s[44:47], s56 offen offset:2048 lds
    buffer_load_dwordx4 v55, s[44:47], s56 offen offset:3072 lds
    s_add_u32 s57, s57, 64
    s_and_b32 s57, s57, 0x3c0
    s_waitcnt vmcnt(12)
    s_barrier
    s_add_u32 m0, s58, 0
    s_mul_i32 s56, s57, s73
    buffer_load_dwordx4 v52, s[44:47], s56 offen offset:0 lds
    buffer_load_dwordx4 v53, s[44:47], s56 offen offset:1024 lds
    buffer_load_dwordx4 v54, s[44:47], s56 offen offset:2048 lds
    buffer_load_dwordx4 v55, s[44:47], s56 offen offset:3072 lds
    s_add_u32 s57, s57, 64
    s_and_b32 s57, s57, 0x3c0
    s_waitcnt vmcnt(12)
    s_barrier
    s_add_u32 m0, s58, 16384
    s_mul_i32 s56, s57, s73
    buffer_load_dwordx4 v52, s[44:47], s56 offen offset:0 lds
    buffer_load_dwordx4 v53, s[44:47], s56 offen offset:1024 lds
    buffer_load_dwordx4 v54, s[44:47], s56 offen offset:2048 lds
    buffer_load_dwordx4 v55, s[44:47], s56 offen offset:3072 lds
    s_add_u32 s57, s57, 64
    s_and_b32 s57, s57, 0x3c0
    s_waitcnt vmcnt(12)
    s_barrier
    s_add_u32 m0, s58, 32768
    s_mul_i32 s56, s57, s73
    buffer_load_dwordx4 v52, s[44:47], s56 offen offset:0 lds
    buffer_load_dwordx4 v53, s[44:47], s56 offen offset:1024 lds
    buffer_load_dwordx4 v54, s[44:47], s56 offen offset:2048 lds
    buffer_load_dwordx4 v55, s[44:47], s56 offen offset:3072 lds
    s_add_u32 s57, s57, 64
    s_and_b32 s57, s57, 0x3c0
    s_waitcnt vmcnt(12)
    s_barrier
    s_add_u32 m0, s58, 49152
    s_mul_i32 s56, s57, s73
    buffer_load_dwordx4 v52, s[44:47], s56 offen offset:0 lds
    buffer_load_dwordx4 v53, s[44:47], s56 offen offset:1024 lds
    buffer_load_dwordx4 v54, s[44:47], s56 offen offset:2048 lds
    buffer_load_dwordx4 v55, s[44:47], s56 offen offset:3072 lds
    s_add_u32 s57, s57, 64
    s_and_b32 s57, s57, 0x3c0
    s_waitcnt vmcnt(12)
    s_barrier
    s_add_u32 m0, s58, 65536
    s_mul_i32 s56, s57, s73
    buffer_load_dwordx4 v52, s[44:47], s56 offen offset:0 lds
    buffer_load_dwordx4 v53, s[44:47], s56 offen offset:1024 lds
    buffer_load_dwordx4 v54, s[44:47], s56 offen offset:2048 lds
    buffer_load_dwordx4 v55, s[44:47], s56 offen offset:3072 lds
    s_add_u32 s57, s57, 64
    s_and_b32 s57, s57, 0x3c0
    s_waitcnt vmcnt(12)
    s_barrier
    s_add_u32 m0, s58, 0
    s_mul_i32 s56, s57, s73
    buffer_load_dwordx4 v52, s[44:47], s56 offen offset:0 lds
    buffer_load_dwordx4 v53, s[44:47], s56 offen offset:1024 lds
    buffer_load_dwordx4 v54, s[44:47], s56 offen offset:2048 lds
    buffer_load_dwordx4 v55, s[44:47], s56 offen offset:3072 lds
    s_add_u32 s57, s57, 64
    s_and_b32 s57, s57, 0x3c0
    s_waitcnt vmcnt(12)
    s_barrier
    s_add_u32 m0, s58, 16384
    s_mul_i32 s56, s57, s73
    buffer_load_dwordx4 v52, s[44:47], s56 offen offset:0 lds
    buffer_load_dwordx4 v53, s[44:47], s56 offen offset:1024 lds
    buffer_load_dwordx4 v54, s[44:47], s56 offen offset:2048 lds
    buffer_load_dwordx4 v55, s[44:47], s56 offen offset:3072 lds
    s_add_u32 s57, s57, 64
    s_and_b32 s57, s57, 0x3c0
    s_waitcnt vmcnt(12)
    s_barrier
    s_add_u32 m0, s58, 32768
    s_mul_i32 s56, s57, s73
    buffer_load_dwordx4 v52, s[44:47], s56 offen offset:0 lds
    buffer_load_dwordx4 v53, s[44:47], s56 offen offset:1024 lds
    buffer_load_dwordx4 v54, s[44:47], s56 offen offset:2048 lds
    buffer_load_dwordx4 v55, s[44:47], s56 offen offset:3072 lds
    s_add_u32 s57, s57, 64
    s_and_b32 s57, s57, 0x3c0
    s_waitcnt vmcnt(12)
    s_barrier
    s_add_u32 m0, s58, 49152
    s_mul_i32 s56, s57, s73
    buffer_load_dwordx4 v52, s[44:47], s56 offen offset:0 lds
    buffer_load_dwordx4 v53, s[44:47], s56 offen offset:1024 lds
    buffer_load_dwordx4 v54, s[44:47], s56 offen offset:2048 lds
    buffer_load_dwordx4 v55, s[44:47], s56 offen offset:3072 lds
    s_add_u32 s57, s57, 64
    s_and_b32 s57, s57, 0x3c0
    s_waitcnt vmcnt(12)
    s_barrier
    s_add_u32 m0, s58, 65536
    s_mul_i32 s56, s57, s73
    buffer_load_dwordx4 v52, s[44:47], s56 offen offset:0 lds
    buffer_load_dwordx4 v53, s[44:47], s56 offen offset:1024 lds
    buffer_load_dwordx4 v54, s[44:47], s56 offen offset:2048 lds
    buffer_load_dwordx4 v55, s[44:47], s56 offen offset:3072 lds
    s_add_u32 s57, s57, 64
    s_and_b32 s57, s57, 0x3c0
    s_waitcnt vmcnt(12)
    s_barrier
    s_add_u32 m0, s58, 0
    s_mul_i32 s56, s57, s73
    buffer_load_dwordx4 v52, s[44:47], s56 offen offset:0 lds
    buffer_load_dwordx4 v53, s[44:47], s56 offen offset:1024 lds
    buffer_load_dwordx4 v54, s[44:47], s56 offen offset:2048 lds
    buffer_load_dwordx4 v55, s[44:47], s56 offen offset:3072 lds
    s_add_u32 s57, s57, 64
    s_and_b32 s57, s57, 0x3c0
    s_waitcnt vmcnt(12)
    s_barrier
    s_add_u32 m0, s58, 16384
    s_mul_i32 s56, s57, s73
    buffer_load_dwordx4 v52, s[44:47], s56 offen offset:0 lds
    buffer_load_dwordx4 v53, s[44:47], s56 offen offset:1024 lds
    buffer_load_dwordx4 v54, s[44:47], s56 offen offset:2048 lds
    buffer_load_dwordx4 v55, s[44:47], s56 offen offset:3072 lds
    s_add_u32 s57, s57, 64
    s_and_b32 s57, s57, 0x3c0
    buffer_load_dword v9, v7, s[8:11], 0 offen sc1
    buffer_load_dwordx4 v[44:47], v12, s[40:43], s66 offen sc1
    s_waitcnt vmcnt(14)
    s_barrier
    buffer_load_dword v10, v7, s[40:43], s65 offen sc1
    s_waitcnt vmcnt(11)
    s_barrier
    s_waitcnt vmcnt(7)
    s_barrier
    s_waitcnt vmcnt(0)
    v_readfirstlane_b32 s4, v9
    s_nop 3
    s_cmp_eq_u32 s4, 0
    s_cbranch_scc1 L_nspin_1
L_ngot_2:
    v_xor_b32 v44, s4, v44
    v_xor_b32 v45, s4, v45
    v_xor_b32 v46, s4, v46
    v_xor_b32 v47, s4, v47
    v_or3_b32 v44, v44, v45, v46
    v_or_b32 v44, v44, v47
    v_cmp_ne_u32 vcc, 0, v44
    s_nop 4
    s_cbranch_vccnz L_slow
    v_cmp_ne_u32 vcc, s4, v10
    buffer_load_dwordx4 v[232:235], v6, s[40:43], s67 offen offset:0 sc1
    buffer_load_dwordx4 v[236:239], v6, s[40:43], s67 offen offset:2112 sc1
    s_nop 2
    s_cbranch_vccnz L_slow2
    buffer_load_dwordx4 v[224:227], v6, s[40:43], s49 offen sc1
    buffer_load_dwordx4 v[228:231], v6, s[40:43], s49 offen offset:1024 sc1
    s_waitcnt vmcnt(7)
    s_barrier
    s_mov_b32 m0, s64
    s_add_u32 s61, s64, 4194304
    buffer_load_dwordx4 v6, s[40:43], s61 offen offset:0 sc1 lds
    buffer_load_dwordx4 v6, s[40:43], s61 offen offset:1024 sc1 lds
    buffer_load_dwordx4 v6, s[40:43], s61 offen offset:2048 sc1 lds
    buffer_load_dwordx4 v6, s[40:43], s61 offen offset:3072 sc1 lds
    s_add_u32 s64, s64, 4096
    s_barrier
    s_mov_b32 m0, s64
    s_add_u32 s61, s64, 4194304
    buffer_load_dwordx4 v6, s[40:43], s61 offen offset:0 sc1 lds
    buffer_load_dwordx4 v6, s[40:43], s61 offen offset:1024 sc1 lds
    buffer_load_dwordx4 v6, s[40:43], s61 offen offset:2048 sc1 lds
    buffer_load_dwordx4 v6, s[40:43], s61 offen offset:3072 sc1 lds
    s_add_u32 s64, s64, 4096
    s_mov_b32 m0, s64
    s_add_u32 s61, s64, 4194304
    buffer_load_dwordx4 v6, s[40:43], s61 offen offset:0 sc1 lds
    buffer_load_dwordx4 v6, s[40:43], s61 offen offset:1024 sc1 lds
    s_mov_b32 s53, 1
    s_waitcnt vmcnt(10)
L_xgo:
    s_setprio 3
    v_swap_b32 v226, v228
    v_swap_b32 v227, v229
    s_nop 1
    v_mfma_f32_32x32x16_bf16 v[128:143], v[232:235], v[224:227], 0
    v_mfma_f32_32x32x16_bf16 v[144:159], v[232:235], v[228:231], 0
    v_mfma_f32_32x32x16_bf16 v[160:175], v[236:239], v[224:227], 0
    s_nop 9
    v_max3_f32 v8, v128, v129, v130
    v_max3_f32 v8, v8, v131, v132
    v_max3_f32 v8, v8, v133, v134
    v_max3_f32 v8, v8, v135, v136
    v_max3_f32 v8, v8, v137, v138
    v_max3_f32 v8, v8, v139, v140
    v_max3_f32 v8, v8, v141, v142
    v_max_f32 v8, v8, v143
    v_mfma_f32_32x32x16_bf16 v[176:191], v[236:239], v[228:231], 0
    v_max3_f32 v9, v144, v145, v146
    v_max3_f32 v9, v9, v147, v148
    v_max3_f32 v9, v9, v149, v150
    v_max3_f32 v9, v9, v151, v152
    v_max3_f32 v9, v9, v153, v154
    v_max3_f32 v9, v9, v155, v156
    v_max3_f32 v9, v9, v157, v158
    v_max_f32 v9, v9, v159
    v_max3_f32 v8, v8, v160, v161
    v_max3_f32 v8, v8, v162, v163
    v_max3_f32 v8, v8, v164, v165
    v_max3_f32 v8, v8, v166, v167
    v_max3_f32 v8, v8, v168, v169
    v_max3_f32 v8, v8, v170, v171
    v_max3_f32 v8, v8, v172, v173
    v_max3_f32 v8, v8, v174, v175
    v_max3_f32 v9, v9, v176, v177
    v_max3_f32 v9, v9, v178, v179
    v_max3_f32 v9, v9, v180, v181
    v_max3_f32 v9, v9, v182, v183
    v_max3_f32 v9, v9, v184, v185
    v_max3_f32 v9, v9, v186, v187
    v_max3_f32 v9, v9, v188, v189
    v_max3_f32 v9, v9, v190, v191
    s_mov_b32 s54, 0xc2cc0000
L_setmax:
    v_mov_b32 v10, v8
    v_mov_b32 v11, v9
    v_mov_b32 v3, v6
    v_mov_b32 v4, v5
    v_permlane32_swap_b32 v8, v10
    v_permlane32_swap_b32 v9, v11
    v_max_f32 v8, v8, v10
    v_max_f32 v9, v9, v11
    v_sub_f32 v8, s54, v8
    v_sub_f32 v10, s54, v9
    v_sub_f32 v11, s54, v9
    v_mov_b32 v9, v8
    v_mov_b64 v[160:161], v[8:9]
    v_mov_b64 v[162:163], v[8:9]
    v_mov_b64 v[164:165], v[8:9]
    v_mov_b64 v[166:167], v[8:9]
    v_mov_b64 v[168:169], v[8:9]
    v_mov_b64 v[170:171], v[8:9]
    v_mov_b64 v[172:173], v[8:9]
    v_mov_b64 v[174:175], v[8:9]
    v_mov_b64 v[176:177], v[10:11]
    v_mov_b64 v[178:179], v[10:11]
    v_mov_b64 v[180:181], v[10:11]
    v_mov_b64 v[182:183], v[10:11]
    v_mov_b64 v[184:185], v[10:11]
    v_mov_b64 v[186:187], v[10:11]
    v_mov_b64 v[188:189], v[10:11]
    v_mov_b64 v[190:191], v[10:11]
    v_mfma_f32_32x32x16_bf16 v[128:143], v[232:235], v[224:227], v[160:175]
    s_cmp_lg_u32 s52, 0
    s_cbranch_scc1 L_nosync
    s_waitcnt vmcnt(0)
    s_mov_b64 exec, 1
    ds_add_u32 v14, v1 offset:0
    s_mov_b64 exec, -1
    s_mov_b32 s62, 1048576
L_lw_4:
    ds_read_b32 v15, v14 offset:0
    s_waitcnt lgkmcnt(0)
    v_readfirstlane_b32 s63, v15
    s_sub_u32 s62, s62, 1
    s_nop 2
    s_cmp_ge_u32 s63, 4
    s_cbranch_scc1 L_lwd_5
    s_cmp_lg_u32 s62, 0
    s_cbranch_scc1 L_lw_4
L_lwd_5:
    s_setprio 1
L_nosync:
    ds_read_b128 v[240:243], v4
    ds_read_b128 v[248:251], v4 offset:544
    ds_read_b128 v[236:239], v3 offset:2112
    ds_read_b128 v[244:247], v4 offset:2112
    s_mov_b32 s53, 8
    s_mov_b32 s55, 0x44040400
    s_nop 2
    s_waitcnt lgkmcnt(3)
    v_exp_f32 v128, v128
    v_exp_f32 v129, v129
.p2align 3
L_loop:
    ds_read_b128 v[252:255], v4 offset:2656
    v_exp_f32 v130, v130
    v_exp_f32 v131, v131
    v_mfma_f32_32x32x16_bf16 v[144:159], v[232:235], v[228:231], v[176:191]
    v_exp_f32 v132, v132
    v_exp_f32 v133, v133
    v_exp_f32 v134, v134
    v_exp_f32 v135, v135
    v_exp_f32 v136, v136
    v_exp_f32 v137, v137
    v_smfmac_f32_32x32x32_bf16 v[192:207], v[240:243], v[128:135], v2
    s_waitcnt lgkmcnt(1)
    v_exp_f32 v138, v138
    v_exp_f32 v139, v139
    v_exp_f32 v140, v140
    v_exp_f32 v141, v141
    v_exp_f32 v142, v142
    v_exp_f32 v143, v143
    v_exp_f32 v144, v144
    v_exp_f32 v145, v145
    v_smfmac_f32_32x32x32_bf16 v[192:207], v[248:251], v[136:143], v2
    ds_read_b128 v[232:235], v3 offset:4224
    v_exp_f32 v146, v146
    v_exp_f32 v147, v147
    v_mfma_f32_32x32x16_bf16 v[128:143], v[236:239], v[224:227], v[160:175]
    v_exp_f32 v148, v148
    v_exp_f32 v149, v149
    v_exp_f32 v150, v150
    v_exp_f32 v151, v151
    v_exp_f32 v152, v152
    v_exp_f32 v153, v153
    v_smfmac_f32_32x32x32_bf16 v[208:223], v[240:243], v[144:151], v2
    ds_read_b128 v[240:243], v4 offset:4224
    v_exp_f32 v154, v154
    v_exp_f32 v155, v155
    v_exp_f32 v156, v156
    v_exp_f32 v157, v157
    v_exp_f32 v158, v158
    v_exp_f32 v159, v159
    v_exp_f32 v128, v128
    v_exp_f32 v129, v129
    v_smfmac_f32_32x32x32_bf16 v[208:223], v[248:251], v[152:159], v2
    ds_read_b128 v[248:251], v4 offset:4768
    v_exp_f32 v130, v130
    v_exp_f32 v131, v131
    v_mfma_f32_32x32x16_bf16 v[144:159], v[236:239], v[228:231], v[176:191]
    v_exp_f32 v132, v132
    v_exp_f32 v133, v133
    v_exp_f32 v134, v134
    v_exp_f32 v135, v135
    v_exp_f32 v136, v136
    v_exp_f32 v137, v137
    v_smfmac_f32_32x32x32_bf16 v[192:207], v[244:247], v[128:135], v2
    s_waitcnt lgkmcnt(1)
    v_exp_f32 v138, v138
    v_exp_f32 v139, v139
    v_exp_f32 v140, v140
    v_exp_f32 v141, v141
    v_exp_f32 v142, v142
    v_exp_f32 v143, v143
    v_exp_f32 v144, v144
    v_exp_f32 v145, v145
    v_smfmac_f32_32x32x32_bf16 v[192:207], v[252:255], v[136:143], v2
    ds_read_b128 v[236:239], v3 offset:6336
    v_exp_f32 v146, v146
    v_exp_f32 v147, v147
    v_mfma_f32_32x32x16_bf16 v[128:143], v[232:235], v[224:227], v[160:175]
    v_exp_f32 v148, v148
    v_exp_f32 v149, v149
    v_exp_f32 v150, v150
    v_exp_f32 v151, v151
    v_exp_f32 v152, v152
    v_exp_f32 v153, v153
    v_smfmac_f32_32x32x32_bf16 v[208:223], v[244:247], v[144:151], v2
    ds_read_b128 v[244:247], v4 offset:6336
    v_exp_f32 v154, v154
    v_exp_f32 v155, v155
    v_exp_f32 v156, v156
    v_exp_f32 v157, v157
    v_exp_f32 v158, v158
    v_exp_f32 v159, v159
    v_exp_f32 v128, v128
    v_exp_f32 v129, v129
    v_smfmac_f32_32x32x32_bf16 v[208:223], v[252:255], v[152:159], v2
    ds_read_b128 v[252:255], v4 offset:6880
    v_exp_f32 v130, v130
    v_exp_f32 v131, v131
    v_mfma_f32_32x32x16_bf16 v[144:159], v[232:235], v[228:231], v[176:191]
    v_exp_f32 v132, v132
    v_exp_f32 v133, v133
    v_exp_f32 v134, v134
    v_exp_f32 v135, v135
    v_exp_f32 v136, v136
    v_exp_f32 v137, v137
    v_smfmac_f32_32x32x32_bf16 v[192:207], v[240:243], v[128:135], v2
    s_waitcnt lgkmcnt(1)
    v_exp_f32 v138, v138
    v_exp_f32 v139, v139
    v_exp_f32 v140, v140
    v_exp_f32 v141, v141
    v_exp_f32 v142, v142
    v_exp_f32 v143, v143
    v_exp_f32 v144, v144
    v_exp_f32 v145, v145
    v_smfmac_f32_32x32x32_bf16 v[192:207], v[248:251], v[136:143], v2
    ds_read_b128 v[232:235], v3 offset:8448
    v_exp_f32 v146, v146
    v_exp_f32 v147, v147
    v_mfma_f32_32x32x16_bf16 v[128:143], v[236:239], v[224:227], v[160:175]
    v_exp_f32 v148, v148
    v_exp_f32 v149, v149
    v_exp_f32 v150, v150
    v_exp_f32 v151, v151
    v_exp_f32 v152, v152
    v_exp_f32 v153, v153
    v_smfmac_f32_32x32x32_bf16 v[208:223], v[240:243], v[144:151], v2
    ds_read_b128 v[240:243], v4 offset:8448
    v_exp_f32 v154, v154
    v_exp_f32 v155, v155
    v_exp_f32 v156, v156
    v_exp_f32 v157, v157
    v_exp_f32 v158, v158
    v_exp_f32 v159, v159
    v_exp_f32 v128, v128
    v_exp_f32 v129, v129
    v_smfmac_f32_32x32x32_bf16 v[208:223], v[248:251], v[152:159], v2
    ds_read_b128 v[248:251], v4 offset:8992
    v_exp_f32 v130, v130
    v_exp_f32 v131, v131
    v_mfma_f32_32x32x16_bf16 v[144:159], v[236:239], v[228:231], v[176:191]
    v_exp_f32 v132, v132
    v_exp_f32 v133, v133
    v_exp_f32 v134, v134
    v_exp_f32 v135, v135
    v_exp_f32 v136, v136
    v_exp_f32 v137, v137
    v_smfmac_f32_32x32x32_bf16 v[192:207], v[244:247], v[128:135], v2
    s_waitcnt lgkmcnt(1)
    v_exp_f32 v138, v138
    v_exp_f32 v139, v139
    v_exp_f32 v140, v140
    v_exp_f32 v141, v141
    v_exp_f32 v142, v142
    v_exp_f32 v143, v143
    v_exp_f32 v144, v144
    v_exp_f32 v145, v145
    v_smfmac_f32_32x32x32_bf16 v[192:207], v[252:255], v[136:143], v2
    ds_read_b128 v[236:239], v3 offset:10560
    v_exp_f32 v146, v146
    v_exp_f32 v147, v147
    v_mfma_f32_32x32x16_bf16 v[128:143], v[232:235], v[224:227], v[160:175]
    v_exp_f32 v148, v148
    v_exp_f32 v149, v149
    v_exp_f32 v150, v150
    v_exp_f32 v151, v151
    v_exp_f32 v152, v152
    v_exp_f32 v153, v153
    v_smfmac_f32_32x32x32_bf16 v[208:223], v[244:247], v[144:151], v2
    ds_read_b128 v[244:247], v4 offset:10560
    v_exp_f32 v154, v154
    v_exp_f32 v155, v155
    v_exp_f32 v156, v156
    v_exp_f32 v157, v157
    v_exp_f32 v158, v158
    v_exp_f32 v159, v159
    v_exp_f32 v128, v128
    v_exp_f32 v129, v129
    v_smfmac_f32_32x32x32_bf16 v[208:223], v[252:255], v[152:159], v2
    ds_read_b128 v[252:255], v4 offset:11104
    v_exp_f32 v130, v130
    v_exp_f32 v131, v131
    v_mfma_f32_32x32x16_bf16 v[144:159], v[232:235], v[228:231], v[176:191]
    v_exp_f32 v132, v132
    v_exp_f32 v133, v133
    v_exp_f32 v134, v134
    v_exp_f32 v135, v135
    v_exp_f32 v136, v136
    v_exp_f32 v137, v137
    v_smfmac_f32_32x32x32_bf16 v[192:207], v[240:243], v[128:135], v2
    s_waitcnt lgkmcnt(1)
    v_exp_f32 v138, v138
    v_exp_f32 v139, v139
    v_exp_f32 v140, v140
    v_exp_f32 v141, v141
    v_exp_f32 v142, v142
    v_exp_f32 v143, v143
    v_exp_f32 v144, v144
    v_exp_f32 v145, v145
    v_smfmac_f32_32x32x32_bf16 v[192:207], v[248:251], v[136:143], v2
    ds_read_b128 v[232:235], v3 offset:12672
    v_exp_f32 v146, v146
    v_exp_f32 v147, v147
    v_mfma_f32_32x32x16_bf16 v[128:143], v[236:239], v[224:227], v[160:175]
    v_exp_f32 v148, v148
    v_exp_f32 v149, v149
    v_exp_f32 v150, v150
    v_exp_f32 v151, v151
    v_exp_f32 v152, v152
    v_exp_f32 v153, v153
    v_smfmac_f32_32x32x32_bf16 v[208:223], v[240:243], v[144:151], v2
    ds_read_b128 v[240:243], v4 offset:12672
    v_exp_f32 v154, v154
    v_exp_f32 v155, v155
    v_exp_f32 v156, v156
    v_exp_f32 v157, v157
    v_exp_f32 v158, v158
    v_exp_f32 v159, v159
    v_exp_f32 v128, v128
    v_exp_f32 v129, v129
    v_smfmac_f32_32x32x32_bf16 v[208:223], v[248:251], v[152:159], v2
    ds_read_b128 v[248:251], v4 offset:13216
    v_exp_f32 v130, v130
    v_exp_f32 v131, v131
    v_mfma_f32_32x32x16_bf16 v[144:159], v[236:239], v[228:231], v[176:191]
    v_exp_f32 v132, v132
    v_exp_f32 v133, v133
    v_exp_f32 v134, v134
    v_exp_f32 v135, v135
    v_exp_f32 v136, v136
    v_exp_f32 v137, v137
    v_smfmac_f32_32x32x32_bf16 v[192:207], v[244:247], v[128:135], v2
    s_waitcnt lgkmcnt(1)
    v_exp_f32 v138, v138
    v_exp_f32 v139, v139
    v_exp_f32 v140, v140
    v_exp_f32 v141, v141
    v_exp_f32 v142, v142
    v_exp_f32 v143, v143
    v_exp_f32 v144, v144
    v_exp_f32 v145, v145
    v_smfmac_f32_32x32x32_bf16 v[192:207], v[252:255], v[136:143], v2
    ds_read_b128 v[236:239], v3 offset:14784
    v_exp_f32 v146, v146
    v_exp_f32 v147, v147
    v_mfma_f32_32x32x16_bf16 v[128:143], v[232:235], v[224:227], v[160:175]
    v_exp_f32 v148, v148
    v_exp_f32 v149, v149
    v_exp_f32 v150, v150
    v_exp_f32 v151, v151
    v_exp_f32 v152, v152
    v_exp_f32 v153, v153
    v_smfmac_f32_32x32x32_bf16 v[208:223], v[244:247], v[144:151], v2
    ds_read_b128 v[244:247], v4 offset:14784
    v_exp_f32 v154, v154
    v_exp_f32 v155, v155
    v_exp_f32 v156, v156
    v_exp_f32 v157, v157
    v_exp_f32 v158, v158
    v_exp_f32 v159, v159
    v_exp_f32 v128, v128
    v_exp_f32 v129, v129
    v_smfmac_f32_32x32x32_bf16 v[208:223], v[252:255], v[152:159], v2
    ds_read_b128 v[252:255], v4 offset:15328
    v_exp_f32 v130, v130
    v_exp_f32 v131, v131
    v_mfma_f32_32x32x16_bf16 v[144:159], v[232:235], v[228:231], v[176:191]
    v_exp_f32 v132, v132
    v_exp_f32 v133, v133
    v_exp_f32 v134, v134
    v_exp_f32 v135, v135
    v_exp_f32 v136, v136
    v_exp_f32 v137, v137
    v_smfmac_f32_32x32x32_bf16 v[192:207], v[240:243], v[128:135], v2
    s_waitcnt lgkmcnt(1)
    v_exp_f32 v138, v138
    v_exp_f32 v139, v139
    v_exp_f32 v140, v140
    v_exp_f32 v141, v141
    v_exp_f32 v142, v142
    v_exp_f32 v143, v143
    v_exp_f32 v144, v144
    v_exp_f32 v145, v145
    v_smfmac_f32_32x32x32_bf16 v[192:207], v[248:251], v[136:143], v2
    ds_read_b128 v[232:235], v3 offset:16896
    v_exp_f32 v146, v146
    v_exp_f32 v147, v147
    v_mfma_f32_32x32x16_bf16 v[128:143], v[236:239], v[224:227], v[160:175]
    v_exp_f32 v148, v148
    v_exp_f32 v149, v149
    v_exp_f32 v150, v150
    v_exp_f32 v151, v151
    v_exp_f32 v152, v152
    v_exp_f32 v153, v153
    v_smfmac_f32_32x32x32_bf16 v[208:223], v[240:243], v[144:151], v2
    ds_read_b128 v[240:243], v4 offset:16896
    v_exp_f32 v154, v154
    v_exp_f32 v155, v155
    v_exp_f32 v156, v156
    v_exp_f32 v157, v157
    v_exp_f32 v158, v158
    v_exp_f32 v159, v159
    v_exp_f32 v128, v128
    v_exp_f32 v129, v129
    v_smfmac_f32_32x32x32_bf16 v[208:223], v[248:251], v[152:159], v2
    ds_read_b32 v17, v14 offset:4
    ds_read_b128 v[248:251], v4 offset:17440
    v_exp_f32 v130, v130
    v_exp_f32 v131, v131
    v_mfma_f32_32x32x16_bf16 v[144:159], v[236:239], v[228:231], v[176:191]
    s_and_b32 s56, s55, 255
    v_exp_f32 v132, v132
    v_exp_f32 v133, v133
    v_exp_f32 v134, v134
    v_exp_f32 v135, v135
    v_exp_f32 v136, v136
    v_exp_f32 v137, v137
    v_smfmac_f32_32x32x32_bf16 v[192:207], v[244:247], v[128:135], v2
    s_waitcnt lgkmcnt(1)
    s_sub_u32 s53, s53, 1
    v_readfirstlane_b32 s63, v17
    v_exp_f32 v138, v138
    v_exp_f32 v139, v139
    v_exp_f32 v140, v140
    v_exp_f32 v141, v141
    v_exp_f32 v142, v142
    v_exp_f32 v143, v143
    v_exp_f32 v144, v144
    v_exp_f32 v145, v145
    v_smfmac_f32_32x32x32_bf16 v[192:207], v[252:255], v[136:143], v2
    s_lshr_b32 s55, s55, 8
    s_cmp_lt_u32 s63, s56
    ds_read_b128 v[236:239], v3 offset:19008
    v_exp_f32 v146, v146
    v_exp_f32 v147, v147
    v_mfma_f32_32x32x16_bf16 v[128:143], v[232:235], v[224:227], v[160:175]
    s_cbranch_scc1 L_kvspin_6
L_kvback_7:
    v_exp_f32 v148, v148
    v_exp_f32 v149, v149
    v_exp_f32 v150, v150
    v_exp_f32 v151, v151
    v_exp_f32 v152, v152
    v_exp_f32 v153, v153
    v_smfmac_f32_32x32x32_bf16 v[208:223], v[244:247], v[144:151], v2
    s_cmp_lg_u32 s53, 0
    ds_read_b128 v[244:247], v4 offset:19008
    v_add_u32 v3, 16896, v3
    v_add_u32 v4, 16896, v4
    v_exp_f32 v154, v154
    v_exp_f32 v155, v155
    v_exp_f32 v156, v156
    v_exp_f32 v157, v157
    v_exp_f32 v158, v158
    v_exp_f32 v159, v159
    v_exp_f32 v128, v128
    v_exp_f32 v129, v129
    v_smfmac_f32_32x32x32_bf16 v[208:223], v[252:255], v[152:159], v2
    s_cbranch_scc1 L_loop
    s_add_u32 s60, s49, 2097152
    v_rcp_f32 v8, v200
    s_mov_b32 s54, 0x49800000
    v_mul_f32 v160, v8, v192
    v_mul_f32 v161, v8, v193
    v_mul_f32 v162, v8, v194
    v_mul_f32 v163, v8, v195
    v_mul_f32 v164, v8, v196
    v_mul_f32 v165, v8, v197
    v_mul_f32 v166, v8, v198
    v_mul_f32 v167, v8, v199
    v_maximum3_f32 v12, abs(v192), abs(v193), abs(v194)
    v_maximum3_f32 v12, v12, abs(v195), abs(v196)
    v_maximum3_f32 v12, v12, abs(v197), abs(v198)
    v_maximum3_f32 v12, v12, abs(v199), abs(v199)
    v_rcp_f32 v10, v216
    v_max_f32 v9, v200, v216
    v_pk_mul_f32 v[168:169], v[208:209], v[10:11] op_sel_hi:[1,0]
    v_pk_mul_f32 v[170:171], v[210:211], v[10:11] op_sel_hi:[1,0]
    v_pk_mul_f32 v[172:173], v[212:213], v[10:11] op_sel_hi:[1,0]
    v_pk_mul_f32 v[174:175], v[214:215], v[10:11] op_sel_hi:[1,0]
    s_movk_i32 s55, 0x203
    v_cvt_pk_bf16_f32 v176, v160, v161
    v_maximum3_f32 v13, abs(v208), abs(v209), abs(v210)
    v_cvt_pk_bf16_f32 v177, v162, v163
    v_maximum3_f32 v13, v13, abs(v211), abs(v212)
    v_cvt_pk_bf16_f32 v178, v164, v165
    v_maximum3_f32 v13, v13, abs(v213), abs(v214)
    v_cvt_pk_bf16_f32 v179, v166, v167
    v_maximum3_f32 v13, v13, abs(v215), abs(v215)
    v_cvt_pk_bf16_f32 v180, v168, v169
    v_mul_f32 v9, s54, v9
    v_cvt_pk_bf16_f32 v181, v170, v171
    v_minimum3_f32 v8, v12, v13, v13
    v_cvt_pk_bf16_f32 v182, v172, v173
    v_maximum3_f32 v9, v9, v12, v13
    v_cvt_pk_bf16_f32 v183, v174, v175
    v_cmp_nle_f32 vcc, 0x6800000, v8
    v_cmp_class_f32 s[62:63], v9, s55
    v_min_u32 v176, -2, v176
    v_min_u32 v180, -2, v180
    s_nop 1
    s_or_b64 vcc, vcc, s[62:63]
    s_cmp_eq_u32 s52, 2
    s_cbranch_scc1 L_pub
    s_cbranch_vccnz L_fallback
L_pub:
    buffer_store_dwordx4 v[176:179], v6, s[40:43], s60 offen sc1
    buffer_store_dwordx4 v[180:183], v6, s[40:43], s60 offen offset:1024 sc1
    s_mov_b64 exec, 1
    ds_add_u32 v14, v1 offset:8
    s_mov_b64 exec, -1
    s_waitcnt vmcnt(0)
    s_mov_b64 exec, 1
    ds_add_u32 v14, v1 offset:0
    s_mov_b64 exec, -1
    s_endpgm
L_slow:
    s_waitcnt vmcnt(0)
    s_mov_b32 s53, 0
    s_barrier
    s_barrier
    s_mov_b32 s62, 131072
L_poll_5001:
    buffer_load_dwordx4 v[44:47], v12, s[40:43], s66 offen sc1
    s_waitcnt vmcnt(0)
    v_xor_b32 v44, s4, v44
    v_xor_b32 v45, s4, v45
    v_xor_b32 v46, s4, v46
    v_xor_b32 v47, s4, v47
    v_or3_b32 v44, v44, v45, v46
    v_or_b32 v44, v44, v47
    v_cmp_ne_u32 vcc, 0, v44
    s_sub_u32 s62, s62, 1
    s_cmp_lg_u32 s62, 0
    s_nop 2
    s_cbranch_vccz L_polled_5002
    s_sleep 4
    s_cbranch_scc1 L_poll_5001
L_polled_5002:
    buffer_load_dwordx4 v[232:235], v6, s[40:43], s67 offen offset:0 sc1
    buffer_load_dwordx4 v[236:239], v6, s[40:43], s67 offen offset:2112 sc1
    buffer_load_dword v10, v7, s[40:43], s65 offen sc1
    s_mov_b32 m0, s64
    s_add_u32 s61, s64, 4194304
    buffer_load_dwordx4 v6, s[40:43], s61 offen offset:0 sc1 lds
    buffer_load_dwordx4 v6, s[40:43], s61 offen offset:1024 sc1 lds
    buffer_load_dwordx4 v6, s[40:43], s61 offen offset:2048 sc1 lds
    buffer_load_dwordx4 v6, s[40:43], s61 offen offset:3072 sc1 lds
    s_add_u32 s64, s64, 4096
    s_branch L_slow3
L_slow2:
    s_mov_b32 s53, 0
    s_waitcnt vmcnt(2)
    s_barrier
    buffer_load_dword v10, v7, s[40:43], s65 offen sc1
    s_mov_b32 m0, s64
    s_add_u32 s61, s64, 4194304
    buffer_load_dwordx4 v6, s[40:43], s61 offen offset:0 sc1 lds
    buffer_load_dwordx4 v6, s[40:43], s61 offen offset:1024 sc1 lds
    buffer_load_dwordx4 v6, s[40:43], s61 offen offset:2048 sc1 lds
    buffer_load_dwordx4 v6, s[40:43], s61 offen offset:3072 sc1 lds
    s_add_u32 s64, s64, 4096
    s_barrier
L_slow3:
    s_waitcnt vmcnt(4)
    v_cmp_ne_u32 vcc, s4, v10
    s_nop 4
    s_cbranch_vccz L_slow4
    s_mov_b32 s62, 131072
L_poll_5003:
    buffer_load_dword v10, v7, s[40:43], s65 offen sc1
    s_waitcnt vmcnt(0)
    v_cmp_ne_u32 vcc, s4, v10
    s_sub_u32 s62, s62, 1
    s_cmp_lg_u32 s62, 0
    s_nop 2
    s_cbranch_vccz L_polled_5004
    s_sleep 1
    s_cbranch_scc1 L_poll_5003
L_polled_5004:
L_slow4:
    buffer_load_dwordx4 v[224:227], v6, s[40:43], s49 offen sc1
    buffer_load_dwordx4 v[228:231], v6, s[40:43], s49 offen offset:1024 sc1
    s_mov_b32 m0, s64
    s_add_u32 s61, s64, 4194304
    buffer_load_dwordx4 v6, s[40:43], s61 offen offset:0 sc1 lds
    buffer_load_dwordx4 v6, s[40:43], s61 offen offset:1024 sc1 lds
    buffer_load_dwordx4 v6, s[40:43], s61 offen offset:2048 sc1 lds
    buffer_load_dwordx4 v6, s[40:43], s61 offen offset:3072 sc1 lds
    s_add_u32 s64, s64, 4096
    s_mov_b32 m0, s64
    s_add_u32 s61, s64, 4194304
    buffer_load_dwordx4 v6, s[40:43], s61 offen offset:0 sc1 lds
    buffer_load_dwordx4 v6, s[40:43], s61 offen offset:1024 sc1 lds
    s_waitcnt vmcnt(6)
    s_branch L_xgo
L_kvspin_6:
    s_mov_b32 s62, 1048576
L_lw_8:
    ds_read_b32 v15, v14 offset:4
    s_waitcnt lgkmcnt(0)
    v_readfirstlane_b32 s63, v15
    s_sub_u32 s62, s62, 1
    s_nop 2
    s_cmp_ge_u32 s63, s56
    s_cbranch_scc1 L_lwd_9
    s_cmp_lg_u32 s62, 0
    s_cbranch_scc1 L_lw_8
L_lwd_9:
    s_branch L_kvback_7
L_fallback:
    s_waitcnt lgkmcnt(0)
    s_mov_b32 s52, 2
    s_mov_b32 s54, 0
    s_mov_b32 s53, 64
    v_mov_b32 v3, v6
    v_mov_b32 v8, 0xff800000
    v_mov_b32 v9, 0xff800000
    v_mov_b64 v[192:193], 0
    v_mov_b64 v[194:195], 0
    v_mov_b64 v[196:197], 0
    v_mov_b64 v[198:199], 0
    v_mov_b64 v[200:201], 0
    v_mov_b64 v[202:203], 0
    v_mov_b64 v[204:205], 0
    v_mov_b64 v[206:207], 0
    v_mov_b64 v[208:209], 0
    v_mov_b64 v[210:211], 0
    v_mov_b64 v[212:213], 0
    v_mov_b64 v[214:215], 0
    v_mov_b64 v[216:217], 0
    v_mov_b64 v[218:219], 0
    v_mov_b64 v[220:221], 0
    v_mov_b64 v[222:223], 0
L_mx:
    ds_read_b128 v[232:235], v3
    v_add_u32 v3, 2112, v3
    s_waitcnt lgkmcnt(0)
    v_mfma_f32_32x32x16_bf16 v[128:143], v[232:235], v[224:227], 0
    v_mfma_f32_32x32x16_bf16 v[144:159], v[232:235], v[228:231], 0
    s_nop 11
    v_max3_f32 v8, v8, v128, v129
    v_max3_f32 v8, v8, v130, v131
    v_max3_f32 v8, v8, v132, v133
    v_max3_f32 v8, v8, v134, v135
    v_max3_f32 v8, v8, v136, v137
    v_max3_f32 v8, v8, v138, v139
    v_max3_f32 v8, v8, v140, v141
    v_max3_f32 v8, v8, v142, v143
    v_max3_f32 v9, v9, v144, v145
    v_max3_f32 v9, v9, v146, v147
    v_max3_f32 v9, v9, v148, v149
    v_max3_f32 v9, v9, v150, v151
    v_max3_f32 v9, v9, v152, v153
    v_max3_f32 v9, v9, v154, v155
    v_max3_f32 v9, v9, v156, v157
    v_max3_f32 v9, v9, v158, v159
    s_sub_u32 s53, s53, 1
    s_cmp_lg_u32 s53, 0
    s_cbranch_scc1 L_mx
    ds_read_b128 v[232:235], v6
    s_waitcnt lgkmcnt(0)
    s_branch L_setmax
L_done:
    s_endpgm
.p2align 12
L_c:
    s_mov_b32 s8, s28
    s_mov_b32 s9, s29
    s_mov_b32 s10, 0x100
    s_mov_b32 s11, 0x00020000
    s_or_b32 s60, s2, s48
    s_cmp_lg_u32 s60, 0
    s_cbranch_scc1 L_nononce
    s_memrealtime s[62:63]
    s_waitcnt lgkmcnt(0)
    s_mul_i32 s62, s62, 0x9e3779b1
    s_or_b32 s62, s62, 1
    v_mov_b32 v16, s62
    s_mov_b64 exec, 1
    buffer_store_dword v16, v13, s[8:11], 0 offen sc1
    s_mov_b64 exec, -1
L_nononce:
    s_bitcmp1_b32 s5, 1
    s_cselect_b32 s36, s14, s12
    s_cselect_b32 s37, s15, s13
    s_lshl_b32 s38, s78, 14
    s_mov_b32 s39, 0x00020000
    s_lshl_b32 s60, s48, 12
    s_add_u32 s61, s60, 147456
    s_lshl_b32 s62, s96, 11
    s_add_u32 s60, s60, s62
    s_add_u32 m0, s61, 0
    s_and_b32 s60, s60, 16383
    buffer_load_dwordx4 v6, s[36:39], s60 offen lds
    s_add_u32 s60, s60, 1024
    s_add_u32 m0, s61, 1024
    s_and_b32 s60, s60, 16383
    buffer_load_dwordx4 v6, s[36:39], s60 offen lds
    s_add_u32 s60, s60, 1024
    s_add_u32 m0, s61, 2048
    s_and_b32 s60, s60, 16383
    buffer_load_dwordx4 v6, s[36:39], s60 offen lds
    s_add_u32 s60, s60, 1024
    s_add_u32 m0, s61, 3072
    s_and_b32 s60, s60, 16383
    buffer_load_dwordx4 v6, s[36:39], s60 offen lds
    s_add_u32 s60, s60, 1024
    v_and_b32 v26, 15, v0
    v_lshrrev_b32 v27, 4, v0
    v_bfe_u32 v22, v0, 1, 3
    v_xor_b32 v22, v22, v27
    v_lshlrev_b32 v22, 4, v22
    v_lshl_add_u32 v244, v26, 7, v22
    v_xor_b32 v245, 64, v244
    v_bfe_u32 v20, v0, 3, 2
    s_lshl_b32 s60, s50, 1
    v_xor_b32 v20, s60, v20
    v_lshlrev_b32 v20, 5, v20
    v_bfe_u32 v23, v0, 2, 2
    v_lshl_add_u32 v20, v23, 7, v20
    v_and_b32 v23, 3, v0
    v_lshl_add_u32 v20, v23, 3, v20
    v_lshl_add_u32 v20, v27, 10, v20
    s_lshl_b32 s60, s51, 12
    v_add_u32 v20, s60, v20
    v_xor_b32 v21, 32, v20
    v_add_u32 v240, 65536, v20
    v_add_u32 v241, 65536, v21
    v_add_u32 v242, 114688, v20
    v_add_u32 v243, 114688, v21
    v_mov_b32 v25, 0
    s_bfe_u32 s52, s5, 0x10001
    s_add_u32 s52, s52, 1
    s_cmp_gt_u32 s78, s51
    s_cselect_b32 s52, s52, 0
    s_cbranch_scc0 L_nokvset
    s_and_b32 s62, s5, 1
    s_lshl1_add_u32 s60, s62, s50
    s_lshl_b32 s60, s60, 11
    v_add_u32 v20, s60, v244
    v_xor_b32 v21, 64, v20
    v_lshlrev_b32 v24, 3, v26
    v_lshl_add_u32 v24, v27, 8, v24
    v_add_u32 v24, 147456, v24
    s_lshl1_add_u32 s64, s6, s62
    s_mul_i32 s64, s64, 2112
    s_add_u32 s64, s64, 4194304
    s_lshl_b32 s65, s6, 7
    s_lshl3_add_u32 s65, s5, s65
    s_lshl2_add_u32 s65, s50, s65
    s_add_u32 s65, s65, 4784128
    v_lshlrev_b32 v25, 4, v26
    v_and_b32 v28, 1, v27
    v_lshrrev_b32 v29, 1, v27
    v_lshl_add_u32 v30, v28, 9, v25
    v_lshl_add_u32 v30, v29, 3, v30
    v_lshl_add_u32 v25, v29, 8, v25
    v_lshl_add_u32 v25, v28, 3, v25
    s_mul_i32 s62, s50, 544
    s_add_u32 s62, s62, 1024
    s_lshl_b32 s63, s50, 8
    s_cmp_eq_u32 s52, 2
    s_cselect_b64 vcc, -1, 0
    s_cselect_b32 s62, s62, s63
    s_add_u32 s64, s64, s62
    v_cndmask_b32 v25, v30, v25, vcc
L_nokvset:
    s_mov_b64 exec, 0
    s_cmp_eq_u32 s48, 0
    s_cbranch_scc1 L_pad_ck
    s_cmp_eq_u32 s48, 1
    s_cbranch_scc1 L_pad_cv
    s_cmp_eq_u32 s48, 2
    s_cbranch_scc1 L_pad_x968
    s_cmp_eq_u32 s48, 3
    s_cbranch_scc1 L_pad_p1q
    s_branch L_warmed_c
L_ret_ck:
    s_branch L_warmed_c
L_ret_cv:
    s_branch L_warmed_c
L_ret_x968:
    s_branch L_warmed_c
L_ret_p1q:
    s_branch L_warmed_c
L_warmed_c:
    s_mov_b64 exec, -1
    s_waitcnt vmcnt(11)
    v_dot2c_f32_bf16 v8, s75, v64
    v_dot2c_f32_bf16 v9, v64, v64
    v_dot2c_f32_bf16 v8, s75, v65
    v_dot2c_f32_bf16 v9, v65, v65
    v_dot2c_f32_bf16 v8, s75, v66
    v_dot2c_f32_bf16 v9, v66, v66
    v_dot2c_f32_bf16 v8, s75, v67
    v_dot2c_f32_bf16 v9, v67, v67
    s_waitcnt vmcnt(10)
    v_dot2c_f32_bf16 v8, s75, v68
    v_dot2c_f32_bf16 v9, v68, v68
    v_dot2c_f32_bf16 v8, s75, v69
    v_dot2c_f32_bf16 v9, v69, v69
    v_dot2c_f32_bf16 v8, s75, v70
    v_dot2c_f32_bf16 v9, v70, v70
    v_dot2c_f32_bf16 v8, s75, v71
    v_dot2c_f32_bf16 v9, v71, v71
    s_waitcnt vmcnt(9)
    v_dot2c_f32_bf16 v8, s75, v72
    v_dot2c_f32_bf16 v9, v72, v72
    v_dot2c_f32_bf16 v8, s75, v73
    v_dot2c_f32_bf16 v9, v73, v73
    v_dot2c_f32_bf16 v8, s75, v74
    v_dot2c_f32_bf16 v9, v74, v74
    v_dot2c_f32_bf16 v8, s75, v75
    v_dot2c_f32_bf16 v9, v75, v75
    s_waitcnt vmcnt(8)
    v_dot2c_f32_bf16 v8, s75, v76
    v_dot2c_f32_bf16 v9, v76, v76
    v_dot2c_f32_bf16 v8, s75, v77
    v_dot2c_f32_bf16 v9, v77, v77
    v_dot2c_f32_bf16 v8, s75, v78
    v_dot2c_f32_bf16 v9, v78, v78
    v_dot2c_f32_bf16 v8, s75, v79
    v_dot2c_f32_bf16 v9, v79, v79
    s_waitcnt vmcnt(7)
    v_dot2c_f32_bf16 v8, s75, v80
    v_dot2c_f32_bf16 v9, v80, v80
    v_dot2c_f32_bf16 v8, s75, v81
    v_dot2c_f32_bf16 v9, v81, v81
    v_dot2c_f32_bf16 v8, s75, v82
    v_dot2c_f32_bf16 v9, v82, v82
    v_dot2c_f32_bf16 v8, s75, v83
    v_dot2c_f32_bf16 v9, v83, v83
    s_waitcnt vmcnt(6)
    v_dot2c_f32_bf16 v8, s75, v84
    v_dot2c_f32_bf16 v9, v84, v84
    v_dot2c_f32_bf16 v8, s75, v85
    v_dot2c_f32_bf16 v9, v85, v85
    v_dot2c_f32_bf16 v8, s75, v86
    v_dot2c_f32_bf16 v9, v86, v86
    v_dot2c_f32_bf16 v8, s75, v87
    v_dot2c_f32_bf16 v9, v87, v87
    s_waitcnt vmcnt(5)
    v_dot2c_f32_bf16 v8, s75, v88
    v_dot2c_f32_bf16 v9, v88, v88
    v_dot2c_f32_bf16 v8, s75, v89
    v_dot2c_f32_bf16 v9, v89, v89
    v_dot2c_f32_bf16 v8, s75, v90
    v_dot2c_f32_bf16 v9, v90, v90
    v_dot2c_f32_bf16 v8, s75, v91
    v_dot2c_f32_bf16 v9, v91, v91
    s_waitcnt vmcnt(4)
    v_dot2c_f32_bf16 v8, s75, v92
    v_dot2c_f32_bf16 v9, v92, v92
    v_dot2c_f32_bf16 v8, s75, v93
    v_dot2c_f32_bf16 v9, v93, v93
    v_dot2c_f32_bf16 v8, s75, v94
    v_dot2c_f32_bf16 v9, v94, v94
    v_dot2c_f32_bf16 v8, s75, v95
    v_dot2c_f32_bf16 v9, v95, v95
    s_nop 2
    v_add_f32_dpp v8, v8, v8 quad_perm:[1,0,3,2] row_mask:0xf bank_mask:0xf
    v_add_f32_dpp v9, v9, v9 quad_perm:[1,0,3,2] row_mask:0xf bank_mask:0xf
    s_nop 0
    v_add_f32_dpp v8, v8, v8 quad_perm:[2,3,0,1] row_mask:0xf bank_mask:0xf
    v_add_f32_dpp v9, v9, v9 quad_perm:[2,3,0,1] row_mask:0xf bank_mask:0xf
    s_nop 0
    v_add_f32_dpp v8, v8, v8 row_half_mirror row_mask:0xf bank_mask:0xf
    v_add_f32_dpp v9, v9, v9 row_half_mirror row_mask:0xf bank_mask:0xf
    s_nop 0
    v_mul_f32 v8, s76, v8
    v_mul_f32 v10, v8, v8
    v_fma_f32 v10, v9, s76, -v10
    v_max_f32 v10, 0, v10
    v_add_f32 v10, s77, v10
    v_rsq_f32 v16, v10
    s_nop 0
    v_mul_f32 v17, v8, v16
    v_lshlrev_b32 v32, 16, v64
    v_and_b32 v33, s59, v64
    v_lshlrev_b32 v34, 16, v65
    v_and_b32 v35, s59, v65
    v_lshlrev_b32 v36, 16, v66
    v_and_b32 v37, s59, v66
    v_lshlrev_b32 v38, 16, v67
    v_and_b32 v39, s59, v67
    v_pk_fma_f32 v[32:33], v[32:33], v[16:17], v[16:17] op_sel:[0,0,1] op_sel_hi:[1,0,1] neg_lo:[0,0,1] neg_hi:[0,0,1]
    v_pk_fma_f32 v[34:35], v[34:35], v[16:17], v[16:17] op_sel:[0,0,1] op_sel_hi:[1,0,1] neg_lo:[0,0,1] neg_hi:[0,0,1]
    v_pk_fma_f32 v[36:37], v[36:37], v[16:17], v[16:17] op_sel:[0,0,1] op_sel_hi:[1,0,1] neg_lo:[0,0,1] neg_hi:[0,0,1]
    v_pk_fma_f32 v[38:39], v[38:39], v[16:17], v[16:17] op_sel:[0,0,1] op_sel_hi:[1,0,1] neg_lo:[0,0,1] neg_hi:[0,0,1]
    v_cvt_pk_bf16_f32 v64, v32, v33
    v_cvt_pk_bf16_f32 v65, v34, v35
    v_cvt_pk_bf16_f32 v66, v36, v37
    v_cvt_pk_bf16_f32 v67, v38, v39
    ds_write_b128 v40, v[64:67]
    v_lshlrev_b32 v32, 16, v68
    v_and_b32 v33, s59, v68
    v_lshlrev_b32 v34, 16, v69
    v_and_b32 v35, s59, v69
    v_lshlrev_b32 v36, 16, v70
    v_and_b32 v37, s59, v70
    v_lshlrev_b32 v38, 16, v71
    v_and_b32 v39, s59, v71
    v_pk_fma_f32 v[32:33], v[32:33], v[16:17], v[16:17] op_sel:[0,0,1] op_sel_hi:[1,0,1] neg_lo:[0,0,1] neg_hi:[0,0,1]
    v_pk_fma_f32 v[34:35], v[34:35], v[16:17], v[16:17] op_sel:[0,0,1] op_sel_hi:[1,0,1] neg_lo:[0,0,1] neg_hi:[0,0,1]
    v_pk_fma_f32 v[36:37], v[36:37], v[16:17], v[16:17] op_sel:[0,0,1] op_sel_hi:[1,0,1] neg_lo:[0,0,1] neg_hi:[0,0,1]
    v_pk_fma_f32 v[38:39], v[38:39], v[16:17], v[16:17] op_sel:[0,0,1] op_sel_hi:[1,0,1] neg_lo:[0,0,1] neg_hi:[0,0,1]
    v_cvt_pk_bf16_f32 v68, v32, v33
    v_cvt_pk_bf16_f32 v69, v34, v35
    v_cvt_pk_bf16_f32 v70, v36, v37
    v_cvt_pk_bf16_f32 v71, v38, v39
    ds_write_b128 v41, v[68:71]
    v_lshlrev_b32 v32, 16, v72
    v_and_b32 v33, s59, v72
    v_lshlrev_b32 v34, 16, v73
    v_and_b32 v35, s59, v73
    v_lshlrev_b32 v36, 16, v74
    v_and_b32 v37, s59, v74
    v_lshlrev_b32 v38, 16, v75
    v_and_b32 v39, s59, v75
    v_pk_fma_f32 v[32:33], v[32:33], v[16:17], v[16:17] op_sel:[0,0,1] op_sel_hi:[1,0,1] neg_lo:[0,0,1] neg_hi:[0,0,1]
    v_pk_fma_f32 v[34:35], v[34:35], v[16:17], v[16:17] op_sel:[0,0,1] op_sel_hi:[1,0,1] neg_lo:[0,0,1] neg_hi:[0,0,1]
    v_pk_fma_f32 v[36:37], v[36:37], v[16:17], v[16:17] op_sel:[0,0,1] op_sel_hi:[1,0,1] neg_lo:[0,0,1] neg_hi:[0,0,1]
    v_pk_fma_f32 v[38:39], v[38:39], v[16:17], v[16:17] op_sel:[0,0,1] op_sel_hi:[1,0,1] neg_lo:[0,0,1] neg_hi:[0,0,1]
    v_cvt_pk_bf16_f32 v72, v32, v33
    v_cvt_pk_bf16_f32 v73, v34, v35
    v_cvt_pk_bf16_f32 v74, v36, v37
    v_cvt_pk_bf16_f32 v75, v38, v39
    ds_write_b128 v42, v[72:75]
    v_lshlrev_b32 v32, 16, v76
    v_and_b32 v33, s59, v76
    v_lshlrev_b32 v34, 16, v77
    v_and_b32 v35, s59, v77
    v_lshlrev_b32 v36, 16, v78
    v_and_b32 v37, s59, v78
    v_lshlrev_b32 v38, 16, v79
    v_and_b32 v39, s59, v79
    v_pk_fma_f32 v[32:33], v[32:33], v[16:17], v[16:17] op_sel:[0,0,1] op_sel_hi:[1,0,1] neg_lo:[0,0,1] neg_hi:[0,0,1]
    v_pk_fma_f32 v[34:35], v[34:35], v[16:17], v[16:17] op_sel:[0,0,1] op_sel_hi:[1,0,1] neg_lo:[0,0,1] neg_hi:[0,0,1]
    v_pk_fma_f32 v[36:37], v[36:37], v[16:17], v[16:17] op_sel:[0,0,1] op_sel_hi:[1,0,1] neg_lo:[0,0,1] neg_hi:[0,0,1]
    v_pk_fma_f32 v[38:39], v[38:39], v[16:17], v[16:17] op_sel:[0,0,1] op_sel_hi:[1,0,1] neg_lo:[0,0,1] neg_hi:[0,0,1]
    v_cvt_pk_bf16_f32 v76, v32, v33
    v_cvt_pk_bf16_f32 v77, v34, v35
    v_cvt_pk_bf16_f32 v78, v36, v37
    v_cvt_pk_bf16_f32 v79, v38, v39
    ds_write_b128 v43, v[76:79]
    v_lshlrev_b32 v32, 16, v80
    v_and_b32 v33, s59, v80
    v_lshlrev_b32 v34, 16, v81
    v_and_b32 v35, s59, v81
    v_lshlrev_b32 v36, 16, v82
    v_and_b32 v37, s59, v82
    v_lshlrev_b32 v38, 16, v83
    v_and_b32 v39, s59, v83
    v_pk_fma_f32 v[32:33], v[32:33], v[16:17], v[16:17] op_sel:[0,0,1] op_sel_hi:[1,0,1] neg_lo:[0,0,1] neg_hi:[0,0,1]
    v_pk_fma_f32 v[34:35], v[34:35], v[16:17], v[16:17] op_sel:[0,0,1] op_sel_hi:[1,0,1] neg_lo:[0,0,1] neg_hi:[0,0,1]
    v_pk_fma_f32 v[36:37], v[36:37], v[16:17], v[16:17] op_sel:[0,0,1] op_sel_hi:[1,0,1] neg_lo:[0,0,1] neg_hi:[0,0,1]
    v_pk_fma_f32 v[38:39], v[38:39], v[16:17], v[16:17] op_sel:[0,0,1] op_sel_hi:[1,0,1] neg_lo:[0,0,1] neg_hi:[0,0,1]
    v_cvt_pk_bf16_f32 v80, v32, v33
    v_cvt_pk_bf16_f32 v81, v34, v35
    v_cvt_pk_bf16_f32 v82, v36, v37
    v_cvt_pk_bf16_f32 v83, v38, v39
    ds_write_b128 v44, v[80:83]
    v_lshlrev_b32 v32, 16, v84
    v_and_b32 v33, s59, v84
    v_lshlrev_b32 v34, 16, v85
    v_and_b32 v35, s59, v85
    v_lshlrev_b32 v36, 16, v86
    v_and_b32 v37, s59, v86
    v_lshlrev_b32 v38, 16, v87
    v_and_b32 v39, s59, v87
    v_pk_fma_f32 v[32:33], v[32:33], v[16:17], v[16:17] op_sel:[0,0,1] op_sel_hi:[1,0,1] neg_lo:[0,0,1] neg_hi:[0,0,1]
    v_pk_fma_f32 v[34:35], v[34:35], v[16:17], v[16:17] op_sel:[0,0,1] op_sel_hi:[1,0,1] neg_lo:[0,0,1] neg_hi:[0,0,1]
    v_pk_fma_f32 v[36:37], v[36:37], v[16:17], v[16:17] op_sel:[0,0,1] op_sel_hi:[1,0,1] neg_lo:[0,0,1] neg_hi:[0,0,1]
    v_pk_fma_f32 v[38:39], v[38:39], v[16:17], v[16:17] op_sel:[0,0,1] op_sel_hi:[1,0,1] neg_lo:[0,0,1] neg_hi:[0,0,1]
    v_cvt_pk_bf16_f32 v84, v32, v33
    v_cvt_pk_bf16_f32 v85, v34, v35
    v_cvt_pk_bf16_f32 v86, v36, v37
    v_cvt_pk_bf16_f32 v87, v38, v39
    ds_write_b128 v45, v[84:87]
    v_lshlrev_b32 v32, 16, v88
    v_and_b32 v33, s59, v88
    v_lshlrev_b32 v34, 16, v89
    v_and_b32 v35, s59, v89
    v_lshlrev_b32 v36, 16, v90
    v_and_b32 v37, s59, v90
    v_lshlrev_b32 v38, 16, v91
    v_and_b32 v39, s59, v91
    v_pk_fma_f32 v[32:33], v[32:33], v[16:17], v[16:17] op_sel:[0,0,1] op_sel_hi:[1,0,1] neg_lo:[0,0,1] neg_hi:[0,0,1]
    v_pk_fma_f32 v[34:35], v[34:35], v[16:17], v[16:17] op_sel:[0,0,1] op_sel_hi:[1,0,1] neg_lo:[0,0,1] neg_hi:[0,0,1]
    v_pk_fma_f32 v[36:37], v[36:37], v[16:17], v[16:17] op_sel:[0,0,1] op_sel_hi:[1,0,1] neg_lo:[0,0,1] neg_hi:[0,0,1]
    v_pk_fma_f32 v[38:39], v[38:39], v[16:17], v[16:17] op_sel:[0,0,1] op_sel_hi:[1,0,1] neg_lo:[0,0,1] neg_hi:[0,0,1]
    v_cvt_pk_bf16_f32 v88, v32, v33
    v_cvt_pk_bf16_f32 v89, v34, v35
    v_cvt_pk_bf16_f32 v90, v36, v37
    v_cvt_pk_bf16_f32 v91, v38, v39
    ds_write_b128 v46, v[88:91]
    v_lshlrev_b32 v32, 16, v92
    v_and_b32 v33, s59, v92
    v_lshlrev_b32 v34, 16, v93
    v_and_b32 v35, s59, v93
    v_lshlrev_b32 v36, 16, v94
    v_and_b32 v37, s59, v94
    v_lshlrev_b32 v38, 16, v95
    v_and_b32 v39, s59, v95
    v_pk_fma_f32 v[32:33], v[32:33], v[16:17], v[16:17] op_sel:[0,0,1] op_sel_hi:[1,0,1] neg_lo:[0,0,1] neg_hi:[0,0,1]
    v_pk_fma_f32 v[34:35], v[34:35], v[16:17], v[16:17] op_sel:[0,0,1] op_sel_hi:[1,0,1] neg_lo:[0,0,1] neg_hi:[0,0,1]
    v_pk_fma_f32 v[36:37], v[36:37], v[16:17], v[16:17] op_sel:[0,0,1] op_sel_hi:[1,0,1] neg_lo:[0,0,1] neg_hi:[0,0,1]
    v_pk_fma_f32 v[38:39], v[38:39], v[16:17], v[16:17] op_sel:[0,0,1] op_sel_hi:[1,0,1] neg_lo:[0,0,1] neg_hi:[0,0,1]
    v_cvt_pk_bf16_f32 v92, v32, v33
    v_cvt_pk_bf16_f32 v93, v34, v35
    v_cvt_pk_bf16_f32 v94, v36, v37
    v_cvt_pk_bf16_f32 v95, v38, v39
    ds_write_b128 v47, v[92:95]
    s_setprio 1
    s_cmp_eq_u32 s52, 1
    s_waitcnt vmcnt(0) lgkmcnt(0)
    s_cbranch_scc1 L_ck
    s_cmp_eq_u32 s52, 2
    s_cbranch_scc1 L_cv
    s_barrier
    ds_read_b128 v[192:195], v244 offset:0
    ds_read_b64_tr_b16 v[208:209], v240 offset:0
    ds_read_b64_tr_b16 v[210:211], v240 offset:512
    ds_read_b64_tr_b16 v[212:213], v241 offset:0
    ds_read_b64_tr_b16 v[214:215], v241 offset:512
    ds_read_b64_tr_b16 v[216:217], v240 offset:8192
    ds_read_b64_tr_b16 v[218:219], v240 offset:8704
    ds_read_b64_tr_b16 v[220:221], v241 offset:8192
    ds_read_b64_tr_b16 v[222:223], v241 offset:8704
    ds_read_b128 v[196:199], v244 offset:2048
    ds_read_b128 v[200:203], v244 offset:4096
    ds_read_b128 v[204:207], v244 offset:6144
    s_waitcnt lgkmcnt(2)
    v_mfma_f32_16x16x32_bf16 v[64:67], v[208:211], v[192:195], 0
    s_barrier
    ds_read_b64_tr_b16 v[224:225], v240 offset:16384
    v_mfma_f32_16x16x32_bf16 v[68:71], v[212:215], v[192:195], 0
    ds_read_b64_tr_b16 v[226:227], v240 offset:16896
    v_mfma_f32_16x16x32_bf16 v[72:75], v[216:219], v[192:195], 0
    ds_read_b64_tr_b16 v[228:229], v241 offset:16384
    v_mfma_f32_16x16x32_bf16 v[76:79], v[220:223], v[192:195], 0
    ds_read_b128 v[192:195], v245 offset:0
    v_mfma_f32_16x16x32_bf16 v[80:83], v[208:211], v[196:199], 0
    ds_read_b64_tr_b16 v[230:231], v241 offset:16896
    v_mfma_f32_16x16x32_bf16 v[84:87], v[212:215], v[196:199], 0
    ds_read_b64_tr_b16 v[232:233], v240 offset:24576
    v_mfma_f32_16x16x32_bf16 v[88:91], v[216:219], v[196:199], 0
    ds_read_b64_tr_b16 v[234:235], v240 offset:25088
    v_mfma_f32_16x16x32_bf16 v[92:95], v[220:223], v[196:199], 0
    s_waitcnt lgkmcnt(7)
    ds_read_b128 v[196:199], v245 offset:2048
    v_mfma_f32_16x16x32_bf16 v[96:99], v[208:211], v[200:203], 0
    ds_read_b64_tr_b16 v[236:237], v241 offset:24576
    v_mfma_f32_16x16x32_bf16 v[100:103], v[212:215], v[200:203], 0
    ds_read_b64_tr_b16 v[238:239], v241 offset:25088
    v_mfma_f32_16x16x32_bf16 v[104:107], v[216:219], v[200:203], 0
    v_mfma_f32_16x16x32_bf16 v[108:111], v[220:223], v[200:203], 0
    ds_read_b128 v[200:203], v245 offset:4096
    v_mfma_f32_16x16x32_bf16 v[112:115], v[208:211], v[204:207], 0
    v_mfma_f32_16x16x32_bf16 v[116:119], v[212:215], v[204:207], 0
    buffer_load_dword v15, v13, s[8:11], 0 offen sc1
    v_mfma_f32_16x16x32_bf16 v[120:123], v[216:219], v[204:207], 0
    v_mfma_f32_16x16x32_bf16 v[124:127], v[220:223], v[204:207], 0
    s_waitcnt lgkmcnt(1)
    ds_read_b128 v[204:207], v245 offset:6144
    v_mfma_f32_16x16x32_bf16 v[64:67], v[224:227], v[192:195], v[64:67]
    s_barrier
    ds_read_b64_tr_b16 v[208:209], v240 offset:32768
    v_mov_b32 v248, 0xc0135761
    v_mfma_f32_16x16x32_bf16 v[68:71], v[228:231], v[192:195], v[68:71]
    ds_read_b64_tr_b16 v[210:211], v240 offset:33280
    v_mov_b32 v249, 0xbdd2d3e8
    v_mfma_f32_16x16x32_bf16 v[72:75], v[232:235], v[192:195], v[72:75]
    ds_read_b64_tr_b16 v[212:213], v241 offset:32768
    v_mov_b32 v250, 1.0
    v_mfma_f32_16x16x32_bf16 v[76:79], v[236:239], v[192:195], v[76:79]
    ds_read_b128 v[192:195], v244 offset:8192
    s_mul_i32 s49, s48, 6144
    v_mfma_f32_16x16x32_bf16 v[80:83], v[224:227], v[196:199], v[80:83]
    ds_read_b64_tr_b16 v[214:215], v241 offset:33280
    s_add_u32 s49, s49, 135168
    v_mfma_f32_16x16x32_bf16 v[84:87], v[228:231], v[196:199], v[84:87]
    ds_read_b64_tr_b16 v[216:217], v240 offset:40960
    v_and_b32 v22, 6, v1
    v_mfma_f32_16x16x32_bf16 v[88:91], v[232:235], v[196:199], v[88:91]
    ds_read_b64_tr_b16 v[218:219], v240 offset:41472
    v_xor_b32 v22, v22, v2
    v_mfma_f32_16x16x32_bf16 v[92:95], v[236:239], v[196:199], v[92:95]
    s_waitcnt lgkmcnt(7)
    ds_read_b128 v[196:199], v244 offset:10240
    s_lshl_b32 s60, s7, 7
    v_mfma_f32_16x16x32_bf16 v[96:99], v[224:227], v[200:203], v[96:99]
    ds_read_b64_tr_b16 v[220:221], v241 offset:40960
    v_lshlrev_b32 v2, 10, v1
    v_mfma_f32_16x16x32_bf16 v[100:103], v[228:231], v[200:203], v[100:103]
    ds_read_b64_tr_b16 v[222:223], v241 offset:41472
    v_lshl_add_u32 v2, v22, 4, v2
    v_mfma_f32_16x16x32_bf16 v[104:107], v[232:235], v[200:203], v[104:107]
    v_add_u32 v2, s60, v2
    v_mfma_f32_16x16x32_bf16 v[108:111], v[236:239], v[200:203], v[108:111]
    ds_read_b128 v[200:203], v244 offset:12288
    v_add_u32 v3, 7168, v2
    v_mfma_f32_16x16x32_bf16 v[112:115], v[224:227], v[204:207], v[112:115]
    v_bfe_u32 v22, v0, 3, 2
    v_mfma_f32_16x16x32_bf16 v[116:119], v[228:231], v[204:207], v[116:119]
    s_lshl_b32 s60, s50, 1
    v_mfma_f32_16x16x32_bf16 v[120:123], v[232:235], v[204:207], v[120:123]
    v_xor_b32 v22, s60, v22
    v_mfma_f32_16x16x32_bf16 v[124:127], v[236:239], v[204:207], v[124:127]
    s_waitcnt lgkmcnt(1)
    ds_read_b128 v[204:207], v244 offset:14336
    v_lshrrev_b32 v23, 2, v0
    v_mfma_f32_16x16x32_bf16 v[64:67], v[208:211], v[192:195], v[64:67]
    s_barrier
    ds_read_b64_tr_b16 v[224:225], v242 offset:0
    v_lshlrev_b32 v23, 7, v23
    v_mfma_f32_16x16x32_bf16 v[68:71], v[212:215], v[192:195], v[68:71]
    ds_read_b64_tr_b16 v[226:227], v242 offset:512
    v_lshl_add_u32 v23, v22, 5, v23
    v_mfma_f32_16x16x32_bf16 v[72:75], v[216:219], v[192:195], v[72:75]
    ds_read_b64_tr_b16 v[228:229], v243 offset:0
    v_and_b32 v22, 3, v0
    v_mfma_f32_16x16x32_bf16 v[76:79], v[220:223], v[192:195], v[76:79]
    ds_read_b128 v[192:195], v245 offset:8192
    v_lshl_add_u32 v23, v22, 3, v23
    v_mfma_f32_16x16x32_bf16 v[80:83], v[208:211], v[196:199], v[80:83]
    ds_read_b64_tr_b16 v[230:231], v243 offset:512
    v_add_u32 v4, s49, v23
    v_mfma_f32_16x16x32_bf16 v[84:87], v[212:215], v[196:199], v[84:87]
    ds_read_b64_tr_b16 v[232:233], v242 offset:8192
    v_xor_b32 v5, 32, v4
    v_mfma_f32_16x16x32_bf16 v[88:91], v[216:219], v[196:199], v[88:91]
    ds_read_b64_tr_b16 v[234:235], v242 offset:8704
    s_lshl_b32 s61, s50, 15
    v_mfma_f32_16x16x32_bf16 v[92:95], v[220:223], v[196:199], v[92:95]
    s_waitcnt lgkmcnt(7)
    ds_read_b128 v[196:199], v245 offset:10240
    s_add_u32 s61, s61, 86016
    v_mfma_f32_16x16x32_bf16 v[96:99], v[208:211], v[200:203], v[96:99]
    ds_read_b64_tr_b16 v[236:237], v243 offset:8192
    v_lshrrev_b32 v22, 5, v0
    v_mfma_f32_16x16x32_bf16 v[100:103], v[212:215], v[200:203], v[100:103]
    ds_read_b64_tr_b16 v[238:239], v243 offset:8704
    v_lshl_add_u32 v23, v22, 10, v23
    v_mfma_f32_16x16x32_bf16 v[104:107], v[216:219], v[200:203], v[104:107]
    v_add_u32 v56, s61, v23
    v_mfma_f32_16x16x32_bf16 v[108:111], v[220:223], v[200:203], v[108:111]
    ds_read_b128 v[200:203], v245 offset:12288
    v_xor_b32 v57, 32, v56
    v_mfma_f32_16x16x32_bf16 v[112:115], v[208:211], v[204:207], v[112:115]
    v_xor_b32 v58, 64, v56
    v_mfma_f32_16x16x32_bf16 v[116:119], v[212:215], v[204:207], v[116:119]
    v_xor_b32 v59, 96, v56
    v_mfma_f32_16x16x32_bf16 v[120:123], v[216:219], v[204:207], v[120:123]
    s_mul_i32 s60, s18, 224
    v_mfma_f32_16x16x32_bf16 v[124:127], v[220:223], v[204:207], v[124:127]
    s_waitcnt lgkmcnt(1)
    ds_read_b128 v[204:207], v245 offset:14336
    s_mul_i32 s61, s48, 28
    v_mfma_f32_16x16x32_bf16 v[64:67], v[224:227], v[192:195], v[64:67]
    s_barrier
    ds_read_b64_tr_b16 v[208:209], v242 offset:16384
    s_add_u32 s61, s60, s61
    v_mfma_f32_16x16x32_bf16 v[68:71], v[228:231], v[192:195], v[68:71]
    ds_read_b64_tr_b16 v[210:211], v242 offset:16896
    s_lshl_b32 s61, s61, 10
    v_mfma_f32_16x16x32_bf16 v[72:75], v[232:235], v[192:195], v[72:75]
    ds_read_b64_tr_b16 v[212:213], v243 offset:16384
    s_add_u32 s61, s61, 5242880
    v_mfma_f32_16x16x32_bf16 v[76:79], v[236:239], v[192:195], v[76:79]
    ds_read_b128 v[192:195], v244 offset:16384
    s_mul_i32 s63, s51, 114688
    v_mfma_f32_16x16x32_bf16 v[80:83], v[224:227], v[196:199], v[80:83]
    ds_read_b64_tr_b16 v[214:215], v243 offset:16896
    s_add_u32 s55, s61, s63
    v_mfma_f32_16x16x32_bf16 v[84:87], v[228:231], v[196:199], v[84:87]
    ds_read_b64_tr_b16 v[216:217], v242 offset:24576
    v_add_u32 v7, s55, v6
    v_mfma_f32_16x16x32_bf16 v[88:91], v[232:235], v[196:199], v[88:91]
    ds_read_b64_tr_b16 v[218:219], v242 offset:25088
    s_add_u32 s61, s61, 114688
    v_mfma_f32_16x16x32_bf16 v[92:95], v[236:239], v[196:199], v[92:95]
    s_waitcnt lgkmcnt(7)
    ds_read_b128 v[196:199], v244 offset:18432
    s_sub_u32 s61, s61, s63
    v_mfma_f32_16x16x32_bf16 v[96:99], v[224:227], v[200:203], v[96:99]
    ds_read_b64_tr_b16 v[220:221], v243 offset:24576
    v_add_u32 v8, s61, v6
    v_mfma_f32_16x16x32_bf16 v[100:103], v[228:231], v[200:203], v[100:103]
    ds_read_b64_tr_b16 v[222:223], v243 offset:25088
    s_mul_i32 s60, s6, 224
    v_mfma_f32_16x16x32_bf16 v[104:107], v[232:235], v[200:203], v[104:107]
    s_add_u32 s61, s97, s51
    v_mfma_f32_16x16x32_bf16 v[108:111], v[236:239], v[200:203], v[108:111]
    ds_read_b128 v[200:203], v244 offset:20480
    s_lshl2_add_u32 s60, s61, s60
    v_mfma_f32_16x16x32_bf16 v[112:115], v[224:227], v[204:207], v[112:115]
    s_lshl1_add_u32 s60, s50, s60
    v_mfma_f32_16x16x32_bf16 v[116:119], v[228:231], v[204:207], v[116:119]
    s_lshl_b32 s60, s60, 10
    v_mfma_f32_16x16x32_bf16 v[120:123], v[232:235], v[204:207], v[120:123]
    s_add_u32 s98, s60, 5242880
    v_mfma_f32_16x16x32_bf16 v[124:127], v[236:239], v[204:207], v[124:127]
    s_waitcnt lgkmcnt(1)
    ds_read_b128 v[204:207], v244 offset:22528
    s_add_u32 s99, s98, 114688
    v_mfma_f32_16x16x32_bf16 v[64:67], v[208:211], v[192:195], v[64:67]
    s_barrier
    ds_read_b64_tr_b16 v[224:225], v240 offset:0
    s_add_u32 s60, s79, 1
    v_mfma_f32_16x16x32_bf16 v[68:71], v[212:215], v[192:195], v[68:71]
    ds_read_b64_tr_b16 v[226:227], v240 offset:512
    s_lshl_b32 s60, s60, 12
    v_mfma_f32_16x16x32_bf16 v[72:75], v[216:219], v[192:195], v[72:75]
    ds_read_b64_tr_b16 v[228:229], v241 offset:0
    s_sub_u32 s75, s98, s60
    v_mfma_f32_16x16x32_bf16 v[76:79], v[220:223], v[192:195], v[76:79]
    ds_read_b128 v[192:195], v245 offset:16384
    s_sub_u32 s76, s99, s60
    v_mfma_f32_16x16x32_bf16 v[80:83], v[208:211], v[196:199], v[80:83]
    ds_read_b64_tr_b16 v[230:231], v241 offset:512
    v_mfma_f32_16x16x32_bf16 v[84:87], v[212:215], v[196:199], v[84:87]
    ds_read_b64_tr_b16 v[232:233], v240 offset:8192
    v_mfma_f32_16x16x32_bf16 v[88:91], v[216:219], v[196:199], v[88:91]
    ds_read_b64_tr_b16 v[234:235], v240 offset:8704
    v_mfma_f32_16x16x32_bf16 v[92:95], v[220:223], v[196:199], v[92:95]
    s_waitcnt lgkmcnt(7)
    ds_read_b128 v[196:199], v245 offset:18432
    v_mfma_f32_16x16x32_bf16 v[96:99], v[208:211], v[200:203], v[96:99]
    ds_read_b64_tr_b16 v[236:237], v241 offset:8192
    v_mfma_f32_16x16x32_bf16 v[100:103], v[212:215], v[200:203], v[100:103]
    ds_read_b64_tr_b16 v[238:239], v241 offset:8704
    v_mfma_f32_16x16x32_bf16 v[104:107], v[216:219], v[200:203], v[104:107]
    v_mfma_f32_16x16x32_bf16 v[108:111], v[220:223], v[200:203], v[108:111]
    ds_read_b128 v[200:203], v245 offset:20480
    v_mfma_f32_16x16x32_bf16 v[112:115], v[208:211], v[204:207], v[112:115]
    v_mfma_f32_16x16x32_bf16 v[116:119], v[212:215], v[204:207], v[116:119]
    v_mfma_f32_16x16x32_bf16 v[120:123], v[216:219], v[204:207], v[120:123]
    v_mfma_f32_16x16x32_bf16 v[124:127], v[220:223], v[204:207], v[124:127]
    s_waitcnt lgkmcnt(1)
    ds_read_b128 v[204:207], v245 offset:22528
    v_mfma_f32_16x16x32_bf16 v[64:67], v[224:227], v[192:195], v[64:67]
    s_barrier
    ds_read_b64_tr_b16 v[208:209], v240 offset:16384
    v_mfma_f32_16x16x32_bf16 v[68:71], v[228:231], v[192:195], v[68:71]
    ds_read_b64_tr_b16 v[210:211], v240 offset:16896
    v_mfma_f32_16x16x32_bf16 v[72:75], v[232:235], v[192:195], v[72:75]
    ds_read_b64_tr_b16 v[212:213], v241 offset:16384
    v_mfma_f32_16x16x32_bf16 v[76:79], v[236:239], v[192:195], v[76:79]
    ds_read_b128 v[192:195], v244 offset:24576
    v_mfma_f32_16x16x32_bf16 v[80:83], v[224:227], v[196:199], v[80:83]
    ds_read_b64_tr_b16 v[214:215], v241 offset:16896
    v_mfma_f32_16x16x32_bf16 v[84:87], v[228:231], v[196:199], v[84:87]
    ds_read_b64_tr_b16 v[216:217], v240 offset:24576
    v_mfma_f32_16x16x32_bf16 v[88:91], v[232:235], v[196:199], v[88:91]
    ds_read_b64_tr_b16 v[218:219], v240 offset:25088
    v_mfma_f32_16x16x32_bf16 v[92:95], v[236:239], v[196:199], v[92:95]
    s_waitcnt lgkmcnt(7)
    ds_read_b128 v[196:199], v244 offset:26624
    v_mfma_f32_16x16x32_bf16 v[96:99], v[224:227], v[200:203], v[96:99]
    ds_read_b64_tr_b16 v[220:221], v241 offset:24576
    v_mfma_f32_16x16x32_bf16 v[100:103], v[228:231], v[200:203], v[100:103]
    ds_read_b64_tr_b16 v[222:223], v241 offset:25088
    v_mfma_f32_16x16x32_bf16 v[104:107], v[232:235], v[200:203], v[104:107]
    v_mfma_f32_16x16x32_bf16 v[108:111], v[236:239], v[200:203], v[108:111]
    ds_read_b128 v[200:203], v244 offset:28672
    v_mfma_f32_16x16x32_bf16 v[112:115], v[224:227], v[204:207], v[112:115]
    v_mfma_f32_16x16x32_bf16 v[116:119], v[228:231], v[204:207], v[116:119]
    v_mfma_f32_16x16x32_bf16 v[120:123], v[232:235], v[204:207], v[120:123]
    v_mfma_f32_16x16x32_bf16 v[124:127], v[236:239], v[204:207], v[124:127]
    s_waitcnt lgkmcnt(1)
    ds_read_b128 v[204:207], v244 offset:30720
    v_mfma_f32_16x16x32_bf16 v[64:67], v[208:211], v[192:195], v[64:67]
    s_barrier
    ds_read_b64_tr_b16 v[224:225], v240 offset:32768
    v_mfma_f32_16x16x32_bf16 v[68:71], v[212:215], v[192:195], v[68:71]
    ds_read_b64_tr_b16 v[226:227], v240 offset:33280
    v_mfma_f32_16x16x32_bf16 v[72:75], v[216:219], v[192:195], v[72:75]
    ds_read_b64_tr_b16 v[228:229], v241 offset:32768
    v_mfma_f32_16x16x32_bf16 v[76:79], v[220:223], v[192:195], v[76:79]
    ds_read_b128 v[192:195], v245 offset:24576
    v_mfma_f32_16x16x32_bf16 v[80:83], v[208:211], v[196:199], v[80:83]
    ds_read_b64_tr_b16 v[230:231], v241 offset:33280
    v_mfma_f32_16x16x32_bf16 v[84:87], v[212:215], v[196:199], v[84:87]
    ds_read_b64_tr_b16 v[232:233], v240 offset:40960
    v_mfma_f32_16x16x32_bf16 v[88:91], v[216:219], v[196:199], v[88:91]
    ds_read_b64_tr_b16 v[234:235], v240 offset:41472
    v_mfma_f32_16x16x32_bf16 v[92:95], v[220:223], v[196:199], v[92:95]
    s_waitcnt lgkmcnt(7)
    ds_read_b128 v[196:199], v245 offset:26624
    v_mfma_f32_16x16x32_bf16 v[96:99], v[208:211], v[200:203], v[96:99]
    ds_read_b64_tr_b16 v[236:237], v241 offset:40960
    v_mfma_f32_16x16x32_bf16 v[100:103], v[212:215], v[200:203], v[100:103]
    ds_read_b64_tr_b16 v[238:239], v241 offset:41472
    v_mfma_f32_16x16x32_bf16 v[104:107], v[216:219], v[200:203], v[104:107]
    v_mfma_f32_16x16x32_bf16 v[108:111], v[220:223], v[200:203], v[108:111]
    ds_read_b128 v[200:203], v245 offset:28672
    v_mfma_f32_16x16x32_bf16 v[112:115], v[208:211], v[204:207], v[112:115]
    v_mfma_f32_16x16x32_bf16 v[116:119], v[212:215], v[204:207], v[116:119]
    v_mfma_f32_16x16x32_bf16 v[120:123], v[216:219], v[204:207], v[120:123]
    v_mfma_f32_16x16x32_bf16 v[124:127], v[220:223], v[204:207], v[124:127]
    s_waitcnt lgkmcnt(1)
    ds_read_b128 v[204:207], v245 offset:30720
    v_mfma_f32_16x16x32_bf16 v[64:67], v[224:227], v[192:195], v[64:67]
    s_barrier
    ds_read_b64_tr_b16 v[208:209], v242 offset:0
    v_mfma_f32_16x16x32_bf16 v[68:71], v[228:231], v[192:195], v[68:71]
    ds_read_b64_tr_b16 v[210:211], v242 offset:512
    v_mfma_f32_16x16x32_bf16 v[72:75], v[232:235], v[192:195], v[72:75]
    ds_read_b64_tr_b16 v[212:213], v243 offset:0
    v_mfma_f32_16x16x32_bf16 v[76:79], v[236:239], v[192:195], v[76:79]
    ds_read_b128 v[192:195], v244 offset:32768
    v_mfma_f32_16x16x32_bf16 v[80:83], v[224:227], v[196:199], v[80:83]
    ds_read_b64_tr_b16 v[214:215], v243 offset:512
    v_mfma_f32_16x16x32_bf16 v[84:87], v[228:231], v[196:199], v[84:87]
    ds_read_b64_tr_b16 v[216:217], v242 offset:8192
    v_mfma_f32_16x16x32_bf16 v[88:91], v[232:235], v[196:199], v[88:91]
    ds_read_b64_tr_b16 v[218:219], v242 offset:8704
    v_mfma_f32_16x16x32_bf16 v[92:95], v[236:239], v[196:199], v[92:95]
    s_waitcnt lgkmcnt(7)
    ds_read_b128 v[196:199], v244 offset:34816
    v_mfma_f32_16x16x32_bf16 v[96:99], v[224:227], v[200:203], v[96:99]
    ds_read_b64_tr_b16 v[220:221], v243 offset:8192
    v_mfma_f32_16x16x32_bf16 v[100:103], v[228:231], v[200:203], v[100:103]
    ds_read_b64_tr_b16 v[222:223], v243 offset:8704
    v_mfma_f32_16x16x32_bf16 v[104:107], v[232:235], v[200:203], v[104:107]
L_pad_x254:
    s_cbranch_execz L_ret_x254
    v_mfma_f32_16x16x32_bf16 v[108:111], v[236:239], v[200:203], v[108:111]
    ds_read_b128 v[200:203], v244 offset:36864
    v_mfma_f32_16x16x32_bf16 v[112:115], v[224:227], v[204:207], v[112:115]
    v_mfma_f32_16x16x32_bf16 v[116:119], v[228:231], v[204:207], v[116:119]
    v_mfma_f32_16x16x32_bf16 v[120:123], v[232:235], v[204:207], v[120:123]
    v_mfma_f32_16x16x32_bf16 v[124:127], v[236:239], v[204:207], v[124:127]
    s_waitcnt lgkmcnt(1)
    ds_read_b128 v[204:207], v244 offset:38912
    v_mfma_f32_16x16x32_bf16 v[64:67], v[208:211], v[192:195], v[64:67]
    s_barrier
    ds_read_b64_tr_b16 v[224:225], v242 offset:16384
    v_mfma_f32_16x16x32_bf16 v[68:71], v[212:215], v[192:195], v[68:71]
    ds_read_b64_tr_b16 v[226:227], v242 offset:16896
    v_mfma_f32_16x16x32_bf16 v[72:75], v[216:219], v[192:195], v[72:75]
    ds_read_b64_tr_b16 v[228:229], v243 offset:16384
    v_mfma_f32_16x16x32_bf16 v[76:79], v[220:223], v[192:195], v[76:79]
    ds_read_b128 v[192:195], v245 offset:32768
    v_mfma_f32_16x16x32_bf16 v[80:83], v[208:211], v[196:199], v[80:83]
    ds_read_b64_tr_b16 v[230:231], v243 offset:16896
    v_mfma_f32_16x16x32_bf16 v[84:87], v[212:215], v[196:199], v[84:87]
    ds_read_b64_tr_b16 v[232:233], v242 offset:24576
    v_mfma_f32_16x16x32_bf16 v[88:91], v[216:219], v[196:199], v[88:91]
    ds_read_b64_tr_b16 v[234:235], v242 offset:25088
    v_mfma_f32_16x16x32_bf16 v[92:95], v[220:223], v[196:199], v[92:95]
    s_waitcnt lgkmcnt(7)
    ds_read_b128 v[196:199], v245 offset:34816
    v_mfma_f32_16x16x32_bf16 v[96:99], v[208:211], v[200:203], v[96:99]
    ds_read_b64_tr_b16 v[236:237], v243 offset:24576
    v_mfma_f32_16x16x32_bf16 v[100:103], v[212:215], v[200:203], v[100:103]
    ds_read_b64_tr_b16 v[238:239], v243 offset:25088
    v_mfma_f32_16x16x32_bf16 v[104:107], v[216:219], v[200:203], v[104:107]
    v_mfma_f32_16x16x32_bf16 v[108:111], v[220:223], v[200:203], v[108:111]
    ds_read_b128 v[200:203], v245 offset:36864
    v_mfma_f32_16x16x32_bf16 v[112:115], v[208:211], v[204:207], v[112:115]
    v_mfma_f32_16x16x32_bf16 v[116:119], v[212:215], v[204:207], v[116:119]
    v_mfma_f32_16x16x32_bf16 v[120:123], v[216:219], v[204:207], v[120:123]
    v_mfma_f32_16x16x32_bf16 v[124:127], v[220:223], v[204:207], v[124:127]
    s_waitcnt lgkmcnt(1)
    ds_read_b128 v[204:207], v245 offset:38912
    v_mfma_f32_16x16x32_bf16 v[64:67], v[224:227], v[192:195], v[64:67]
    s_barrier
    ds_read_b64_tr_b16 v[208:209], v240 offset:0
    v_mfma_f32_16x16x32_bf16 v[68:71], v[228:231], v[192:195], v[68:71]
    ds_read_b64_tr_b16 v[210:211], v240 offset:512
    v_mfma_f32_16x16x32_bf16 v[72:75], v[232:235], v[192:195], v[72:75]
    ds_read_b64_tr_b16 v[212:213], v241 offset:0
    v_mfma_f32_16x16x32_bf16 v[76:79], v[236:239], v[192:195], v[76:79]
    ds_read_b128 v[192:195], v244 offset:40960
    v_mfma_f32_16x16x32_bf16 v[80:83], v[224:227], v[196:199], v[80:83]
    ds_read_b64_tr_b16 v[214:215], v241 offset:512
    v_mfma_f32_16x16x32_bf16 v[84:87], v[228:231], v[196:199], v[84:87]
    ds_read_b64_tr_b16 v[216:217], v240 offset:8192
    v_mfma_f32_16x16x32_bf16 v[88:91], v[232:235], v[196:199], v[88:91]
    ds_read_b64_tr_b16 v[218:219], v240 offset:8704
    v_mfma_f32_16x16x32_bf16 v[92:95], v[236:239], v[196:199], v[92:95]
    s_waitcnt lgkmcnt(7)
    ds_read_b128 v[196:199], v244 offset:43008
    v_mfma_f32_16x16x32_bf16 v[96:99], v[224:227], v[200:203], v[96:99]
    ds_read_b64_tr_b16 v[220:221], v241 offset:8192
    v_mfma_f32_16x16x32_bf16 v[100:103], v[228:231], v[200:203], v[100:103]
    ds_read_b64_tr_b16 v[222:223], v241 offset:8704
    v_mfma_f32_16x16x32_bf16 v[104:107], v[232:235], v[200:203], v[104:107]
    v_mfma_f32_16x16x32_bf16 v[108:111], v[236:239], v[200:203], v[108:111]
    ds_read_b128 v[200:203], v244 offset:45056
    v_mfma_f32_16x16x32_bf16 v[112:115], v[224:227], v[204:207], v[112:115]
    v_mfma_f32_16x16x32_bf16 v[116:119], v[228:231], v[204:207], v[116:119]
    s_cmp_gt_u32 s51, s79
    s_cselect_b32 s77, 1, 0
    s_mul_i32 s55, s48, 458752
    s_and_b32 s61, s18, 3
    s_lshl1_add_u32 s60, s61, s7
    s_cmp_ge_u32 s60, 7
    s_cselect_b32 s61, 7, 0
    s_sub_u32 s60, s60, s61
    s_lshl_b32 s53, s60, 12
    s_lshl2_add_u32 s60, s6, s5
    s_lshl_b32 s60, s60, 7
    s_lshl4_add_u32 s60, s79, s60
    s_lshl2_add_u32 s60, s48, s60
    s_add_u32 s67, s60, 4718592
    s_lshl2_add_u32 s60, s18, s48
    s_lshl_b32 s60, s60, 7
    s_add_u32 s66, s60, 4718592
    v_and_b32 v11, 7, v0
    v_lshlrev_b32 v11, 2, v11
    v_bfe_u32 v22, v0, 3, 1
    v_lshl_add_u32 v11, v22, 14, v11
    s_lshl1_add_u32 s60, s18, s50
    s_lshr_b32 s61, s7, 2
    s_lshl1_add_u32 s60, s60, s61
    s_lshl_b32 s60, s60, 7
    s_lshl3_add_u32 s60, s54, s60
    s_lshl2_add_u32 s60, s51, s60
    s_add_u32 s72, s60, 4734976
    v_add_u32 v9, s49, v6
    v_mov_b32 v1, 1
    s_waitcnt vmcnt(0)
    v_readfirstlane_b32 s4, v15
    s_nop 3
    s_cmp_eq_u32 s4, 0
    s_cbranch_scc1 L_nspin_10
L_ngot_11:
    v_mfma_f32_16x16x32_bf16 v[120:123], v[232:235], v[204:207], v[120:123]
    v_mfma_f32_16x16x32_bf16 v[124:127], v[236:239], v[204:207], v[124:127]
    s_waitcnt lgkmcnt(1)
    ds_read_b128 v[204:207], v244 offset:47104
L_kvjoin:
    v_mfma_f32_16x16x32_bf16 v[64:67], v[208:211], v[192:195], v[64:67]
    s_barrier
    ds_read_b64_tr_b16 v[224:225], v240 offset:16384
    v_mov_b32 v12, s4
    v_mfma_f32_16x16x32_bf16 v[68:71], v[212:215], v[192:195], v[68:71]
    ds_read_b64_tr_b16 v[226:227], v240 offset:16896
    v_mov_b32 v14, 163824
    v_mfma_f32_16x16x32_bf16 v[72:75], v[216:219], v[192:195], v[72:75]
    ds_read_b64_tr_b16 v[228:229], v241 offset:16384
    s_lshl_b32 s71, s48, 14
    v_mfma_f32_16x16x32_bf16 v[76:79], v[220:223], v[192:195], v[76:79]
    ds_read_b128 v[192:195], v245 offset:40960
    s_add_u32 s71, s71, 86016
    v_mfma_f32_16x16x32_bf16 v[80:83], v[208:211], v[196:199], v[80:83]
    ds_read_b64_tr_b16 v[230:231], v241 offset:16896
    s_lshl1_add_u32 s74, s18, s50
    v_mfma_f32_16x16x32_bf16 v[84:87], v[212:215], v[196:199], v[84:87]
    ds_read_b64_tr_b16 v[232:233], v240 offset:24576
    s_lshl_b32 s74, s74, 5
    v_mfma_f32_16x16x32_bf16 v[88:91], v[216:219], v[196:199], v[88:91]
    ds_read_b64_tr_b16 v[234:235], v240 offset:25088
    s_lshl2_add_u32 s74, s7, s74
    v_mfma_f32_16x16x32_bf16 v[92:95], v[220:223], v[196:199], v[92:95]
    s_waitcnt lgkmcnt(7)
    ds_read_b128 v[196:199], v245 offset:43008
    s_lshl1_add_u32 s74, s51, s74
    v_mfma_f32_16x16x32_bf16 v[96:99], v[208:211], v[200:203], v[96:99]
    ds_read_b64_tr_b16 v[236:237], v241 offset:24576
    s_lshl_b32 s74, s74, 10
    v_mfma_f32_16x16x32_bf16 v[100:103], v[212:215], v[200:203], v[100:103]
    ds_read_b64_tr_b16 v[238:239], v241 offset:25088
    s_add_u32 s74, s74, 2097152
    v_mfma_f32_16x16x32_bf16 v[104:107], v[216:219], v[200:203], v[104:107]
    s_xor_b32 s60, s48, 1
    v_mfma_f32_16x16x32_bf16 v[108:111], v[220:223], v[200:203], v[108:111]
    ds_read_b128 v[200:203], v245 offset:45056
    s_mul_i32 s60, s60, 6144
    v_mfma_f32_16x16x32_bf16 v[112:115], v[208:211], v[204:207], v[112:115]
    s_add_u32 s68, s60, 135168
    v_mfma_f32_16x16x32_bf16 v[116:119], v[212:215], v[204:207], v[116:119]
    s_xor_b32 s60, s48, 2
    v_mfma_f32_16x16x32_bf16 v[120:123], v[216:219], v[204:207], v[120:123]
    s_mul_i32 s60, s60, 6144
    v_mfma_f32_16x16x32_bf16 v[124:127], v[220:223], v[204:207], v[124:127]
    s_waitcnt lgkmcnt(1)
    ds_read_b128 v[204:207], v245 offset:47104
    s_add_u32 s69, s60, 137216
    v_mfma_f32_16x16x32_bf16 v[64:67], v[224:227], v[192:195], v[64:67]
    s_barrier
    ds_read_b64_tr_b16 v[208:209], v240 offset:32768
    s_xor_b32 s60, s48, 3
    v_mfma_f32_16x16x32_bf16 v[68:71], v[228:231], v[192:195], v[68:71]
    ds_read_b64_tr_b16 v[210:211], v240 offset:33280
    s_mul_i32 s60, s60, 6144
    v_mfma_f32_16x16x32_bf16 v[72:75], v[232:235], v[192:195], v[72:75]
    ds_read_b64_tr_b16 v[212:213], v241 offset:32768
    s_add_u32 s70, s60, 139264
    v_mfma_f32_16x16x32_bf16 v[76:79], v[236:239], v[192:195], v[76:79]
    ds_read_b128 v[192:195], v244 offset:49152
    s_lshl_b32 s60, s6, 6
    v_mfma_f32_16x16x32_bf16 v[80:83], v[224:227], v[196:199], v[80:83]
    ds_read_b64_tr_b16 v[214:215], v241 offset:33280
    s_lshl3_add_u32 s60, s5, s60
    v_mfma_f32_16x16x32_bf16 v[84:87], v[228:231], v[196:199], v[84:87]
    ds_read_b64_tr_b16 v[216:217], v240 offset:40960
    s_lshl1_add_u32 s60, s50, s60
    v_mfma_f32_16x16x32_bf16 v[88:91], v[232:235], v[196:199], v[88:91]
    ds_read_b64_tr_b16 v[218:219], v240 offset:41472
    s_lshl_b32 s20, s60, 10
    v_mfma_f32_16x16x32_bf16 v[92:95], v[236:239], v[196:199], v[92:95]
    s_waitcnt lgkmcnt(7)
    ds_read_b128 v[196:199], v244 offset:51200
    s_add_u32 s21, s20, 32768
    v_mfma_f32_16x16x32_bf16 v[96:99], v[224:227], v[200:203], v[96:99]
    ds_read_b64_tr_b16 v[220:221], v241 offset:40960
    s_add_u32 s22, s20, 4096
    v_mfma_f32_16x16x32_bf16 v[100:103], v[228:231], v[200:203], v[100:103]
    ds_read_b64_tr_b16 v[222:223], v241 offset:41472
    s_add_u32 s23, s21, 4096
    v_mfma_f32_16x16x32_bf16 v[104:107], v[232:235], v[200:203], v[104:107]
    s_lshl_b32 s19, s6, 7
    v_mfma_f32_16x16x32_bf16 v[108:111], v[236:239], v[200:203], v[108:111]
    ds_read_b128 v[200:203], v244 offset:53248
    s_lshl3_add_u32 s19, s5, s19
    v_mfma_f32_16x16x32_bf16 v[112:115], v[224:227], v[204:207], v[112:115]
    s_lshl2_add_u32 s19, s50, s19
    v_mfma_f32_16x16x32_bf16 v[116:119], v[228:231], v[204:207], v[116:119]
    s_add_u32 s19, s19, 4792320
    v_mfma_f32_16x16x32_bf16 v[120:123], v[232:235], v[204:207], v[120:123]
    v_mov_b32 v16, 0
    v_mfma_f32_16x16x32_bf16 v[124:127], v[236:239], v[204:207], v[124:127]
    s_waitcnt lgkmcnt(1)
    ds_read_b128 v[204:207], v244 offset:55296
    v_mov_b32 v17, 0
    v_mfma_f32_16x16x32_bf16 v[64:67], v[208:211], v[192:195], v[64:67]
    s_barrier
    ds_read_b64_tr_b16 v[224:225], v242 offset:0
    v_and_b32 v10, 15, v0
    v_mfma_f32_16x16x32_bf16 v[68:71], v[212:215], v[192:195], v[68:71]
    ds_read_b64_tr_b16 v[226:227], v242 offset:512
    v_lshlrev_b32 v10, 4, v10
    v_mfma_f32_16x16x32_bf16 v[72:75], v[216:219], v[192:195], v[72:75]
    ds_read_b64_tr_b16 v[228:229], v243 offset:0
    v_lshrrev_b32 v22, 4, v0
    v_mfma_f32_16x16x32_bf16 v[76:79], v[220:223], v[192:195], v[76:79]
    ds_read_b128 v[192:195], v245 offset:49152
    v_lshl_add_u32 v10, v22, 9, v10
    v_mfma_f32_16x16x32_bf16 v[80:83], v[208:211], v[196:199], v[80:83]
    ds_read_b64_tr_b16 v[230:231], v243 offset:512
    v_mfma_f32_16x16x32_bf16 v[84:87], v[212:215], v[196:199], v[84:87]
    ds_read_b64_tr_b16 v[232:233], v242 offset:8192
    v_mfma_f32_16x16x32_bf16 v[88:91], v[216:219], v[196:199], v[88:91]
    ds_read_b64_tr_b16 v[234:235], v242 offset:8704
    v_mfma_f32_16x16x32_bf16 v[92:95], v[220:223], v[196:199], v[92:95]
    s_waitcnt lgkmcnt(7)
    ds_read_b128 v[196:199], v245 offset:51200
    v_mfma_f32_16x16x32_bf16 v[96:99], v[208:211], v[200:203], v[96:99]
    ds_read_b64_tr_b16 v[236:237], v243 offset:8192
    v_mfma_f32_16x16x32_bf16 v[100:103], v[212:215], v[200:203], v[100:103]
    ds_read_b64_tr_b16 v[238:239], v243 offset:8704
    v_mfma_f32_16x16x32_bf16 v[104:107], v[216:219], v[200:203], v[104:107]
    v_mfma_f32_16x16x32_bf16 v[108:111], v[220:223], v[200:203], v[108:111]
    ds_read_b128 v[200:203], v245 offset:53248
    v_mfma_f32_16x16x32_bf16 v[112:115], v[208:211], v[204:207], v[112:115]
    v_mfma_f32_16x16x32_bf16 v[116:119], v[212:215], v[204:207], v[116:119]
    v_mfma_f32_16x16x32_bf16 v[120:123], v[216:219], v[204:207], v[120:123]
    v_mfma_f32_16x16x32_bf16 v[124:127], v[220:223], v[204:207], v[124:127]
    s_waitcnt lgkmcnt(1)
    ds_read_b128 v[204:207], v245 offset:55296
    v_mfma_f32_16x16x32_bf16 v[64:67], v[224:227], v[192:195], v[64:67]
    s_barrier
    ds_read_b64_tr_b16 v[208:209], v242 offset:16384
    v_mfma_f32_16x16x32_bf16 v[68:71], v[228:231], v[192:195], v[68:71]
    ds_read_b64_tr_b16 v[210:211], v242 offset:16896
    v_mfma_f32_16x16x32_bf16 v[72:75], v[232:235], v[192:195], v[72:75]
    ds_read_b64_tr_b16 v[212:213], v243 offset:16384
    v_mfma_f32_16x16x32_bf16 v[76:79], v[236:239], v[192:195], v[76:79]
    ds_read_b128 v[192:195], v244 offset:57344
    v_mfma_f32_16x16x32_bf16 v[80:83], v[224:227], v[196:199], v[80:83]
    ds_read_b64_tr_b16 v[214:215], v243 offset:16896
    v_mfma_f32_16x16x32_bf16 v[84:87], v[228:231], v[196:199], v[84:87]
    ds_read_b64_tr_b16 v[216:217], v242 offset:24576
    v_mfma_f32_16x16x32_bf16 v[88:91], v[232:235], v[196:199], v[88:91]
    ds_read_b64_tr_b16 v[218:219], v242 offset:25088
    v_mfma_f32_16x16x32_bf16 v[92:95], v[236:239], v[196:199], v[92:95]
    s_waitcnt lgkmcnt(7)
    ds_read_b128 v[196:199], v244 offset:59392
    v_mfma_f32_16x16x32_bf16 v[96:99], v[224:227], v[200:203], v[96:99]
    ds_read_b64_tr_b16 v[220:221], v243 offset:24576
    v_mfma_f32_16x16x32_bf16 v[100:103], v[228:231], v[200:203], v[100:103]
    ds_read_b64_tr_b16 v[222:223], v243 offset:25088
    v_mfma_f32_16x16x32_bf16 v[104:107], v[232:235], v[200:203], v[104:107]
    v_mfma_f32_16x16x32_bf16 v[108:111], v[236:239], v[200:203], v[108:111]
    ds_read_b128 v[200:203], v244 offset:61440
    v_mfma_f32_16x16x32_bf16 v[112:115], v[224:227], v[204:207], v[112:115]
    v_mfma_f32_16x16x32_bf16 v[116:119], v[228:231], v[204:207], v[116:119]
    v_mfma_f32_16x16x32_bf16 v[120:123], v[232:235], v[204:207], v[120:123]
    v_mfma_f32_16x16x32_bf16 v[124:127], v[236:239], v[204:207], v[124:127]
    s_waitcnt lgkmcnt(1)
    ds_read_b128 v[204:207], v244 offset:63488
    v_mfma_f32_16x16x32_bf16 v[64:67], v[208:211], v[192:195], v[64:67]
    s_barrier
    ds_read_b64_tr_b16 v[224:225], v240 offset:0
    v_mfma_f32_16x16x32_bf16 v[68:71], v[212:215], v[192:195], v[68:71]
    ds_read_b64_tr_b16 v[226:227], v240 offset:512
    v_mfma_f32_16x16x32_bf16 v[72:75], v[216:219], v[192:195], v[72:75]
    ds_read_b64_tr_b16 v[228:229], v241 offset:0
    v_mfma_f32_16x16x32_bf16 v[76:79], v[220:223], v[192:195], v[76:79]
    ds_read_b128 v[192:195], v245 offset:57344
    v_mfma_f32_16x16x32_bf16 v[80:83], v[208:211], v[196:199], v[80:83]
    ds_read_b64_tr_b16 v[230:231], v241 offset:512
    v_mfma_f32_16x16x32_bf16 v[84:87], v[212:215], v[196:199], v[84:87]
    ds_read_b64_tr_b16 v[232:233], v240 offset:8192
    v_mfma_f32_16x16x32_bf16 v[88:91], v[216:219], v[196:199], v[88:91]
    ds_read_b64_tr_b16 v[234:235], v240 offset:8704
    v_mfma_f32_16x16x32_bf16 v[92:95], v[220:223], v[196:199], v[92:95]
    s_waitcnt lgkmcnt(7)
    ds_read_b128 v[196:199], v245 offset:59392
    v_mfma_f32_16x16x32_bf16 v[96:99], v[208:211], v[200:203], v[96:99]
    ds_read_b64_tr_b16 v[236:237], v241 offset:8192
    v_mfma_f32_16x16x32_bf16 v[100:103], v[212:215], v[200:203], v[100:103]
    ds_read_b64_tr_b16 v[238:239], v241 offset:8704
    s_mov_b64 exec, 1
    ds_write_b64 v14, v[16:17]
    ds_write_b64 v14, v[16:17] offset:8
    s_mov_b64 exec, -1
    v_mfma_f32_16x16x32_bf16 v[104:107], v[216:219], v[200:203], v[104:107]
    v_mfma_f32_16x16x32_bf16 v[108:111], v[220:223], v[200:203], v[108:111]
    ds_read_b128 v[200:203], v245 offset:61440
    v_mfma_f32_16x16x32_bf16 v[112:115], v[208:211], v[204:207], v[112:115]
    v_mfma_f32_16x16x32_bf16 v[116:119], v[212:215], v[204:207], v[116:119]
    v_mfma_f32_16x16x32_bf16 v[120:123], v[216:219], v[204:207], v[120:123]
    v_mfma_f32_16x16x32_bf16 v[124:127], v[220:223], v[204:207], v[124:127]
    s_waitcnt lgkmcnt(1)
    ds_read_b128 v[204:207], v245 offset:63488
    v_mfma_f32_16x16x32_bf16 v[64:67], v[224:227], v[192:195], v[64:67]
    s_barrier
    ds_read_b64_tr_b16 v[208:209], v240 offset:16384
    v_mfma_f32_16x16x32_bf16 v[68:71], v[228:231], v[192:195], v[68:71]
    ds_read_b64_tr_b16 v[210:211], v240 offset:16896
    v_mfma_f32_16x16x32_bf16 v[72:75], v[232:235], v[192:195], v[72:75]
    ds_read_b64_tr_b16 v[212:213], v241 offset:16384
    v_mfma_f32_16x16x32_bf16 v[76:79], v[236:239], v[192:195], v[76:79]
    ds_read_b128 v[192:195], v244 offset:0
    v_mfma_f32_16x16x32_bf16 v[80:83], v[224:227], v[196:199], v[80:83]
    ds_read_b64_tr_b16 v[214:215], v241 offset:16896
    v_mfma_f32_16x16x32_bf16 v[84:87], v[228:231], v[196:199], v[84:87]
    ds_read_b64_tr_b16 v[216:217], v240 offset:24576
    v_mfma_f32_16x16x32_bf16 v[88:91], v[232:235], v[196:199], v[88:91]
    ds_read_b64_tr_b16 v[218:219], v240 offset:25088
    v_mfma_f32_16x16x32_bf16 v[92:95], v[236:239], v[196:199], v[92:95]
    s_waitcnt lgkmcnt(7)
    ds_read_b128 v[196:199], v244 offset:2048
    v_mfma_f32_16x16x32_bf16 v[96:99], v[224:227], v[200:203], v[96:99]
    ds_read_b64_tr_b16 v[220:221], v241 offset:24576
    v_mfma_f32_16x16x32_bf16 v[100:103], v[228:231], v[200:203], v[100:103]
    ds_read_b64_tr_b16 v[222:223], v241 offset:25088
    v_mfma_f32_16x16x32_bf16 v[104:107], v[232:235], v[200:203], v[104:107]
    v_mfma_f32_16x16x32_bf16 v[108:111], v[236:239], v[200:203], v[108:111]
    ds_read_b128 v[200:203], v244 offset:4096
    v_mfma_f32_16x16x32_bf16 v[112:115], v[224:227], v[204:207], v[112:115]
    v_mfma_f32_16x16x32_bf16 v[116:119], v[228:231], v[204:207], v[116:119]
    s_cmp_eq_u32 s52, 0
    s_cbranch_scc1 L_nokvf_13
    s_mov_b64 exec, 1
    s_waitcnt vmcnt(0)
    buffer_store_dword v12, v13, s[40:43], s65 offen sc1
    s_mov_b64 exec, -1
L_nokvf_13:
    v_mfma_f32_16x16x32_bf16 v[120:123], v[232:235], v[204:207], v[120:123]
    v_mfma_f32_16x16x32_bf16 v[124:127], v[236:239], v[204:207], v[124:127]
    s_waitcnt lgkmcnt(1)
    ds_read_b128 v[204:207], v244 offset:6144
    s_cmp_lg_u32 s77, 0
    s_cbranch_scc1 L_p1q
    v_mfma_f32_16x16x32_bf16 v[128:131], v[208:211], v[192:195], 0
    s_barrier
    ds_read_b64_tr_b16 v[224:225], v240 offset:32768
    v_mfma_f32_16x16x32_bf16 v[132:135], v[212:215], v[192:195], 0
    ds_read_b64_tr_b16 v[226:227], v240 offset:33280
    v_mfma_f32_16x16x32_bf16 v[136:139], v[216:219], v[192:195], 0
    ds_read_b64_tr_b16 v[228:229], v241 offset:32768
    v_mul_f32 v16, v64, v64
    v_mfma_f32_16x16x32_bf16 v[140:143], v[220:223], v[192:195], 0
    ds_read_b128 v[192:195], v245 offset:0
    v_mul_f32 v17, v65, v65
    v_mfma_f32_16x16x32_bf16 v[144:147], v[208:211], v[196:199], 0
    ds_read_b64_tr_b16 v[230:231], v241 offset:33280
    v_mul_f32 v18, v66, v66
    v_mfma_f32_16x16x32_bf16 v[148:151], v[212:215], v[196:199], 0
    ds_read_b64_tr_b16 v[232:233], v240 offset:40960
    v_mul_f32 v19, v67, v67
    v_mfma_f32_16x16x32_bf16 v[152:155], v[216:219], v[196:199], 0
    ds_read_b64_tr_b16 v[234:235], v240 offset:41472
    v_mul_f32 v20, v68, v68
    v_mfma_f32_16x16x32_bf16 v[156:159], v[220:223], v[196:199], 0
    s_waitcnt lgkmcnt(7)
    ds_read_b128 v[196:199], v245 offset:2048
    v_mul_f32 v21, v69, v69
    v_mfma_f32_16x16x32_bf16 v[160:163], v[208:211], v[200:203], 0
    ds_read_b64_tr_b16 v[236:237], v241 offset:40960
    v_mul_f32 v22, v70, v70
    v_mfma_f32_16x16x32_bf16 v[164:167], v[212:215], v[200:203], 0
    ds_read_b64_tr_b16 v[238:239], v241 offset:41472
    v_mul_f32 v23, v71, v71
    v_mfma_f32_16x16x32_bf16 v[168:171], v[216:219], v[200:203], 0
    v_fma_f32 v16, v16, v249, v248
    v_fma_f32 v17, v17, v249, v248
    v_fma_f32 v18, v18, v249, v248
    v_mfma_f32_16x16x32_bf16 v[172:175], v[220:223], v[200:203], 0
    ds_read_b128 v[200:203], v245 offset:4096
    v_fma_f32 v19, v19, v249, v248
    v_mfma_f32_16x16x32_bf16 v[176:179], v[208:211], v[204:207], 0
    v_fma_f32 v20, v20, v249, v248
    v_fma_f32 v21, v21, v249, v248
    v_fma_f32 v22, v22, v249, v248
    v_mfma_f32_16x16x32_bf16 v[180:183], v[212:215], v[204:207], 0
    v_fma_f32 v23, v23, v249, v248
    v_mul_f32 v16, v16, v64
    v_mul_f32 v17, v17, v65
    v_mfma_f32_16x16x32_bf16 v[184:187], v[216:219], v[204:207], 0
    v_mul_f32 v18, v18, v66
    v_mul_f32 v19, v19, v67
    v_mul_f32 v20, v20, v68
    v_mfma_f32_16x16x32_bf16 v[188:191], v[220:223], v[204:207], 0
    s_waitcnt lgkmcnt(1)
    ds_read_b128 v[204:207], v245 offset:6144
    v_mul_f32 v21, v21, v69
    v_mfma_f32_16x16x32_bf16 v[128:131], v[224:227], v[192:195], v[128:131]
    s_barrier
    ds_read_b64_tr_b16 v[208:209], v242 offset:0
    v_mul_f32 v22, v22, v70
    v_mfma_f32_16x16x32_bf16 v[132:135], v[228:231], v[192:195], v[132:135]
    ds_read_b64_tr_b16 v[210:211], v242 offset:512
    v_mul_f32 v23, v23, v71
    v_mfma_f32_16x16x32_bf16 v[136:139], v[232:235], v[192:195], v[136:139]
    ds_read_b64_tr_b16 v[212:213], v243 offset:0
    v_mfma_f32_16x16x32_bf16 v[140:143], v[236:239], v[192:195], v[140:143]
    ds_read_b128 v[192:195], v244 offset:8192
    v_mfma_f32_16x16x32_bf16 v[144:147], v[224:227], v[196:199], v[144:147]
    ds_read_b64_tr_b16 v[214:215], v243 offset:512
    v_mfma_f32_16x16x32_bf16 v[148:151], v[228:231], v[196:199], v[148:151]
    ds_read_b64_tr_b16 v[216:217], v242 offset:8192
    v_mfma_f32_16x16x32_bf16 v[152:155], v[232:235], v[196:199], v[152:155]
    ds_read_b64_tr_b16 v[218:219], v242 offset:8704
    v_mfma_f32_16x16x32_bf16 v[156:159], v[236:239], v[196:199], v[156:159]
    s_waitcnt lgkmcnt(7)
    ds_read_b128 v[196:199], v244 offset:10240
    v_mfma_f32_16x16x32_bf16 v[160:163], v[224:227], v[200:203], v[160:163]
    ds_read_b64_tr_b16 v[220:221], v243 offset:8192
    v_mfma_f32_16x16x32_bf16 v[164:167], v[228:231], v[200:203], v[164:167]
    ds_read_b64_tr_b16 v[222:223], v243 offset:8704
    v_mfma_f32_16x16x32_bf16 v[168:171], v[232:235], v[200:203], v[168:171]
    v_exp_f32 v16, v16
    v_mul_f32 v64, v64, v72
    v_mfma_f32_16x16x32_bf16 v[172:175], v[236:239], v[200:203], v[172:175]
    ds_read_b128 v[200:203], v244 offset:12288
    v_mfma_f32_16x16x32_bf16 v[176:179], v[224:227], v[204:207], v[176:179]
    v_exp_f32 v17, v17
    v_mul_f32 v65, v65, v73
    v_mfma_f32_16x16x32_bf16 v[180:183], v[228:231], v[204:207], v[180:183]
    v_exp_f32 v18, v18
    v_mul_f32 v66, v66, v74
    v_mfma_f32_16x16x32_bf16 v[184:187], v[232:235], v[204:207], v[184:187]
    v_exp_f32 v19, v19
    v_mul_f32 v67, v67, v75
    v_mfma_f32_16x16x32_bf16 v[188:191], v[236:239], v[204:207], v[188:191]
    s_waitcnt lgkmcnt(1)
    ds_read_b128 v[204:207], v244 offset:14336
    v_mfma_f32_16x16x32_bf16 v[128:131], v[208:211], v[192:195], v[128:131]
    s_barrier
    ds_read_b64_tr_b16 v[224:225], v242 offset:16384
    v_mfma_f32_16x16x32_bf16 v[132:135], v[212:215], v[192:195], v[132:135]
    ds_read_b64_tr_b16 v[226:227], v242 offset:16896
    v_mfma_f32_16x16x32_bf16 v[136:139], v[216:219], v[192:195], v[136:139]
    ds_read_b64_tr_b16 v[228:229], v243 offset:16384
    v_mfma_f32_16x16x32_bf16 v[140:143], v[220:223], v[192:195], v[140:143]
    ds_read_b128 v[192:195], v245 offset:8192
    v_mfma_f32_16x16x32_bf16 v[144:147], v[208:211], v[196:199], v[144:147]
    ds_read_b64_tr_b16 v[230:231], v243 offset:16896
    v_mfma_f32_16x16x32_bf16 v[148:151], v[212:215], v[196:199], v[148:151]
    ds_read_b64_tr_b16 v[232:233], v242 offset:24576
    v_mfma_f32_16x16x32_bf16 v[152:155], v[216:219], v[196:199], v[152:155]
    ds_read_b64_tr_b16 v[234:235], v242 offset:25088
    v_mfma_f32_16x16x32_bf16 v[156:159], v[220:223], v[196:199], v[156:159]
    s_waitcnt lgkmcnt(7)
    ds_read_b128 v[196:199], v245 offset:10240
    v_mfma_f32_16x16x32_bf16 v[160:163], v[208:211], v[200:203], v[160:163]
    ds_read_b64_tr_b16 v[236:237], v243 offset:24576
    v_mfma_f32_16x16x32_bf16 v[164:167], v[212:215], v[200:203], v[164:167]
    ds_read_b64_tr_b16 v[238:239], v243 offset:25088
    v_mfma_f32_16x16x32_bf16 v[168:171], v[216:219], v[200:203], v[168:171]
    v_exp_f32 v20, v20
    v_mul_f32 v68, v68, v76
    v_mfma_f32_16x16x32_bf16 v[172:175], v[220:223], v[200:203], v[172:175]
    ds_read_b128 v[200:203], v245 offset:12288
    v_mfma_f32_16x16x32_bf16 v[176:179], v[208:211], v[204:207], v[176:179]
    v_exp_f32 v21, v21
    v_mul_f32 v69, v69, v77
    v_mfma_f32_16x16x32_bf16 v[180:183], v[212:215], v[204:207], v[180:183]
    v_exp_f32 v22, v22
    v_mul_f32 v70, v70, v78
    v_mfma_f32_16x16x32_bf16 v[184:187], v[216:219], v[204:207], v[184:187]
    v_exp_f32 v23, v23
    v_mul_f32 v71, v71, v79
    v_mfma_f32_16x16x32_bf16 v[188:191], v[220:223], v[204:207], v[188:191]
    s_waitcnt lgkmcnt(1)
    ds_read_b128 v[204:207], v245 offset:14336
    v_add_f32 v16, 1.0, v16
    v_mfma_f32_16x16x32_bf16 v[128:131], v[224:227], v[192:195], v[128:131]
    s_barrier
    ds_read_b64_tr_b16 v[208:209], v240 offset:0
    v_add_f32 v17, 1.0, v17
    v_mfma_f32_16x16x32_bf16 v[132:135], v[228:231], v[192:195], v[132:135]
    ds_read_b64_tr_b16 v[210:211], v240 offset:512
    v_mfma_f32_16x16x32_bf16 v[136:139], v[232:235], v[192:195], v[136:139]
    ds_read_b64_tr_b16 v[212:213], v241 offset:0
    v_mfma_f32_16x16x32_bf16 v[140:143], v[236:239], v[192:195], v[140:143]
    ds_read_b128 v[192:195], v244 offset:16384
    v_mfma_f32_16x16x32_bf16 v[144:147], v[224:227], v[196:199], v[144:147]
    ds_read_b64_tr_b16 v[214:215], v241 offset:512
    v_mfma_f32_16x16x32_bf16 v[148:151], v[228:231], v[196:199], v[148:151]
    ds_read_b64_tr_b16 v[216:217], v240 offset:8192
    v_mfma_f32_16x16x32_bf16 v[152:155], v[232:235], v[196:199], v[152:155]
    ds_read_b64_tr_b16 v[218:219], v240 offset:8704
    v_mfma_f32_16x16x32_bf16 v[156:159], v[236:239], v[196:199], v[156:159]
    s_waitcnt lgkmcnt(7)
    ds_read_b128 v[196:199], v244 offset:18432
    v_mfma_f32_16x16x32_bf16 v[160:163], v[224:227], v[200:203], v[160:163]
    ds_read_b64_tr_b16 v[220:221], v241 offset:8192
    v_mfma_f32_16x16x32_bf16 v[164:167], v[228:231], v[200:203], v[164:167]
    ds_read_b64_tr_b16 v[222:223], v241 offset:8704
    v_mfma_f32_16x16x32_bf16 v[168:171], v[232:235], v[200:203], v[168:171]
    v_rcp_f32 v16, v16
    v_add_f32 v18, 1.0, v18
    v_mfma_f32_16x16x32_bf16 v[172:175], v[236:239], v[200:203], v[172:175]
    ds_read_b128 v[200:203], v244 offset:20480
    v_mfma_f32_16x16x32_bf16 v[176:179], v[224:227], v[204:207], v[176:179]
    v_rcp_f32 v17, v17
    v_add_f32 v19, 1.0, v19
    v_mfma_f32_16x16x32_bf16 v[180:183], v[228:231], v[204:207], v[180:183]
    v_rcp_f32 v18, v18
    v_add_f32 v20, 1.0, v20
    v_mfma_f32_16x16x32_bf16 v[184:187], v[232:235], v[204:207], v[184:187]
    v_rcp_f32 v19, v19
    v_add_f32 v21, 1.0, v21
    v_mfma_f32_16x16x32_bf16 v[188:191], v[236:239], v[204:207], v[188:191]
    s_waitcnt lgkmcnt(1)
    ds_read_b128 v[204:207], v244 offset:22528
    v_mfma_f32_16x16x32_bf16 v[128:131], v[208:211], v[192:195], v[128:131]
    s_barrier
    ds_read_b64_tr_b16 v[224:225], v240 offset:16384
    v_mfma_f32_16x16x32_bf16 v[132:135], v[212:215], v[192:195], v[132:135]
    ds_read_b64_tr_b16 v[226:227], v240 offset:16896
    v_mfma_f32_16x16x32_bf16 v[136:139], v[216:219], v[192:195], v[136:139]
    ds_read_b64_tr_b16 v[228:229], v241 offset:16384
    v_mfma_f32_16x16x32_bf16 v[140:143], v[220:223], v[192:195], v[140:143]
    ds_read_b128 v[192:195], v245 offset:16384
    v_mfma_f32_16x16x32_bf16 v[144:147], v[208:211], v[196:199], v[144:147]
    ds_read_b64_tr_b16 v[230:231], v241 offset:16896
    v_mfma_f32_16x16x32_bf16 v[148:151], v[212:215], v[196:199], v[148:151]
    ds_read_b64_tr_b16 v[232:233], v240 offset:24576
    v_mfma_f32_16x16x32_bf16 v[152:155], v[216:219], v[196:199], v[152:155]
    ds_read_b64_tr_b16 v[234:235], v240 offset:25088
    v_mfma_f32_16x16x32_bf16 v[156:159], v[220:223], v[196:199], v[156:159]
    s_waitcnt lgkmcnt(7)
    ds_read_b128 v[196:199], v245 offset:18432
    v_mfma_f32_16x16x32_bf16 v[160:163], v[208:211], v[200:203], v[160:163]
    ds_read_b64_tr_b16 v[236:237], v241 offset:24576
    v_mfma_f32_16x16x32_bf16 v[164:167], v[212:215], v[200:203], v[164:167]
    ds_read_b64_tr_b16 v[238:239], v241 offset:25088
    v_mfma_f32_16x16x32_bf16 v[168:171], v[216:219], v[200:203], v[168:171]
    v_rcp_f32 v20, v20
    v_add_f32 v22, 1.0, v22
    v_mfma_f32_16x16x32_bf16 v[172:175], v[220:223], v[200:203], v[172:175]
    ds_read_b128 v[200:203], v245 offset:20480
    v_mfma_f32_16x16x32_bf16 v[176:179], v[208:211], v[204:207], v[176:179]
    v_rcp_f32 v21, v21
    v_add_f32 v23, 1.0, v23
    v_mfma_f32_16x16x32_bf16 v[180:183], v[212:215], v[204:207], v[180:183]
    v_rcp_f32 v22, v22
    v_mfma_f32_16x16x32_bf16 v[184:187], v[216:219], v[204:207], v[184:187]
    v_rcp_f32 v23, v23
    v_mul_f32 v64, v64, v16
    v_mfma_f32_16x16x32_bf16 v[188:191], v[220:223], v[204:207], v[188:191]
    s_waitcnt lgkmcnt(1)
    ds_read_b128 v[204:207], v245 offset:22528
    v_mul_f32 v65, v65, v17
    v_mfma_f32_16x16x32_bf16 v[128:131], v[224:227], v[192:195], v[128:131]
    s_barrier
    ds_read_b64_tr_b16 v[208:209], v240 offset:32768
    v_mul_f32 v66, v66, v18
    v_mfma_f32_16x16x32_bf16 v[132:135], v[228:231], v[192:195], v[132:135]
    ds_read_b64_tr_b16 v[210:211], v240 offset:33280
    v_mul_f32 v67, v67, v19
    v_mfma_f32_16x16x32_bf16 v[136:139], v[232:235], v[192:195], v[136:139]
    ds_read_b64_tr_b16 v[212:213], v241 offset:32768
    v_mul_f32 v68, v68, v20
    v_mfma_f32_16x16x32_bf16 v[140:143], v[236:239], v[192:195], v[140:143]
    ds_read_b128 v[192:195], v244 offset:24576
    v_mul_f32 v69, v69, v21
    v_mfma_f32_16x16x32_bf16 v[144:147], v[224:227], v[196:199], v[144:147]
    ds_read_b64_tr_b16 v[214:215], v241 offset:33280
    v_mul_f32 v70, v70, v22
    v_mfma_f32_16x16x32_bf16 v[148:151], v[228:231], v[196:199], v[148:151]
    ds_read_b64_tr_b16 v[216:217], v240 offset:40960
    v_mul_f32 v71, v71, v23
    v_mfma_f32_16x16x32_bf16 v[152:155], v[232:235], v[196:199], v[152:155]
    ds_read_b64_tr_b16 v[218:219], v240 offset:41472
    v_cvt_pk_bf16_f32 v24, v64, v65
    v_mfma_f32_16x16x32_bf16 v[156:159], v[236:239], v[196:199], v[156:159]
    s_waitcnt lgkmcnt(7)
    ds_read_b128 v[196:199], v244 offset:26624
    v_cvt_pk_bf16_f32 v25, v66, v67
    v_mfma_f32_16x16x32_bf16 v[160:163], v[224:227], v[200:203], v[160:163]
    ds_read_b64_tr_b16 v[220:221], v241 offset:40960
    v_cvt_pk_bf16_f32 v26, v68, v69
    v_mfma_f32_16x16x32_bf16 v[164:167], v[228:231], v[200:203], v[164:167]
    ds_read_b64_tr_b16 v[222:223], v241 offset:41472
    v_cvt_pk_bf16_f32 v27, v70, v71
    v_mfma_f32_16x16x32_bf16 v[168:171], v[232:235], v[200:203], v[168:171]
    v_mul_f32 v16, v80, v80
    v_mul_f32 v17, v81, v81
    v_mul_f32 v18, v82, v82
    v_mfma_f32_16x16x32_bf16 v[172:175], v[236:239], v[200:203], v[172:175]
    ds_read_b128 v[200:203], v244 offset:28672
    v_mul_f32 v19, v83, v83
    v_mfma_f32_16x16x32_bf16 v[176:179], v[224:227], v[204:207], v[176:179]
L_pad_x438:
    s_cbranch_execz L_ret_x438
    v_mul_f32 v20, v84, v84
    v_mul_f32 v21, v85, v85
    v_mul_f32 v22, v86, v86
    v_mfma_f32_16x16x32_bf16 v[180:183], v[228:231], v[204:207], v[180:183]
    v_mul_f32 v23, v87, v87
    v_fma_f32 v16, v16, v249, v248
    v_fma_f32 v17, v17, v249, v248
    v_mfma_f32_16x16x32_bf16 v[184:187], v[232:235], v[204:207], v[184:187]
    v_fma_f32 v18, v18, v249, v248
    v_fma_f32 v19, v19, v249, v248
    v_fma_f32 v20, v20, v249, v248
    v_mfma_f32_16x16x32_bf16 v[188:191], v[236:239], v[204:207], v[188:191]
    s_waitcnt lgkmcnt(1)
    ds_read_b128 v[204:207], v244 offset:30720
    v_fma_f32 v21, v21, v249, v248
    v_mfma_f32_16x16x32_bf16 v[128:131], v[208:211], v[192:195], v[128:131]
    s_barrier
    ds_read_b64_tr_b16 v[224:225], v242 offset:0
    v_fma_f32 v22, v22, v249, v248
    v_mfma_f32_16x16x32_bf16 v[132:135], v[212:215], v[192:195], v[132:135]
    ds_read_b64_tr_b16 v[226:227], v242 offset:512
    v_fma_f32 v23, v23, v249, v248
    v_mfma_f32_16x16x32_bf16 v[136:139], v[216:219], v[192:195], v[136:139]
    ds_read_b64_tr_b16 v[228:229], v243 offset:0
    v_mul_f32 v16, v16, v80
    v_mfma_f32_16x16x32_bf16 v[140:143], v[220:223], v[192:195], v[140:143]
    ds_read_b128 v[192:195], v245 offset:24576
    v_mul_f32 v17, v17, v81
    v_mfma_f32_16x16x32_bf16 v[144:147], v[208:211], v[196:199], v[144:147]
    ds_read_b64_tr_b16 v[230:231], v243 offset:512
    v_mul_f32 v18, v18, v82
    v_mfma_f32_16x16x32_bf16 v[148:151], v[212:215], v[196:199], v[148:151]
    ds_read_b64_tr_b16 v[232:233], v242 offset:8192
    v_mul_f32 v19, v19, v83
    v_mfma_f32_16x16x32_bf16 v[152:155], v[216:219], v[196:199], v[152:155]
    ds_read_b64_tr_b16 v[234:235], v242 offset:8704
    v_mul_f32 v20, v20, v84
    v_mfma_f32_16x16x32_bf16 v[156:159], v[220:223], v[196:199], v[156:159]
    s_waitcnt lgkmcnt(7)
    ds_read_b128 v[196:199], v245 offset:26624
    v_mul_f32 v21, v21, v85
    v_mfma_f32_16x16x32_bf16 v[160:163], v[208:211], v[200:203], v[160:163]
    ds_read_b64_tr_b16 v[236:237], v243 offset:8192
    v_mul_f32 v22, v22, v86
    v_mfma_f32_16x16x32_bf16 v[164:167], v[212:215], v[200:203], v[164:167]
    ds_read_b64_tr_b16 v[238:239], v243 offset:8704
    v_mul_f32 v23, v23, v87
    v_mfma_f32_16x16x32_bf16 v[168:171], v[216:219], v[200:203], v[168:171]
    v_exp_f32 v16, v16
    v_mul_f32 v80, v80, v88
    v_mfma_f32_16x16x32_bf16 v[172:175], v[220:223], v[200:203], v[172:175]
    ds_read_b128 v[200:203], v245 offset:28672
    v_mfma_f32_16x16x32_bf16 v[176:179], v[208:211], v[204:207], v[176:179]
    v_exp_f32 v17, v17
    v_mul_f32 v81, v81, v89
    v_mfma_f32_16x16x32_bf16 v[180:183], v[212:215], v[204:207], v[180:183]
    v_exp_f32 v18, v18
    v_mul_f32 v82, v82, v90
    v_mfma_f32_16x16x32_bf16 v[184:187], v[216:219], v[204:207], v[184:187]
    v_exp_f32 v19, v19
    v_mul_f32 v83, v83, v91
    v_mfma_f32_16x16x32_bf16 v[188:191], v[220:223], v[204:207], v[188:191]
    s_waitcnt lgkmcnt(1)
    ds_read_b128 v[204:207], v245 offset:30720
    v_mfma_f32_16x16x32_bf16 v[128:131], v[224:227], v[192:195], v[128:131]
    s_barrier
    ds_read_b64_tr_b16 v[208:209], v242 offset:16384
    v_mfma_f32_16x16x32_bf16 v[132:135], v[228:231], v[192:195], v[132:135]
    ds_read_b64_tr_b16 v[210:211], v242 offset:16896
    v_mfma_f32_16x16x32_bf16 v[136:139], v[232:235], v[192:195], v[136:139]
    ds_read_b64_tr_b16 v[212:213], v243 offset:16384
    v_mfma_f32_16x16x32_bf16 v[140:143], v[236:239], v[192:195], v[140:143]
    ds_read_b128 v[192:195], v244 offset:32768
    v_mfma_f32_16x16x32_bf16 v[144:147], v[224:227], v[196:199], v[144:147]
    ds_read_b64_tr_b16 v[214:215], v243 offset:16896
    v_mfma_f32_16x16x32_bf16 v[148:151], v[228:231], v[196:199], v[148:151]
    ds_read_b64_tr_b16 v[216:217], v242 offset:24576
    v_mfma_f32_16x16x32_bf16 v[152:155], v[232:235], v[196:199], v[152:155]
    ds_read_b64_tr_b16 v[218:219], v242 offset:25088
    v_mfma_f32_16x16x32_bf16 v[156:159], v[236:239], v[196:199], v[156:159]
    s_waitcnt lgkmcnt(7)
    ds_read_b128 v[196:199], v244 offset:34816
    v_mfma_f32_16x16x32_bf16 v[160:163], v[224:227], v[200:203], v[160:163]
    ds_read_b64_tr_b16 v[220:221], v243 offset:24576
    v_mfma_f32_16x16x32_bf16 v[164:167], v[228:231], v[200:203], v[164:167]
    ds_read_b64_tr_b16 v[222:223], v243 offset:25088
    v_mfma_f32_16x16x32_bf16 v[168:171], v[232:235], v[200:203], v[168:171]
    v_exp_f32 v20, v20
    v_mul_f32 v84, v84, v92
    v_mfma_f32_16x16x32_bf16 v[172:175], v[236:239], v[200:203], v[172:175]
    ds_read_b128 v[200:203], v244 offset:36864
    v_mfma_f32_16x16x32_bf16 v[176:179], v[224:227], v[204:207], v[176:179]
    v_exp_f32 v21, v21
    v_mul_f32 v85, v85, v93
    v_mfma_f32_16x16x32_bf16 v[180:183], v[228:231], v[204:207], v[180:183]
    v_exp_f32 v22, v22
    v_mul_f32 v86, v86, v94
    v_mfma_f32_16x16x32_bf16 v[184:187], v[232:235], v[204:207], v[184:187]
    v_exp_f32 v23, v23
    v_mul_f32 v87, v87, v95
    v_mfma_f32_16x16x32_bf16 v[188:191], v[236:239], v[204:207], v[188:191]
    s_waitcnt lgkmcnt(1)
    ds_read_b128 v[204:207], v244 offset:38912
    v_add_f32 v16, 1.0, v16
    v_mfma_f32_16x16x32_bf16 v[128:131], v[208:211], v[192:195], v[128:131]
    s_barrier
    ds_read_b64_tr_b16 v[224:225], v240 offset:0
    v_add_f32 v17, 1.0, v17
    v_mfma_f32_16x16x32_bf16 v[132:135], v[212:215], v[192:195], v[132:135]
    ds_read_b64_tr_b16 v[226:227], v240 offset:512
    v_mfma_f32_16x16x32_bf16 v[136:139], v[216:219], v[192:195], v[136:139]
    ds_read_b64_tr_b16 v[228:229], v241 offset:0
    v_mfma_f32_16x16x32_bf16 v[140:143], v[220:223], v[192:195], v[140:143]
    ds_read_b128 v[192:195], v245 offset:32768
    v_mfma_f32_16x16x32_bf16 v[144:147], v[208:211], v[196:199], v[144:147]
    ds_read_b64_tr_b16 v[230:231], v241 offset:512
    v_mfma_f32_16x16x32_bf16 v[148:151], v[212:215], v[196:199], v[148:151]
    ds_read_b64_tr_b16 v[232:233], v240 offset:8192
    v_mfma_f32_16x16x32_bf16 v[152:155], v[216:219], v[196:199], v[152:155]
    ds_read_b64_tr_b16 v[234:235], v240 offset:8704
    v_mfma_f32_16x16x32_bf16 v[156:159], v[220:223], v[196:199], v[156:159]
    s_waitcnt lgkmcnt(7)
    ds_read_b128 v[196:199], v245 offset:34816
    v_mfma_f32_16x16x32_bf16 v[160:163], v[208:211], v[200:203], v[160:163]
    ds_read_b64_tr_b16 v[236:237], v241 offset:8192
    v_mfma_f32_16x16x32_bf16 v[164:167], v[212:215], v[200:203], v[164:167]
    ds_read_b64_tr_b16 v[238:239], v241 offset:8704
    v_mfma_f32_16x16x32_bf16 v[168:171], v[216:219], v[200:203], v[168:171]
    v_rcp_f32 v16, v16
    v_add_f32 v18, 1.0, v18
    v_mfma_f32_16x16x32_bf16 v[172:175], v[220:223], v[200:203], v[172:175]
    ds_read_b128 v[200:203], v245 offset:36864
    v_mfma_f32_16x16x32_bf16 v[176:179], v[208:211], v[204:207], v[176:179]
    v_rcp_f32 v17, v17
    v_add_f32 v19, 1.0, v19
    v_mfma_f32_16x16x32_bf16 v[180:183], v[212:215], v[204:207], v[180:183]
    v_rcp_f32 v18, v18
    v_add_f32 v20, 1.0, v20
    v_mfma_f32_16x16x32_bf16 v[184:187], v[216:219], v[204:207], v[184:187]
    v_rcp_f32 v19, v19
    v_add_f32 v21, 1.0, v21
    v_mfma_f32_16x16x32_bf16 v[188:191], v[220:223], v[204:207], v[188:191]
    s_waitcnt lgkmcnt(1)
    ds_read_b128 v[204:207], v245 offset:38912
    v_mfma_f32_16x16x32_bf16 v[128:131], v[224:227], v[192:195], v[128:131]
    s_barrier
    ds_read_b64_tr_b16 v[208:209], v240 offset:16384
    v_mfma_f32_16x16x32_bf16 v[132:135], v[228:231], v[192:195], v[132:135]
    ds_read_b64_tr_b16 v[210:211], v240 offset:16896
    v_mfma_f32_16x16x32_bf16 v[136:139], v[232:235], v[192:195], v[136:139]
    ds_read_b64_tr_b16 v[212:213], v241 offset:16384
    v_mfma_f32_16x16x32_bf16 v[140:143], v[236:239], v[192:195], v[140:143]
    ds_read_b128 v[192:195], v244 offset:40960
    v_mfma_f32_16x16x32_bf16 v[144:147], v[224:227], v[196:199], v[144:147]
    ds_read_b64_tr_b16 v[214:215], v241 offset:16896
    v_mfma_f32_16x16x32_bf16 v[148:151], v[228:231], v[196:199], v[148:151]
    ds_read_b64_tr_b16 v[216:217], v240 offset:24576
    v_mfma_f32_16x16x32_bf16 v[152:155], v[232:235], v[196:199], v[152:155]
    ds_read_b64_tr_b16 v[218:219], v240 offset:25088
    v_mfma_f32_16x16x32_bf16 v[156:159], v[236:239], v[196:199], v[156:159]
    s_waitcnt lgkmcnt(7)
    ds_read_b128 v[196:199], v244 offset:43008
    v_mfma_f32_16x16x32_bf16 v[160:163], v[224:227], v[200:203], v[160:163]
    ds_read_b64_tr_b16 v[220:221], v241 offset:24576
    v_mfma_f32_16x16x32_bf16 v[164:167], v[228:231], v[200:203], v[164:167]
    ds_read_b64_tr_b16 v[222:223], v241 offset:25088
    v_mfma_f32_16x16x32_bf16 v[168:171], v[232:235], v[200:203], v[168:171]
    v_rcp_f32 v20, v20
    v_add_f32 v22, 1.0, v22
    v_mfma_f32_16x16x32_bf16 v[172:175], v[236:239], v[200:203], v[172:175]
    ds_read_b128 v[200:203], v244 offset:45056
    v_mfma_f32_16x16x32_bf16 v[176:179], v[224:227], v[204:207], v[176:179]
    v_rcp_f32 v21, v21
    v_add_f32 v23, 1.0, v23
    v_mfma_f32_16x16x32_bf16 v[180:183], v[228:231], v[204:207], v[180:183]
    v_rcp_f32 v22, v22
    v_mfma_f32_16x16x32_bf16 v[184:187], v[232:235], v[204:207], v[184:187]
    v_rcp_f32 v23, v23
    v_mul_f32 v80, v80, v16
    v_mfma_f32_16x16x32_bf16 v[188:191], v[236:239], v[204:207], v[188:191]
    s_waitcnt lgkmcnt(1)
    ds_read_b128 v[204:207], v244 offset:47104
    v_mul_f32 v81, v81, v17
    v_mfma_f32_16x16x32_bf16 v[128:131], v[208:211], v[192:195], v[128:131]
    s_barrier
    ds_read_b64_tr_b16 v[224:225], v240 offset:32768
    v_mul_f32 v82, v82, v18
    v_mfma_f32_16x16x32_bf16 v[132:135], v[212:215], v[192:195], v[132:135]
    ds_read_b64_tr_b16 v[226:227], v240 offset:33280
    v_mul_f32 v83, v83, v19
    v_mfma_f32_16x16x32_bf16 v[136:139], v[216:219], v[192:195], v[136:139]
    ds_read_b64_tr_b16 v[228:229], v241 offset:32768
    v_mul_f32 v84, v84, v20
    v_mfma_f32_16x16x32_bf16 v[140:143], v[220:223], v[192:195], v[140:143]
    ds_read_b128 v[192:195], v245 offset:40960
    v_mul_f32 v85, v85, v21
    v_mfma_f32_16x16x32_bf16 v[144:147], v[208:211], v[196:199], v[144:147]
    ds_read_b64_tr_b16 v[230:231], v241 offset:33280
    v_mul_f32 v86, v86, v22
    v_mfma_f32_16x16x32_bf16 v[148:151], v[212:215], v[196:199], v[148:151]
    ds_read_b64_tr_b16 v[232:233], v240 offset:40960
    v_mul_f32 v87, v87, v23
    v_mfma_f32_16x16x32_bf16 v[152:155], v[216:219], v[196:199], v[152:155]
    ds_read_b64_tr_b16 v[234:235], v240 offset:41472
    v_cvt_pk_bf16_f32 v28, v80, v81
    v_mfma_f32_16x16x32_bf16 v[156:159], v[220:223], v[196:199], v[156:159]
    s_waitcnt lgkmcnt(7)
    ds_read_b128 v[196:199], v245 offset:43008
    v_cvt_pk_bf16_f32 v29, v82, v83
    v_mfma_f32_16x16x32_bf16 v[160:163], v[208:211], v[200:203], v[160:163]
    ds_read_b64_tr_b16 v[236:237], v241 offset:40960
    v_cvt_pk_bf16_f32 v30, v84, v85
    v_mfma_f32_16x16x32_bf16 v[164:167], v[212:215], v[200:203], v[164:167]
    ds_read_b64_tr_b16 v[238:239], v241 offset:41472
    v_cvt_pk_bf16_f32 v31, v86, v87
    v_mfma_f32_16x16x32_bf16 v[168:171], v[216:219], v[200:203], v[168:171]
    v_mul_f32 v16, v96, v96
    v_mul_f32 v17, v97, v97
    v_mul_f32 v18, v98, v98
    v_mfma_f32_16x16x32_bf16 v[172:175], v[220:223], v[200:203], v[172:175]
    ds_read_b128 v[200:203], v245 offset:45056
    v_mul_f32 v19, v99, v99
    v_mfma_f32_16x16x32_bf16 v[176:179], v[208:211], v[204:207], v[176:179]
    v_mul_f32 v20, v100, v100
    v_mul_f32 v21, v101, v101
    v_mul_f32 v22, v102, v102
    v_mfma_f32_16x16x32_bf16 v[180:183], v[212:215], v[204:207], v[180:183]
    v_mul_f32 v23, v103, v103
    v_fma_f32 v16, v16, v249, v248
    v_fma_f32 v17, v17, v249, v248
    v_mfma_f32_16x16x32_bf16 v[184:187], v[216:219], v[204:207], v[184:187]
    v_fma_f32 v18, v18, v249, v248
    v_fma_f32 v19, v19, v249, v248
    v_fma_f32 v20, v20, v249, v248
    v_mfma_f32_16x16x32_bf16 v[188:191], v[220:223], v[204:207], v[188:191]
    s_waitcnt lgkmcnt(1)
    ds_read_b128 v[204:207], v245 offset:47104
    v_fma_f32 v21, v21, v249, v248
    v_mfma_f32_16x16x32_bf16 v[128:131], v[224:227], v[192:195], v[128:131]
    s_barrier
    ds_read_b64_tr_b16 v[208:209], v242 offset:0
    v_fma_f32 v22, v22, v249, v248
    v_mfma_f32_16x16x32_bf16 v[132:135], v[228:231], v[192:195], v[132:135]
    ds_read_b64_tr_b16 v[210:211], v242 offset:512
    v_fma_f32 v23, v23, v249, v248
    v_mfma_f32_16x16x32_bf16 v[136:139], v[232:235], v[192:195], v[136:139]
    ds_read_b64_tr_b16 v[212:213], v243 offset:0
    v_mul_f32 v16, v16, v96
    v_mfma_f32_16x16x32_bf16 v[140:143], v[236:239], v[192:195], v[140:143]
    ds_read_b128 v[192:195], v244 offset:49152
    v_mul_f32 v17, v17, v97
    v_mfma_f32_16x16x32_bf16 v[144:147], v[224:227], v[196:199], v[144:147]
    ds_read_b64_tr_b16 v[214:215], v243 offset:512
    v_mul_f32 v18, v18, v98
    v_mfma_f32_16x16x32_bf16 v[148:151], v[228:231], v[196:199], v[148:151]
    ds_read_b64_tr_b16 v[216:217], v242 offset:8192
    v_mul_f32 v19, v19, v99
    v_mfma_f32_16x16x32_bf16 v[152:155], v[232:235], v[196:199], v[152:155]
    ds_read_b64_tr_b16 v[218:219], v242 offset:8704
    v_mul_f32 v20, v20, v100
    v_mfma_f32_16x16x32_bf16 v[156:159], v[236:239], v[196:199], v[156:159]
    s_waitcnt lgkmcnt(7)
    ds_read_b128 v[196:199], v244 offset:51200
    v_mul_f32 v21, v21, v101
    v_mfma_f32_16x16x32_bf16 v[160:163], v[224:227], v[200:203], v[160:163]
    ds_read_b64_tr_b16 v[220:221], v243 offset:8192
    v_mul_f32 v22, v22, v102
    v_mfma_f32_16x16x32_bf16 v[164:167], v[228:231], v[200:203], v[164:167]
    ds_read_b64_tr_b16 v[222:223], v243 offset:8704
    v_mul_f32 v23, v23, v103
    v_mfma_f32_16x16x32_bf16 v[168:171], v[232:235], v[200:203], v[168:171]
    v_exp_f32 v16, v16
    v_mul_f32 v96, v96, v104
    v_mfma_f32_16x16x32_bf16 v[172:175], v[236:239], v[200:203], v[172:175]
    ds_read_b128 v[200:203], v244 offset:53248
    v_mfma_f32_16x16x32_bf16 v[176:179], v[224:227], v[204:207], v[176:179]
    v_exp_f32 v17, v17
    v_mul_f32 v97, v97, v105
    v_mfma_f32_16x16x32_bf16 v[180:183], v[228:231], v[204:207], v[180:183]
    v_exp_f32 v18, v18
    v_mul_f32 v98, v98, v106
    v_mfma_f32_16x16x32_bf16 v[184:187], v[232:235], v[204:207], v[184:187]
    v_exp_f32 v19, v19
    v_mul_f32 v99, v99, v107
    v_mfma_f32_16x16x32_bf16 v[188:191], v[236:239], v[204:207], v[188:191]
    s_waitcnt lgkmcnt(1)
    ds_read_b128 v[204:207], v244 offset:55296
    v_mfma_f32_16x16x32_bf16 v[128:131], v[208:211], v[192:195], v[128:131]
    s_barrier
    ds_read_b64_tr_b16 v[224:225], v242 offset:16384
    v_mfma_f32_16x16x32_bf16 v[132:135], v[212:215], v[192:195], v[132:135]
    ds_read_b64_tr_b16 v[226:227], v242 offset:16896
    v_mfma_f32_16x16x32_bf16 v[136:139], v[216:219], v[192:195], v[136:139]
    ds_read_b64_tr_b16 v[228:229], v243 offset:16384
    v_mfma_f32_16x16x32_bf16 v[140:143], v[220:223], v[192:195], v[140:143]
    ds_read_b128 v[192:195], v245 offset:49152
    v_mfma_f32_16x16x32_bf16 v[144:147], v[208:211], v[196:199], v[144:147]
    ds_read_b64_tr_b16 v[230:231], v243 offset:16896
    v_mfma_f32_16x16x32_bf16 v[148:151], v[212:215], v[196:199], v[148:151]
    ds_read_b64_tr_b16 v[232:233], v242 offset:24576
    v_mfma_f32_16x16x32_bf16 v[152:155], v[216:219], v[196:199], v[152:155]
    ds_read_b64_tr_b16 v[234:235], v242 offset:25088
    v_mfma_f32_16x16x32_bf16 v[156:159], v[220:223], v[196:199], v[156:159]
    s_waitcnt lgkmcnt(7)
    ds_read_b128 v[196:199], v245 offset:51200
    v_mfma_f32_16x16x32_bf16 v[160:163], v[208:211], v[200:203], v[160:163]
    ds_read_b64_tr_b16 v[236:237], v243 offset:24576
    v_mfma_f32_16x16x32_bf16 v[164:167], v[212:215], v[200:203], v[164:167]
    ds_read_b64_tr_b16 v[238:239], v243 offset:25088
    v_mfma_f32_16x16x32_bf16 v[168:171], v[216:219], v[200:203], v[168:171]
    v_exp_f32 v20, v20
    v_mul_f32 v100, v100, v108
    v_mfma_f32_16x16x32_bf16 v[172:175], v[220:223], v[200:203], v[172:175]
    ds_read_b128 v[200:203], v245 offset:53248
    v_mfma_f32_16x16x32_bf16 v[176:179], v[208:211], v[204:207], v[176:179]
    v_exp_f32 v21, v21
    v_mul_f32 v101, v101, v109
    v_mfma_f32_16x16x32_bf16 v[180:183], v[212:215], v[204:207], v[180:183]
    v_exp_f32 v22, v22
    v_mul_f32 v102, v102, v110
    v_mfma_f32_16x16x32_bf16 v[184:187], v[216:219], v[204:207], v[184:187]
    v_exp_f32 v23, v23
    v_mul_f32 v103, v103, v111
    v_mfma_f32_16x16x32_bf16 v[188:191], v[220:223], v[204:207], v[188:191]
    s_waitcnt lgkmcnt(1)
    ds_read_b128 v[204:207], v245 offset:55296
    v_add_f32 v16, 1.0, v16
    v_mfma_f32_16x16x32_bf16 v[128:131], v[224:227], v[192:195], v[128:131]
    s_barrier
    ds_read_b64_tr_b16 v[208:209], v240 offset:0
    v_add_f32 v17, 1.0, v17
    v_mfma_f32_16x16x32_bf16 v[132:135], v[228:231], v[192:195], v[132:135]
    ds_read_b64_tr_b16 v[210:211], v240 offset:512
    v_mfma_f32_16x16x32_bf16 v[136:139], v[232:235], v[192:195], v[136:139]
    ds_read_b64_tr_b16 v[212:213], v241 offset:0
    v_mfma_f32_16x16x32_bf16 v[140:143], v[236:239], v[192:195], v[140:143]
    ds_read_b128 v[192:195], v244 offset:57344
    v_mfma_f32_16x16x32_bf16 v[144:147], v[224:227], v[196:199], v[144:147]
    ds_read_b64_tr_b16 v[214:215], v241 offset:512
    v_mfma_f32_16x16x32_bf16 v[148:151], v[228:231], v[196:199], v[148:151]
    ds_read_b64_tr_b16 v[216:217], v240 offset:8192
    v_mfma_f32_16x16x32_bf16 v[152:155], v[232:235], v[196:199], v[152:155]
    ds_read_b64_tr_b16 v[218:219], v240 offset:8704
    v_mfma_f32_16x16x32_bf16 v[156:159], v[236:239], v[196:199], v[156:159]
    s_waitcnt lgkmcnt(7)
    ds_read_b128 v[196:199], v244 offset:59392
    v_mfma_f32_16x16x32_bf16 v[160:163], v[224:227], v[200:203], v[160:163]
    ds_read_b64_tr_b16 v[220:221], v241 offset:8192
    v_mfma_f32_16x16x32_bf16 v[164:167], v[228:231], v[200:203], v[164:167]
    ds_read_b64_tr_b16 v[222:223], v241 offset:8704
    v_mfma_f32_16x16x32_bf16 v[168:171], v[232:235], v[200:203], v[168:171]
    v_rcp_f32 v16, v16
    v_add_f32 v18, 1.0, v18
    v_mfma_f32_16x16x32_bf16 v[172:175], v[236:239], v[200:203], v[172:175]
    ds_read_b128 v[200:203], v244 offset:61440
    v_mfma_f32_16x16x32_bf16 v[176:179], v[224:227], v[204:207], v[176:179]
    v_rcp_f32 v17, v17
    v_add_f32 v19, 1.0, v19
    v_mfma_f32_16x16x32_bf16 v[180:183], v[228:231], v[204:207], v[180:183]
    v_rcp_f32 v18, v18
    v_add_f32 v20, 1.0, v20
    v_mfma_f32_16x16x32_bf16 v[184:187], v[232:235], v[204:207], v[184:187]
    v_rcp_f32 v19, v19
    v_add_f32 v21, 1.0, v21
    v_mfma_f32_16x16x32_bf16 v[188:191], v[236:239], v[204:207], v[188:191]
    s_waitcnt lgkmcnt(1)
    ds_read_b128 v[204:207], v244 offset:63488
    v_mfma_f32_16x16x32_bf16 v[128:131], v[208:211], v[192:195], v[128:131]
    s_barrier
    ds_read_b64_tr_b16 v[224:225], v240 offset:16384
    v_mfma_f32_16x16x32_bf16 v[132:135], v[212:215], v[192:195], v[132:135]
    ds_read_b64_tr_b16 v[226:227], v240 offset:16896
    v_mfma_f32_16x16x32_bf16 v[136:139], v[216:219], v[192:195], v[136:139]
    ds_read_b64_tr_b16 v[228:229], v241 offset:16384
    v_mfma_f32_16x16x32_bf16 v[140:143], v[220:223], v[192:195], v[140:143]
    ds_read_b128 v[192:195], v245 offset:57344
    v_mfma_f32_16x16x32_bf16 v[144:147], v[208:211], v[196:199], v[144:147]
    ds_read_b64_tr_b16 v[230:231], v241 offset:16896
    v_mfma_f32_16x16x32_bf16 v[148:151], v[212:215], v[196:199], v[148:151]
    ds_read_b64_tr_b16 v[232:233], v240 offset:24576
    v_mfma_f32_16x16x32_bf16 v[152:155], v[216:219], v[196:199], v[152:155]
    ds_read_b64_tr_b16 v[234:235], v240 offset:25088
    v_mfma_f32_16x16x32_bf16 v[156:159], v[220:223], v[196:199], v[156:159]
    s_waitcnt lgkmcnt(7)
    ds_read_b128 v[196:199], v245 offset:59392
    v_mfma_f32_16x16x32_bf16 v[160:163], v[208:211], v[200:203], v[160:163]
    ds_read_b64_tr_b16 v[236:237], v241 offset:24576
    v_mfma_f32_16x16x32_bf16 v[164:167], v[212:215], v[200:203], v[164:167]
    ds_read_b64_tr_b16 v[238:239], v241 offset:25088
    v_mfma_f32_16x16x32_bf16 v[168:171], v[216:219], v[200:203], v[168:171]
    v_rcp_f32 v20, v20
    v_add_f32 v22, 1.0, v22
    v_mfma_f32_16x16x32_bf16 v[172:175], v[220:223], v[200:203], v[172:175]
    ds_read_b128 v[200:203], v245 offset:61440
    v_mfma_f32_16x16x32_bf16 v[176:179], v[208:211], v[204:207], v[176:179]
    v_rcp_f32 v21, v21
    v_add_f32 v23, 1.0, v23
    v_mfma_f32_16x16x32_bf16 v[180:183], v[212:215], v[204:207], v[180:183]
    v_rcp_f32 v22, v22
    v_mfma_f32_16x16x32_bf16 v[184:187], v[216:219], v[204:207], v[184:187]
    v_rcp_f32 v23, v23
    v_mul_f32 v96, v96, v16
    v_mfma_f32_16x16x32_bf16 v[188:191], v[220:223], v[204:207], v[188:191]
    s_waitcnt lgkmcnt(1)
    ds_read_b128 v[204:207], v245 offset:63488
    v_mul_f32 v97, v97, v17
    v_mfma_f32_16x16x32_bf16 v[128:131], v[224:227], v[192:195], v[128:131]
    v_mul_f32 v98, v98, v18
    v_mul_f32 v99, v99, v19
    v_mul_f32 v100, v100, v20
    v_mfma_f32_16x16x32_bf16 v[132:135], v[228:231], v[192:195], v[132:135]
    v_mul_f32 v101, v101, v21
    v_mul_f32 v102, v102, v22
    v_mul_f32 v103, v103, v23
    v_mfma_f32_16x16x32_bf16 v[136:139], v[232:235], v[192:195], v[136:139]
    v_cvt_pk_bf16_f32 v32, v96, v97
    v_cvt_pk_bf16_f32 v33, v98, v99
    v_cvt_pk_bf16_f32 v34, v100, v101
    v_mfma_f32_16x16x32_bf16 v[140:143], v[236:239], v[192:195], v[140:143]
    v_cvt_pk_bf16_f32 v35, v102, v103
    v_mul_f32 v16, v112, v112
    v_mul_f32 v17, v113, v113
    v_mfma_f32_16x16x32_bf16 v[144:147], v[224:227], v[196:199], v[144:147]
    v_mul_f32 v18, v114, v114
    v_mul_f32 v19, v115, v115
    v_mul_f32 v20, v116, v116
    v_mfma_f32_16x16x32_bf16 v[148:151], v[228:231], v[196:199], v[148:151]
    v_mul_f32 v21, v117, v117
    v_mul_f32 v22, v118, v118
    v_mul_f32 v23, v119, v119
    v_mfma_f32_16x16x32_bf16 v[152:155], v[232:235], v[196:199], v[152:155]
    v_fma_f32 v16, v16, v249, v248
    v_fma_f32 v17, v17, v249, v248
    v_fma_f32 v18, v18, v249, v248
    v_mfma_f32_16x16x32_bf16 v[156:159], v[236:239], v[196:199], v[156:159]
    s_waitcnt lgkmcnt(0)
    s_barrier
    v_fma_f32 v19, v19, v249, v248
    v_fma_f32 v20, v20, v249, v248
    v_fma_f32 v21, v21, v249, v248
    v_mfma_f32_16x16x32_bf16 v[160:163], v[224:227], v[200:203], v[160:163]
    v_fma_f32 v22, v22, v249, v248
    v_fma_f32 v23, v23, v249, v248
    v_mul_f32 v16, v16, v112
    v_mfma_f32_16x16x32_bf16 v[164:167], v[228:231], v[200:203], v[164:167]
    v_mul_f32 v17, v17, v113
    v_mul_f32 v18, v18, v114
    v_mul_f32 v19, v19, v115
    v_mfma_f32_16x16x32_bf16 v[168:171], v[232:235], v[200:203], v[168:171]
    v_mul_f32 v20, v20, v116
    v_mul_f32 v21, v21, v117
    v_mul_f32 v22, v22, v118
    v_mfma_f32_16x16x32_bf16 v[172:175], v[236:239], v[200:203], v[172:175]
    v_mul_f32 v23, v23, v119
    v_exp_f32 v16, v16
    v_mfma_f32_16x16x32_bf16 v[176:179], v[224:227], v[204:207], v[176:179]
    v_mul_f32 v112, v112, v120
    v_exp_f32 v17, v17
    v_mfma_f32_16x16x32_bf16 v[180:183], v[228:231], v[204:207], v[180:183]
    v_mul_f32 v113, v113, v121
    v_exp_f32 v18, v18
    v_mfma_f32_16x16x32_bf16 v[184:187], v[232:235], v[204:207], v[184:187]
    v_mul_f32 v114, v114, v122
    v_exp_f32 v19, v19
    v_mfma_f32_16x16x32_bf16 v[188:191], v[236:239], v[204:207], v[188:191]
    v_mul_f32 v115, v115, v123
    v_exp_f32 v20, v20
    v_mul_f32 v116, v116, v124
    v_exp_f32 v21, v21
    v_mul_f32 v117, v117, v125
    v_exp_f32 v22, v22
    v_mul_f32 v118, v118, v126
    v_exp_f32 v23, v23
    v_mul_f32 v119, v119, v127
    v_add_f32 v16, 1.0, v16
    v_add_f32 v17, 1.0, v17
    v_rcp_f32 v16, v16
    v_add_f32 v18, 1.0, v18
    v_rcp_f32 v17, v17
    v_add_f32 v19, 1.0, v19
    v_rcp_f32 v18, v18
    v_add_f32 v20, 1.0, v20
    v_rcp_f32 v19, v19
    v_add_f32 v21, 1.0, v21
    v_rcp_f32 v20, v20
    v_add_f32 v22, 1.0, v22
    v_rcp_f32 v21, v21
    v_add_f32 v23, 1.0, v23
    v_rcp_f32 v22, v22
    v_rcp_f32 v23, v23
    v_mul_f32 v112, v112, v16
    v_mul_f32 v113, v113, v17
    v_mul_f32 v114, v114, v18
    v_mul_f32 v115, v115, v19
    v_mul_f32 v116, v116, v20
    v_mul_f32 v117, v117, v21
    v_mul_f32 v118, v118, v22
    v_mul_f32 v119, v119, v23
    v_cvt_pk_bf16_f32 v36, v112, v113
    v_cvt_pk_bf16_f32 v37, v114, v115
    v_cvt_pk_bf16_f32 v38, v116, v117
    v_cvt_pk_bf16_f32 v39, v118, v119
L_p1e:
    s_setprio 2
    s_mov_b32 s36, s24
    s_mov_b32 s37, s25
    s_mov_b32 s38, 0x1c0000
    s_mov_b32 s39, 0x00020000
    s_mov_b32 s44, s16
    s_mov_b32 s45, s17
    s_mov_b32 s46, 0x80000
    s_mov_b32 s47, 0x00020000
    v_pk_mul_f32 v[16:17], v[128:129], v[128:129]
    v_pk_mul_f32 v[18:19], v[130:131], v[130:131]
    v_pk_mul_f32 v[20:21], v[132:133], v[132:133]
    v_pk_mul_f32 v[22:23], v[134:135], v[134:135]
    v_pk_fma_f32 v[16:17], v[16:17], v[248:249], v[248:249] op_sel:[0,1,0] op_sel_hi:[1,1,0]
    v_pk_fma_f32 v[18:19], v[18:19], v[248:249], v[248:249] op_sel:[0,1,0] op_sel_hi:[1,1,0]
    v_pk_fma_f32 v[20:21], v[20:21], v[248:249], v[248:249] op_sel:[0,1,0] op_sel_hi:[1,1,0]
    v_pk_fma_f32 v[22:23], v[22:23], v[248:249], v[248:249] op_sel:[0,1,0] op_sel_hi:[1,1,0]
    v_pk_mul_f32 v[16:17], v[16:17], v[128:129]
    v_pk_mul_f32 v[18:19], v[18:19], v[130:131]
    v_pk_mul_f32 v[20:21], v[20:21], v[132:133]
    v_pk_mul_f32 v[22:23], v[22:23], v[134:135]
    v_exp_f32 v16, v16
    v_exp_f32 v17, v17
    v_pk_mul_f32 v[128:129], v[128:129], v[136:137]
    v_exp_f32 v18, v18
    v_exp_f32 v19, v19
    v_pk_mul_f32 v[130:131], v[130:131], v[138:139]
    v_exp_f32 v20, v20
    v_exp_f32 v21, v21
    v_pk_mul_f32 v[132:133], v[132:133], v[140:141]
    v_exp_f32 v22, v22
    v_exp_f32 v23, v23
    v_pk_mul_f32 v[134:135], v[134:135], v[142:143]
    v_pk_add_f32 v[16:17], v[16:17], v[250:251] op_sel_hi:[1,0]
    v_pk_add_f32 v[18:19], v[18:19], v[250:251] op_sel_hi:[1,0]
    v_pk_add_f32 v[20:21], v[20:21], v[250:251] op_sel_hi:[1,0]
    v_pk_add_f32 v[22:23], v[22:23], v[250:251] op_sel_hi:[1,0]
    v_rcp_f32 v16, v16
    v_rcp_f32 v17, v17
    v_rcp_f32 v18, v18
    v_rcp_f32 v19, v19
    v_rcp_f32 v20, v20
    v_rcp_f32 v21, v21
    v_rcp_f32 v22, v22
    v_rcp_f32 v23, v23
    v_pk_mul_f32 v[128:129], v[128:129], v[16:17]
    v_pk_mul_f32 v[130:131], v[130:131], v[18:19]
    v_pk_mul_f32 v[132:133], v[132:133], v[20:21]
    v_pk_mul_f32 v[134:135], v[134:135], v[22:23]
    v_cvt_pk_bf16_f32 v40, v128, v129
    v_cvt_pk_bf16_f32 v41, v130, v131
    v_cvt_pk_bf16_f32 v42, v132, v133
    v_cvt_pk_bf16_f32 v43, v134, v135
    v_pk_mul_f32 v[16:17], v[144:145], v[144:145]
    v_pk_mul_f32 v[18:19], v[146:147], v[146:147]
    v_pk_mul_f32 v[20:21], v[148:149], v[148:149]
    v_pk_mul_f32 v[22:23], v[150:151], v[150:151]
    v_pk_fma_f32 v[16:17], v[16:17], v[248:249], v[248:249] op_sel:[0,1,0] op_sel_hi:[1,1,0]
    v_pk_fma_f32 v[18:19], v[18:19], v[248:249], v[248:249] op_sel:[0,1,0] op_sel_hi:[1,1,0]
    v_pk_fma_f32 v[20:21], v[20:21], v[248:249], v[248:249] op_sel:[0,1,0] op_sel_hi:[1,1,0]
    v_pk_fma_f32 v[22:23], v[22:23], v[248:249], v[248:249] op_sel:[0,1,0] op_sel_hi:[1,1,0]
    v_pk_mul_f32 v[16:17], v[16:17], v[144:145]
    v_pk_mul_f32 v[18:19], v[18:19], v[146:147]
    v_pk_mul_f32 v[20:21], v[20:21], v[148:149]
    v_pk_mul_f32 v[22:23], v[22:23], v[150:151]
    v_exp_f32 v16, v16
    v_exp_f32 v17, v17
    v_pk_mul_f32 v[144:145], v[144:145], v[152:153]
    v_exp_f32 v18, v18
    v_exp_f32 v19, v19
    v_pk_mul_f32 v[146:147], v[146:147], v[154:155]
    v_exp_f32 v20, v20
    v_exp_f32 v21, v21
    v_pk_mul_f32 v[148:149], v[148:149], v[156:157]
    v_exp_f32 v22, v22
    v_exp_f32 v23, v23
    v_pk_mul_f32 v[150:151], v[150:151], v[158:159]
    v_pk_add_f32 v[16:17], v[16:17], v[250:251] op_sel_hi:[1,0]
    v_pk_add_f32 v[18:19], v[18:19], v[250:251] op_sel_hi:[1,0]
    v_pk_add_f32 v[20:21], v[20:21], v[250:251] op_sel_hi:[1,0]
    v_pk_add_f32 v[22:23], v[22:23], v[250:251] op_sel_hi:[1,0]
    v_rcp_f32 v16, v16
    v_rcp_f32 v17, v17
    v_rcp_f32 v18, v18
    v_rcp_f32 v19, v19
    v_rcp_f32 v20, v20
    v_rcp_f32 v21, v21
    v_rcp_f32 v22, v22
    v_rcp_f32 v23, v23
    v_pk_mul_f32 v[144:145], v[144:145], v[16:17]
    v_pk_mul_f32 v[146:147], v[146:147], v[18:19]
    v_pk_mul_f32 v[148:149], v[148:149], v[20:21]
    v_pk_mul_f32 v[150:151], v[150:151], v[22:23]
    v_cvt_pk_bf16_f32 v44, v144, v145
    v_cvt_pk_bf16_f32 v45, v146, v147
    v_cvt_pk_bf16_f32 v46, v148, v149
    v_cvt_pk_bf16_f32 v47, v150, v151
    v_pk_mul_f32 v[16:17], v[160:161], v[160:161]
    v_pk_mul_f32 v[18:19], v[162:163], v[162:163]
    v_pk_mul_f32 v[20:21], v[164:165], v[164:165]
    v_pk_mul_f32 v[22:23], v[166:167], v[166:167]
    v_pk_fma_f32 v[16:17], v[16:17], v[248:249], v[248:249] op_sel:[0,1,0] op_sel_hi:[1,1,0]
    v_pk_fma_f32 v[18:19], v[18:19], v[248:249], v[248:249] op_sel:[0,1,0] op_sel_hi:[1,1,0]
    v_pk_fma_f32 v[20:21], v[20:21], v[248:249], v[248:249] op_sel:[0,1,0] op_sel_hi:[1,1,0]
    v_pk_fma_f32 v[22:23], v[22:23], v[248:249], v[248:249] op_sel:[0,1,0] op_sel_hi:[1,1,0]
    v_pk_mul_f32 v[16:17], v[16:17], v[160:161]
    v_pk_mul_f32 v[18:19], v[18:19], v[162:163]
    v_pk_mul_f32 v[20:21], v[20:21], v[164:165]
    v_pk_mul_f32 v[22:23], v[22:23], v[166:167]
    v_exp_f32 v16, v16
    v_exp_f32 v17, v17
    v_pk_mul_f32 v[160:161], v[160:161], v[168:169]
    v_exp_f32 v18, v18
    v_exp_f32 v19, v19
    v_pk_mul_f32 v[162:163], v[162:163], v[170:171]
    v_exp_f32 v20, v20
    v_exp_f32 v21, v21
    v_pk_mul_f32 v[164:165], v[164:165], v[172:173]
    v_exp_f32 v22, v22
    v_exp_f32 v23, v23
    v_pk_mul_f32 v[166:167], v[166:167], v[174:175]
    v_pk_add_f32 v[16:17], v[16:17], v[250:251] op_sel_hi:[1,0]
    v_pk_add_f32 v[18:19], v[18:19], v[250:251] op_sel_hi:[1,0]
    v_pk_add_f32 v[20:21], v[20:21], v[250:251] op_sel_hi:[1,0]
    v_pk_add_f32 v[22:23], v[22:23], v[250:251] op_sel_hi:[1,0]
    v_rcp_f32 v16, v16
    v_rcp_f32 v17, v17
    v_rcp_f32 v18, v18
    v_rcp_f32 v19, v19
    v_rcp_f32 v20, v20
    v_rcp_f32 v21, v21
    v_rcp_f32 v22, v22
    v_rcp_f32 v23, v23
L_pad_x592:
    s_cbranch_execz L_ret_x592
    v_pk_mul_f32 v[160:161], v[160:161], v[16:17]
    v_pk_mul_f32 v[162:163], v[162:163], v[18:19]
    v_pk_mul_f32 v[164:165], v[164:165], v[20:21]
    v_pk_mul_f32 v[166:167], v[166:167], v[22:23]
    v_cvt_pk_bf16_f32 v48, v160, v161
    v_cvt_pk_bf16_f32 v49, v162, v163
    v_cvt_pk_bf16_f32 v50, v164, v165
    v_cvt_pk_bf16_f32 v51, v166, v167
    v_pk_mul_f32 v[16:17], v[176:177], v[176:177]
    v_pk_mul_f32 v[18:19], v[178:179], v[178:179]
    v_pk_mul_f32 v[20:21], v[180:181], v[180:181]
    v_pk_mul_f32 v[22:23], v[182:183], v[182:183]
    v_pk_fma_f32 v[16:17], v[16:17], v[248:249], v[248:249] op_sel:[0,1,0] op_sel_hi:[1,1,0]
    v_pk_fma_f32 v[18:19], v[18:19], v[248:249], v[248:249] op_sel:[0,1,0] op_sel_hi:[1,1,0]
    v_pk_fma_f32 v[20:21], v[20:21], v[248:249], v[248:249] op_sel:[0,1,0] op_sel_hi:[1,1,0]
    v_pk_fma_f32 v[22:23], v[22:23], v[248:249], v[248:249] op_sel:[0,1,0] op_sel_hi:[1,1,0]
    v_pk_mul_f32 v[16:17], v[16:17], v[176:177]
    v_pk_mul_f32 v[18:19], v[18:19], v[178:179]
    v_pk_mul_f32 v[20:21], v[20:21], v[180:181]
    v_pk_mul_f32 v[22:23], v[22:23], v[182:183]
    v_exp_f32 v16, v16
    v_exp_f32 v17, v17
    v_pk_mul_f32 v[176:177], v[176:177], v[184:185]
    v_exp_f32 v18, v18
    v_exp_f32 v19, v19
    v_pk_mul_f32 v[178:179], v[178:179], v[186:187]
    v_exp_f32 v20, v20
    v_exp_f32 v21, v21
    v_pk_mul_f32 v[180:181], v[180:181], v[188:189]
    v_exp_f32 v22, v22
    v_exp_f32 v23, v23
    v_pk_mul_f32 v[182:183], v[182:183], v[190:191]
    v_pk_add_f32 v[16:17], v[16:17], v[250:251] op_sel_hi:[1,0]
    v_pk_add_f32 v[18:19], v[18:19], v[250:251] op_sel_hi:[1,0]
    v_pk_add_f32 v[20:21], v[20:21], v[250:251] op_sel_hi:[1,0]
    v_pk_add_f32 v[22:23], v[22:23], v[250:251] op_sel_hi:[1,0]
    v_rcp_f32 v16, v16
    v_rcp_f32 v17, v17
    v_rcp_f32 v18, v18
    v_rcp_f32 v19, v19
    v_rcp_f32 v20, v20
    v_rcp_f32 v21, v21
    v_rcp_f32 v22, v22
    v_rcp_f32 v23, v23
    v_pk_mul_f32 v[176:177], v[176:177], v[16:17]
    v_pk_mul_f32 v[178:179], v[178:179], v[18:19]
    v_pk_mul_f32 v[180:181], v[180:181], v[20:21]
    v_pk_mul_f32 v[182:183], v[182:183], v[22:23]
    v_cvt_pk_bf16_f32 v52, v176, v177
    v_cvt_pk_bf16_f32 v53, v178, v179
    v_cvt_pk_bf16_f32 v54, v180, v181
    v_cvt_pk_bf16_f32 v55, v182, v183
    s_mov_b32 s57, s53
    s_lshl_b32 s64, s48, 10
    s_add_u32 s64, s64, 40960
    v_mov_b64 v[16:17], -1
    v_mov_b64 v[18:19], -1
    v_mov_b32 v20, 16
    s_mov_b32 s62, 1048576
L_lw_14:
    ds_read_b32 v15, v14 offset:0
    s_waitcnt lgkmcnt(0)
    v_readfirstlane_b32 s63, v15
    s_sub_u32 s62, s62, 1
    s_nop 2
    s_cmp_ge_u32 s63, 4
    s_cbranch_scc1 L_lwd_15
    s_sleep 1
    s_cmp_lg_u32 s62, 0
    s_cbranch_scc1 L_lw_14
L_lwd_15:
    s_setprio 0
    s_add_u32 m0, s64, 0
    s_add_u32 s61, s64, 4194304
    buffer_load_dwordx4 v6, s[40:43], s61 offen sc1 lds
    s_add_u32 m0, s64, 4096
    s_add_u32 s61, s64, 4198400
    buffer_load_dwordx4 v6, s[40:43], s61 offen sc1 lds
    s_add_u32 m0, s64, 8192
    s_add_u32 s61, s64, 4202496
    buffer_load_dwordx4 v6, s[40:43], s61 offen sc1 lds
    s_add_u32 m0, s64, 12288
    s_add_u32 s61, s64, 4206592
    buffer_load_dwordx4 v6, s[40:43], s61 offen sc1 lds
    s_add_u32 m0, s64, 16384
    s_add_u32 s61, s64, 4210688
    buffer_load_dwordx4 v6, s[40:43], s61 offen sc1 lds
    s_add_u32 m0, s64, 20480
    s_add_u32 s61, s64, 4214784
    buffer_load_dwordx4 v6, s[40:43], s61 offen sc1 lds
    s_add_u32 m0, s64, 24576
    s_add_u32 s61, s64, 4218880
    buffer_load_dwordx4 v6, s[40:43], s61 offen sc1 lds
    s_add_u32 m0, s64, 28672
    s_add_u32 s61, s64, 4222976
    buffer_load_dwordx4 v6, s[40:43], s61 offen sc1 lds
    s_add_u32 m0, s64, 32768
    s_add_u32 s61, s64, 4227072
    buffer_load_dwordx4 v6, s[40:43], s61 offen sc1 lds
    s_add_u32 m0, s64, 36864
    s_add_u32 s61, s64, 4231168
    buffer_load_dwordx4 v6, s[40:43], s61 offen sc1 lds
    s_add_u32 m0, s64, 40960
    s_add_u32 s61, s64, 4235264
    buffer_load_dwordx4 v6, s[40:43], s61 offen sc1 lds
    buffer_store_dwordx4 v[40:43], v6, s[40:43], s98 offen offset:0 sc1
    buffer_store_dwordx4 v[44:47], v6, s[40:43], s98 offen offset:1024 sc1
    buffer_store_dwordx4 v[48:51], v6, s[40:43], s99 offen offset:0 sc1
    buffer_store_dwordx4 v[52:55], v6, s[40:43], s99 offen offset:1024 sc1
    buffer_store_dwordx4 v[16:19], v6, s[40:43], s74 offen offset:0 sc1
    buffer_store_dwordx4 v[16:19], v6, s[40:43], s74 offen offset:1024 sc1
    s_waitcnt vmcnt(6)
    s_mov_b64 exec, 1
    ds_add_u32 v14, v1 offset:4
    s_mov_b64 exec, -1
    s_cmp_lg_u32 s77, 0
    s_cbranch_scc1 L_noh0_16
    buffer_store_dwordx4 v[24:27], v6, s[40:43], s75 offen offset:0 sc1
    buffer_store_dwordx4 v[28:31], v6, s[40:43], s75 offen offset:1024 sc1
    buffer_store_dwordx4 v[32:35], v6, s[40:43], s76 offen offset:0 sc1
    buffer_store_dwordx4 v[36:39], v6, s[40:43], s76 offen offset:1024 sc1
L_noh0_16:
    s_add_u32 m0, s71, 0
    s_lshl_b32 s58, s50, 1
    s_xor_b32 s58, s58, s54
    s_xor_b32 s58, s58, 3
    s_lshl2_add_u32 s58, s51, s58
    s_lshl_b32 s58, s58, 16
    buffer_load_dwordx4 v2, s[44:47], s58 offen lds
    buffer_load_dwordx4 v3, s[44:47], s58 offen offset:1024 lds
    s_add_u32 m0, s71, 2048
    s_add_u32 s58, s58, 16384
    buffer_load_dwordx4 v2, s[44:47], s58 offen lds
    buffer_load_dwordx4 v3, s[44:47], s58 offen offset:1024 lds
    s_add_u32 m0, s71, 4096
    s_add_u32 s58, s58, 16384
    buffer_load_dwordx4 v2, s[44:47], s58 offen lds
    buffer_load_dwordx4 v3, s[44:47], s58 offen offset:1024 lds
    s_waitcnt vmcnt(6)
    s_mov_b64 exec, 1
    buffer_store_dword v12, v13, s[40:43], s67 offen sc1
    buffer_store_dword v12, v13, s[40:43], s72 offen sc1
    s_mov_b64 exec, -1
    s_add_u32 m0, s71, 6144
    s_add_u32 s58, s58, 16384
    buffer_load_dwordx4 v2, s[44:47], s58 offen lds
    buffer_load_dwordx4 v3, s[44:47], s58 offen offset:1024 lds
    s_add_u32 m0, s71, 8192
    s_lshl_b32 s58, s50, 1
    s_xor_b32 s58, s58, s54
    s_xor_b32 s58, s58, 2
    s_lshl2_add_u32 s58, s51, s58
    s_lshl_b32 s58, s58, 16
    buffer_load_dwordx4 v2, s[44:47], s58 offen lds
    buffer_load_dwordx4 v3, s[44:47], s58 offen offset:1024 lds
    s_add_u32 m0, s71, 10240
    s_add_u32 s58, s58, 16384
    buffer_load_dwordx4 v2, s[44:47], s58 offen lds
    buffer_load_dwordx4 v3, s[44:47], s58 offen offset:1024 lds
    s_add_u32 m0, s71, 12288
    s_add_u32 s58, s58, 16384
    buffer_load_dwordx4 v2, s[44:47], s58 offen lds
    buffer_load_dwordx4 v3, s[44:47], s58 offen offset:1024 lds
    s_add_u32 m0, s71, 14336
    s_add_u32 s58, s58, 16384
    buffer_load_dwordx4 v2, s[44:47], s58 offen lds
    buffer_load_dwordx4 v3, s[44:47], s58 offen offset:1024 lds
    s_mov_b64 exec, 0
    s_cmp_eq_u32 s48, 0
    s_cbranch_scc1 L_pad_x677
    s_cmp_eq_u32 s48, 1
    s_cbranch_scc1 L_pad_x761
    s_cmp_eq_u32 s48, 2
    s_cbranch_scc1 L_pad_rare
    s_cmp_eq_u32 s48, 3
    s_cbranch_scc1 L_pad_ogen
    s_branch L_warmed_g
L_ret_x677:
    s_branch L_warmed_g
L_ret_x761:
    s_branch L_warmed_g
L_ret_rare:
    s_branch L_warmed_g
L_ret_ogen:
    s_branch L_warmed_g
L_warmed_g:
    s_mov_b64 exec, -1
    s_waitcnt vmcnt(0)
    s_mov_b64 exec, 1
    ds_add_u32 v14, v1 offset:12
    s_mov_b64 exec, -1
    s_setprio 2
    s_mov_b32 s62, 1048576
L_lw_17:
    ds_read_b32 v15, v14 offset:12
    s_waitcnt lgkmcnt(0)
    v_readfirstlane_b32 s63, v15
    s_sub_u32 s62, s62, 1
    s_nop 2
    s_cmp_ge_u32 s63, 4
    s_cbranch_scc1 L_lwd_18
    s_sleep 3
    s_cmp_lg_u32 s62, 0
    s_cbranch_scc1 L_lw_17
L_lwd_18:
    s_setprio 0
    ds_read_b64_tr_b16 v[80:81], v56 offset:0
    ds_read_b64_tr_b16 v[82:83], v56 offset:1024
    ds_read_b64_tr_b16 v[84:85], v57 offset:0
    ds_read_b64_tr_b16 v[86:87], v57 offset:1024
    ds_read_b64_tr_b16 v[88:89], v58 offset:0
    ds_read_b64_tr_b16 v[90:91], v58 offset:1024
    ds_read_b64_tr_b16 v[92:93], v59 offset:0
    ds_read_b64_tr_b16 v[94:95], v59 offset:1024
    ds_read_b64_tr_b16 v[96:97], v56 offset:4096
    ds_read_b64_tr_b16 v[98:99], v56 offset:5120
    ds_read_b64_tr_b16 v[100:101], v57 offset:4096
    ds_read_b64_tr_b16 v[102:103], v57 offset:5120
    ds_read_b64_tr_b16 v[104:105], v58 offset:4096
    ds_read_b64_tr_b16 v[106:107], v58 offset:5120
    ds_read_b64_tr_b16 v[108:109], v59 offset:4096
    ds_read_b64_tr_b16 v[110:111], v59 offset:5120
    ds_read_b64_tr_b16 v[112:113], v56 offset:8192
    ds_read_b64_tr_b16 v[114:115], v56 offset:9216
    ds_read_b64_tr_b16 v[116:117], v57 offset:8192
    ds_read_b64_tr_b16 v[118:119], v57 offset:9216
    ds_read_b64_tr_b16 v[120:121], v58 offset:8192
    ds_read_b64_tr_b16 v[122:123], v58 offset:9216
    ds_read_b64_tr_b16 v[124:125], v59 offset:8192
    ds_read_b64_tr_b16 v[126:127], v59 offset:9216
    ds_read_b64_tr_b16 v[128:129], v56 offset:12288
    ds_read_b64_tr_b16 v[130:131], v56 offset:13312
    ds_read_b64_tr_b16 v[132:133], v57 offset:12288
    ds_read_b64_tr_b16 v[134:135], v57 offset:13312
    ds_read_b64_tr_b16 v[136:137], v58 offset:12288
    ds_read_b64_tr_b16 v[138:139], v58 offset:13312
    ds_read_b64_tr_b16 v[140:141], v59 offset:12288
    ds_read_b64_tr_b16 v[142:143], v59 offset:13312
    ds_read_b64_tr_b16 v[144:145], v56 offset:16384
    ds_read_b64_tr_b16 v[146:147], v56 offset:17408
    ds_read_b64_tr_b16 v[148:149], v57 offset:16384
    ds_read_b64_tr_b16 v[150:151], v57 offset:17408
    ds_read_b64_tr_b16 v[152:153], v58 offset:16384
    ds_read_b64_tr_b16 v[154:155], v58 offset:17408
    ds_read_b64_tr_b16 v[156:157], v59 offset:16384
    ds_read_b64_tr_b16 v[158:159], v59 offset:17408
    ds_read_b64_tr_b16 v[160:161], v56 offset:20480
    ds_read_b64_tr_b16 v[162:163], v56 offset:21504
    ds_read_b64_tr_b16 v[164:165], v57 offset:20480
    ds_read_b64_tr_b16 v[166:167], v57 offset:21504
    ds_read_b64_tr_b16 v[168:169], v58 offset:20480
    ds_read_b64_tr_b16 v[170:171], v58 offset:21504
    ds_read_b64_tr_b16 v[172:173], v59 offset:20480
    ds_read_b64_tr_b16 v[174:175], v59 offset:21504
    ds_read_b64_tr_b16 v[176:177], v56 offset:24576
    ds_read_b64_tr_b16 v[178:179], v56 offset:25600
    ds_read_b64_tr_b16 v[180:181], v57 offset:24576
    ds_read_b64_tr_b16 v[182:183], v57 offset:25600
    ds_read_b64_tr_b16 v[184:185], v58 offset:24576
    ds_read_b64_tr_b16 v[186:187], v58 offset:25600
    ds_read_b64_tr_b16 v[188:189], v59 offset:24576
    ds_read_b64_tr_b16 v[190:191], v59 offset:25600
    ds_read_b64_tr_b16 v[192:193], v56 offset:28672
    ds_read_b64_tr_b16 v[194:195], v56 offset:29696
    ds_read_b64_tr_b16 v[196:197], v57 offset:28672
    ds_read_b64_tr_b16 v[198:199], v57 offset:29696
    ds_read_b64_tr_b16 v[200:201], v58 offset:28672
    ds_read_b64_tr_b16 v[202:203], v58 offset:29696
    ds_read_b64_tr_b16 v[204:205], v59 offset:28672
    ds_read_b64_tr_b16 v[206:207], v59 offset:29696
    s_waitcnt lgkmcnt(0)
    s_mov_b64 exec, 1
    ds_add_u32 v14, v1 offset:12
    s_mov_b64 exec, -1
    s_setprio 2
    s_mov_b32 s62, 1048576
L_lw_19:
    ds_read_b32 v15, v14 offset:12
    s_waitcnt lgkmcnt(0)
    v_readfirstlane_b32 s63, v15
    s_sub_u32 s62, s62, 1
    s_nop 2
    s_cmp_ge_u32 s63, 8
    s_cbranch_scc1 L_lwd_20
    s_sleep 3
    s_cmp_lg_u32 s62, 0
    s_cbranch_scc1 L_lw_19
L_lwd_20:
    s_setprio 0
    s_add_u32 m0, s64, 45056
    s_add_u32 s61, s64, 4239360
    buffer_load_dwordx4 v6, s[40:43], s61 offen sc1 lds
    s_add_u32 m0, s64, 49152
    s_add_u32 s61, s64, 4243456
    buffer_load_dwordx4 v6, s[40:43], s61 offen sc1 lds
    s_add_u32 m0, s64, 53248
    s_add_u32 s61, s64, 4247552
    buffer_load_dwordx4 v6, s[40:43], s61 offen sc1 lds
    s_add_u32 m0, s64, 57344
    s_add_u32 s61, s64, 4251648
    buffer_load_dwordx4 v6, s[40:43], s61 offen sc1 lds
    s_add_u32 m0, s64, 61440
    s_add_u32 s61, s64, 4255744
    buffer_load_dwordx4 v6, s[40:43], s61 offen sc1 lds
    s_add_u32 m0, s64, 65536
    s_add_u32 s61, s64, 4259840
    buffer_load_dwordx4 v6, s[40:43], s61 offen sc1 lds
    s_add_u32 m0, s64, 69632
    s_add_u32 s61, s64, 4263936
    buffer_load_dwordx4 v6, s[40:43], s61 offen sc1 lds
    s_add_u32 m0, s64, 73728
    s_add_u32 s61, s64, 4268032
    buffer_load_dwordx4 v6, s[40:43], s61 offen sc1 lds
    s_add_u32 m0, s64, 77824
    s_add_u32 s61, s64, 4272128
    buffer_load_dwordx4 v6, s[40:43], s61 offen sc1 lds
    s_add_u32 m0, s64, 81920
    s_add_u32 s61, s64, 4276224
    buffer_load_dwordx4 v6, s[40:43], s61 offen sc1 lds
    s_add_u32 m0, s64, 86016
    s_add_u32 s61, s64, 4280320
    buffer_load_dwordx4 v6, s[40:43], s61 offen sc1 lds
    s_add_u32 m0, s64, 90112
    s_add_u32 s61, s64, 4284416
    buffer_load_dwordx4 v6, s[40:43], s61 offen sc1 lds
    s_waitcnt vmcnt(0)
    s_mov_b64 exec, 1
    ds_add_u32 v14, v20 offset:4
    s_mov_b64 exec, -1
    s_setprio 2
    s_mov_b32 s62, 131072
L_poll_21:
    buffer_load_dword v15, v11, s[40:43], s66 offen sc1
    s_waitcnt vmcnt(0)
    v_cmp_ne_u32 vcc, s4, v15
    s_sub_u32 s62, s62, 1
    s_cmp_lg_u32 s62, 0
    s_nop 2
    s_cbranch_vccz L_polled_22
    s_sleep 2
    s_cbranch_scc1 L_poll_21
L_polled_22:
    v_xor_b32 v12, 64, v4
    v_xor_b32 v13, 96, v4
    s_setprio 0
    s_add_u32 m0, s49, 0
    s_lshl4_add_u32 s56, s53, s55
    buffer_load_dwordx4 v2, s[36:39], s56 offen lds
    buffer_load_dwordx4 v3, s[36:39], s56 offen offset:1024 lds
    buffer_load_dwordx4 v[208:211], v7, s[40:43], s57 offen offset:0 sc1
    buffer_load_dwordx4 v[212:215], v7, s[40:43], s57 offen offset:1024 sc1
    s_add_u32 m0, s49, 2048
    s_add_u32 s56, s56, 16384
    buffer_load_dwordx4 v2, s[36:39], s56 offen lds
    buffer_load_dwordx4 v3, s[36:39], s56 offen offset:1024 lds
    buffer_load_dwordx4 v[216:219], v8, s[40:43], s57 offen offset:0 sc1
    buffer_load_dwordx4 v[220:223], v8, s[40:43], s57 offen offset:1024 sc1
    s_add_u32 m0, s49, 4096
    s_add_u32 s56, s56, 16384
    buffer_load_dwordx4 v2, s[36:39], s56 offen lds
    buffer_load_dwordx4 v3, s[36:39], s56 offen offset:1024 lds
    buffer_load_dwordx4 v[224:227], v7, s[40:43], s57 offen offset:2048 sc1
    buffer_load_dwordx4 v[228:231], v7, s[40:43], s57 offen offset:3072 sc1
    buffer_load_dwordx4 v[232:235], v8, s[40:43], s57 offen offset:2048 sc1
    buffer_load_dwordx4 v[236:239], v8, s[40:43], s57 offen offset:3072 sc1
    s_add_u32 s57, s57, 4096
    s_cmp_ge_u32 s57, 28672
    s_cselect_b32 s57, 0, s57
    s_waitcnt vmcnt(12)
    ds_read_b64_tr_b16 v[240:241], v4 offset:0
    ds_read_b64_tr_b16 v[244:245], v5 offset:0
    ds_read_b64_tr_b16 v[248:249], v12 offset:0
    ds_read_b64_tr_b16 v[252:253], v13 offset:0
    s_waitcnt lgkmcnt(0)
    s_add_u32 m0, s49, 0
    s_add_u32 s56, s56, 16384
    buffer_load_dwordx4 v2, s[36:39], s56 offen lds
    buffer_load_dwordx4 v3, s[36:39], s56 offen offset:1024 lds
    s_add_u32 s53, s53, 4096
    s_cmp_ge_u32 s53, 28672
    s_cselect_b32 s53, 0, s53
    s_waitcnt vmcnt(8)
    ds_read_b64_tr_b16 v[242:243], v4 offset:2048
    ds_read_b64_tr_b16 v[246:247], v5 offset:2048
    ds_read_b64_tr_b16 v[250:251], v12 offset:2048
    ds_read_b64_tr_b16 v[254:255], v13 offset:2048
    s_waitcnt lgkmcnt(3)
    v_mfma_f32_16x16x32_bf16 v[16:19], v[240:243], v[208:211], 0
    v_mfma_f32_16x16x32_bf16 v[24:27], v[240:243], v[212:215], 0
    v_mfma_f32_16x16x32_bf16 v[48:51], v[240:243], v[216:219], 0
    v_mfma_f32_16x16x32_bf16 v[56:59], v[240:243], v[220:223], 0
    s_waitcnt lgkmcnt(0)
    s_add_u32 m0, s49, 2048
    s_lshl4_add_u32 s56, s53, s55
    buffer_load_dwordx4 v2, s[36:39], s56 offen lds
    buffer_load_dwordx4 v3, s[36:39], s56 offen offset:1024 lds
    s_waitcnt vmcnt(8)
    ds_read_b64_tr_b16 v[240:241], v4 offset:4096
    v_mfma_f32_16x16x32_bf16 v[20:23], v[244:247], v[208:211], 0
    v_mfma_f32_16x16x32_bf16 v[28:31], v[244:247], v[212:215], 0
    v_mfma_f32_16x16x32_bf16 v[52:55], v[244:247], v[216:219], 0
    v_mfma_f32_16x16x32_bf16 v[60:63], v[244:247], v[220:223], 0
    ds_read_b64_tr_b16 v[244:245], v5 offset:4096
    v_mfma_f32_16x16x32_bf16 v[32:35], v[248:251], v[208:211], 0
    v_mfma_f32_16x16x32_bf16 v[40:43], v[248:251], v[212:215], 0
    v_mfma_f32_16x16x32_bf16 v[64:67], v[248:251], v[216:219], 0
    v_mfma_f32_16x16x32_bf16 v[72:75], v[248:251], v[220:223], 0
    ds_read_b64_tr_b16 v[248:249], v12 offset:4096
    v_mfma_f32_16x16x32_bf16 v[36:39], v[252:255], v[208:211], 0
    v_mfma_f32_16x16x32_bf16 v[44:47], v[252:255], v[212:215], 0
    v_mfma_f32_16x16x32_bf16 v[68:71], v[252:255], v[216:219], 0
    v_mfma_f32_16x16x32_bf16 v[76:79], v[252:255], v[220:223], 0
    ds_read_b64_tr_b16 v[252:253], v13 offset:4096
    buffer_load_dwordx4 v[208:211], v7, s[40:43], s57 offen offset:0 sc1
    buffer_load_dwordx4 v[212:215], v7, s[40:43], s57 offen offset:1024 sc1
    buffer_load_dwordx4 v[216:219], v8, s[40:43], s57 offen offset:0 sc1
    buffer_load_dwordx4 v[220:223], v8, s[40:43], s57 offen offset:1024 sc1
    s_waitcnt lgkmcnt(0)
    s_add_u32 m0, s49, 4096
    s_add_u32 s56, s56, 16384
    buffer_load_dwordx4 v2, s[36:39], s56 offen lds
    buffer_load_dwordx4 v3, s[36:39], s56 offen offset:1024 lds
    s_waitcnt vmcnt(8)
    ds_read_b64_tr_b16 v[242:243], v4 offset:0
    ds_read_b64_tr_b16 v[246:247], v5 offset:0
    ds_read_b64_tr_b16 v[250:251], v12 offset:0
    ds_read_b64_tr_b16 v[254:255], v13 offset:0
    s_waitcnt lgkmcnt(3)
    v_mfma_f32_16x16x32_bf16 v[16:19], v[240:243], v[224:227], v[16:19]
    v_mfma_f32_16x16x32_bf16 v[24:27], v[240:243], v[228:231], v[24:27]
    v_mfma_f32_16x16x32_bf16 v[48:51], v[240:243], v[232:235], v[48:51]
    v_mfma_f32_16x16x32_bf16 v[56:59], v[240:243], v[236:239], v[56:59]
    s_waitcnt lgkmcnt(0)
    s_add_u32 m0, s49, 0
    s_add_u32 s56, s56, 16384
    buffer_load_dwordx4 v2, s[36:39], s56 offen lds
    buffer_load_dwordx4 v3, s[36:39], s56 offen offset:1024 lds
    s_waitcnt vmcnt(8)
    ds_read_b64_tr_b16 v[240:241], v4 offset:2048
    v_mfma_f32_16x16x32_bf16 v[20:23], v[244:247], v[224:227], v[20:23]
    v_mfma_f32_16x16x32_bf16 v[28:31], v[244:247], v[228:231], v[28:31]
    v_mfma_f32_16x16x32_bf16 v[52:55], v[244:247], v[232:235], v[52:55]
    v_mfma_f32_16x16x32_bf16 v[60:63], v[244:247], v[236:239], v[60:63]
    ds_read_b64_tr_b16 v[244:245], v5 offset:2048
    v_mfma_f32_16x16x32_bf16 v[32:35], v[248:251], v[224:227], v[32:35]
    v_mfma_f32_16x16x32_bf16 v[40:43], v[248:251], v[228:231], v[40:43]
    v_mfma_f32_16x16x32_bf16 v[64:67], v[248:251], v[232:235], v[64:67]
    v_mfma_f32_16x16x32_bf16 v[72:75], v[248:251], v[236:239], v[72:75]
    ds_read_b64_tr_b16 v[248:249], v12 offset:2048
    v_mfma_f32_16x16x32_bf16 v[36:39], v[252:255], v[224:227], v[36:39]
    v_mfma_f32_16x16x32_bf16 v[44:47], v[252:255], v[228:231], v[44:47]
    v_mfma_f32_16x16x32_bf16 v[68:71], v[252:255], v[232:235], v[68:71]
    v_mfma_f32_16x16x32_bf16 v[76:79], v[252:255], v[236:239], v[76:79]
    ds_read_b64_tr_b16 v[252:253], v13 offset:2048
    buffer_load_dwordx4 v[224:227], v7, s[40:43], s57 offen offset:2048 sc1
    buffer_load_dwordx4 v[228:231], v7, s[40:43], s57 offen offset:3072 sc1
    buffer_load_dwordx4 v[232:235], v8, s[40:43], s57 offen offset:2048 sc1
    buffer_load_dwordx4 v[236:239], v8, s[40:43], s57 offen offset:3072 sc1
    s_add_u32 s57, s57, 4096
    s_cmp_ge_u32 s57, 28672
    s_cselect_b32 s57, 0, s57
    s_waitcnt lgkmcnt(0)
    s_add_u32 m0, s49, 2048
    s_add_u32 s56, s56, 16384
    buffer_load_dwordx4 v2, s[36:39], s56 offen lds
    buffer_load_dwordx4 v3, s[36:39], s56 offen offset:1024 lds
    s_add_u32 s53, s53, 4096
    s_cmp_ge_u32 s53, 28672
    s_cselect_b32 s53, 0, s53
    s_waitcnt vmcnt(8)
    ds_read_b64_tr_b16 v[242:243], v4 offset:4096
    ds_read_b64_tr_b16 v[246:247], v5 offset:4096
    ds_read_b64_tr_b16 v[250:251], v12 offset:4096
    ds_read_b64_tr_b16 v[254:255], v13 offset:4096
    s_waitcnt lgkmcnt(3)
    v_mfma_f32_16x16x32_bf16 v[16:19], v[240:243], v[208:211], v[16:19]
    v_mfma_f32_16x16x32_bf16 v[24:27], v[240:243], v[212:215], v[24:27]
    v_mfma_f32_16x16x32_bf16 v[48:51], v[240:243], v[216:219], v[48:51]
    v_mfma_f32_16x16x32_bf16 v[56:59], v[240:243], v[220:223], v[56:59]
    s_waitcnt lgkmcnt(0)
    s_add_u32 m0, s49, 4096
    s_lshl4_add_u32 s56, s53, s55
    buffer_load_dwordx4 v2, s[36:39], s56 offen lds
    buffer_load_dwordx4 v3, s[36:39], s56 offen offset:1024 lds
    s_waitcnt vmcnt(8)
    ds_read_b64_tr_b16 v[240:241], v4 offset:0
    v_mfma_f32_16x16x32_bf16 v[20:23], v[244:247], v[208:211], v[20:23]
    v_mfma_f32_16x16x32_bf16 v[28:31], v[244:247], v[212:215], v[28:31]
    v_mfma_f32_16x16x32_bf16 v[52:55], v[244:247], v[216:219], v[52:55]
    v_mfma_f32_16x16x32_bf16 v[60:63], v[244:247], v[220:223], v[60:63]
    ds_read_b64_tr_b16 v[244:245], v5 offset:0
    v_mfma_f32_16x16x32_bf16 v[32:35], v[248:251], v[208:211], v[32:35]
    v_mfma_f32_16x16x32_bf16 v[40:43], v[248:251], v[212:215], v[40:43]
    v_mfma_f32_16x16x32_bf16 v[64:67], v[248:251], v[216:219], v[64:67]
    v_mfma_f32_16x16x32_bf16 v[72:75], v[248:251], v[220:223], v[72:75]
    ds_read_b64_tr_b16 v[248:249], v12 offset:0
    v_mfma_f32_16x16x32_bf16 v[36:39], v[252:255], v[208:211], v[36:39]
    v_mfma_f32_16x16x32_bf16 v[44:47], v[252:255], v[212:215], v[44:47]
    v_mfma_f32_16x16x32_bf16 v[68:71], v[252:255], v[216:219], v[68:71]
    v_mfma_f32_16x16x32_bf16 v[76:79], v[252:255], v[220:223], v[76:79]
    ds_read_b64_tr_b16 v[252:253], v13 offset:0
    buffer_load_dwordx4 v[208:211], v7, s[40:43], s57 offen offset:0 sc1
    buffer_load_dwordx4 v[212:215], v7, s[40:43], s57 offen offset:1024 sc1
    buffer_load_dwordx4 v[216:219], v8, s[40:43], s57 offen offset:0 sc1
    buffer_load_dwordx4 v[220:223], v8, s[40:43], s57 offen offset:1024 sc1
    s_waitcnt lgkmcnt(0)
    s_add_u32 m0, s49, 0
    s_add_u32 s56, s56, 16384
    buffer_load_dwordx4 v2, s[36:39], s56 offen lds
    buffer_load_dwordx4 v3, s[36:39], s56 offen offset:1024 lds
    s_waitcnt vmcnt(8)
    ds_read_b64_tr_b16 v[242:243], v4 offset:2048
    ds_read_b64_tr_b16 v[246:247], v5 offset:2048
    ds_read_b64_tr_b16 v[250:251], v12 offset:2048
    ds_read_b64_tr_b16 v[254:255], v13 offset:2048
    s_waitcnt lgkmcnt(3)
    v_mfma_f32_16x16x32_bf16 v[16:19], v[240:243], v[224:227], v[16:19]
    v_mfma_f32_16x16x32_bf16 v[24:27], v[240:243], v[228:231], v[24:27]
    v_mfma_f32_16x16x32_bf16 v[48:51], v[240:243], v[232:235], v[48:51]
    v_mfma_f32_16x16x32_bf16 v[56:59], v[240:243], v[236:239], v[56:59]
    s_waitcnt lgkmcnt(0)
    s_add_u32 m0, s49, 2048
    s_add_u32 s56, s56, 16384
    buffer_load_dwordx4 v2, s[36:39], s56 offen lds
    buffer_load_dwordx4 v3, s[36:39], s56 offen offset:1024 lds
    s_waitcnt vmcnt(8)
    ds_read_b64_tr_b16 v[240:241], v4 offset:4096
    v_mfma_f32_16x16x32_bf16 v[20:23], v[244:247], v[224:227], v[20:23]
    v_mfma_f32_16x16x32_bf16 v[28:31], v[244:247], v[228:231], v[28:31]
    v_mfma_f32_16x16x32_bf16 v[52:55], v[244:247], v[232:235], v[52:55]
    v_mfma_f32_16x16x32_bf16 v[60:63], v[244:247], v[236:239], v[60:63]
    ds_read_b64_tr_b16 v[244:245], v5 offset:4096
    v_mfma_f32_16x16x32_bf16 v[32:35], v[248:251], v[224:227], v[32:35]
    v_mfma_f32_16x16x32_bf16 v[40:43], v[248:251], v[228:231], v[40:43]
    v_mfma_f32_16x16x32_bf16 v[64:67], v[248:251], v[232:235], v[64:67]
    v_mfma_f32_16x16x32_bf16 v[72:75], v[248:251], v[236:239], v[72:75]
    ds_read_b64_tr_b16 v[248:249], v12 offset:4096
    v_mfma_f32_16x16x32_bf16 v[36:39], v[252:255], v[224:227], v[36:39]
    v_mfma_f32_16x16x32_bf16 v[44:47], v[252:255], v[228:231], v[44:47]
    v_mfma_f32_16x16x32_bf16 v[68:71], v[252:255], v[232:235], v[68:71]
    v_mfma_f32_16x16x32_bf16 v[76:79], v[252:255], v[236:239], v[76:79]
    ds_read_b64_tr_b16 v[252:253], v13 offset:4096
    buffer_load_dwordx4 v[224:227], v7, s[40:43], s57 offen offset:2048 sc1
    buffer_load_dwordx4 v[228:231], v7, s[40:43], s57 offen offset:3072 sc1
    buffer_load_dwordx4 v[232:235], v8, s[40:43], s57 offen offset:2048 sc1
    buffer_load_dwordx4 v[236:239], v8, s[40:43], s57 offen offset:3072 sc1
    s_add_u32 s57, s57, 4096
    s_cmp_ge_u32 s57, 28672
    s_cselect_b32 s57, 0, s57
    s_waitcnt lgkmcnt(0)
    s_add_u32 m0, s49, 4096
    s_add_u32 s56, s56, 16384
    buffer_load_dwordx4 v2, s[36:39], s56 offen lds
    buffer_load_dwordx4 v3, s[36:39], s56 offen offset:1024 lds
    s_add_u32 s53, s53, 4096
    s_cmp_ge_u32 s53, 28672
    s_cselect_b32 s53, 0, s53
    s_waitcnt vmcnt(8)
    ds_read_b64_tr_b16 v[242:243], v4 offset:0
    ds_read_b64_tr_b16 v[246:247], v5 offset:0
    ds_read_b64_tr_b16 v[250:251], v12 offset:0
    ds_read_b64_tr_b16 v[254:255], v13 offset:0
    s_waitcnt lgkmcnt(3)
    v_mfma_f32_16x16x32_bf16 v[16:19], v[240:243], v[208:211], v[16:19]
    v_mfma_f32_16x16x32_bf16 v[24:27], v[240:243], v[212:215], v[24:27]
    v_mfma_f32_16x16x32_bf16 v[48:51], v[240:243], v[216:219], v[48:51]
    v_mfma_f32_16x16x32_bf16 v[56:59], v[240:243], v[220:223], v[56:59]
    s_waitcnt lgkmcnt(0)
    s_add_u32 m0, s49, 0
    s_lshl4_add_u32 s56, s53, s55
    buffer_load_dwordx4 v2, s[36:39], s56 offen lds
    buffer_load_dwordx4 v3, s[36:39], s56 offen offset:1024 lds
    s_waitcnt vmcnt(8)
    ds_read_b64_tr_b16 v[240:241], v4 offset:2048
    v_mfma_f32_16x16x32_bf16 v[20:23], v[244:247], v[208:211], v[20:23]
    v_mfma_f32_16x16x32_bf16 v[28:31], v[244:247], v[212:215], v[28:31]
    v_mfma_f32_16x16x32_bf16 v[52:55], v[244:247], v[216:219], v[52:55]
    v_mfma_f32_16x16x32_bf16 v[60:63], v[244:247], v[220:223], v[60:63]
    ds_read_b64_tr_b16 v[244:245], v5 offset:2048
    v_mfma_f32_16x16x32_bf16 v[32:35], v[248:251], v[208:211], v[32:35]
    v_mfma_f32_16x16x32_bf16 v[40:43], v[248:251], v[212:215], v[40:43]
    v_mfma_f32_16x16x32_bf16 v[64:67], v[248:251], v[216:219], v[64:67]
    v_mfma_f32_16x16x32_bf16 v[72:75], v[248:251], v[220:223], v[72:75]
    ds_read_b64_tr_b16 v[248:249], v12 offset:2048
    v_mfma_f32_16x16x32_bf16 v[36:39], v[252:255], v[208:211], v[36:39]
    v_mfma_f32_16x16x32_bf16 v[44:47], v[252:255], v[212:215], v[44:47]
    v_mfma_f32_16x16x32_bf16 v[68:71], v[252:255], v[216:219], v[68:71]
    v_mfma_f32_16x16x32_bf16 v[76:79], v[252:255], v[220:223], v[76:79]
    ds_read_b64_tr_b16 v[252:253], v13 offset:2048
    buffer_load_dwordx4 v[208:211], v7, s[40:43], s57 offen offset:0 sc1
    buffer_load_dwordx4 v[212:215], v7, s[40:43], s57 offen offset:1024 sc1
    buffer_load_dwordx4 v[216:219], v8, s[40:43], s57 offen offset:0 sc1
    buffer_load_dwordx4 v[220:223], v8, s[40:43], s57 offen offset:1024 sc1
    s_waitcnt lgkmcnt(0)
    s_add_u32 m0, s49, 2048
    s_add_u32 s56, s56, 16384
    buffer_load_dwordx4 v2, s[36:39], s56 offen lds
    buffer_load_dwordx4 v3, s[36:39], s56 offen offset:1024 lds
    s_waitcnt vmcnt(8)
    ds_read_b64_tr_b16 v[242:243], v4 offset:4096
    ds_read_b64_tr_b16 v[246:247], v5 offset:4096
    ds_read_b64_tr_b16 v[250:251], v12 offset:4096
    ds_read_b64_tr_b16 v[254:255], v13 offset:4096
    s_waitcnt lgkmcnt(3)
    v_mfma_f32_16x16x32_bf16 v[16:19], v[240:243], v[224:227], v[16:19]
    v_mfma_f32_16x16x32_bf16 v[24:27], v[240:243], v[228:231], v[24:27]
    v_mfma_f32_16x16x32_bf16 v[48:51], v[240:243], v[232:235], v[48:51]
    v_mfma_f32_16x16x32_bf16 v[56:59], v[240:243], v[236:239], v[56:59]
L_pad_x677:
    s_cbranch_execz L_ret_x677
    s_waitcnt lgkmcnt(0)
    s_add_u32 m0, s49, 4096
    s_add_u32 s56, s56, 16384
    buffer_load_dwordx4 v2, s[36:39], s56 offen lds
    buffer_load_dwordx4 v3, s[36:39], s56 offen offset:1024 lds
    s_waitcnt vmcnt(8)
    ds_read_b64_tr_b16 v[240:241], v4 offset:0
    v_mfma_f32_16x16x32_bf16 v[20:23], v[244:247], v[224:227], v[20:23]
    v_mfma_f32_16x16x32_bf16 v[28:31], v[244:247], v[228:231], v[28:31]
    v_mfma_f32_16x16x32_bf16 v[52:55], v[244:247], v[232:235], v[52:55]
    v_mfma_f32_16x16x32_bf16 v[60:63], v[244:247], v[236:239], v[60:63]
    ds_read_b64_tr_b16 v[244:245], v5 offset:0
    v_mfma_f32_16x16x32_bf16 v[32:35], v[248:251], v[224:227], v[32:35]
    v_mfma_f32_16x16x32_bf16 v[40:43], v[248:251], v[228:231], v[40:43]
    v_mfma_f32_16x16x32_bf16 v[64:67], v[248:251], v[232:235], v[64:67]
    v_mfma_f32_16x16x32_bf16 v[72:75], v[248:251], v[236:239], v[72:75]
    ds_read_b64_tr_b16 v[248:249], v12 offset:0
    v_mfma_f32_16x16x32_bf16 v[36:39], v[252:255], v[224:227], v[36:39]
    v_mfma_f32_16x16x32_bf16 v[44:47], v[252:255], v[228:231], v[44:47]
    v_mfma_f32_16x16x32_bf16 v[68:71], v[252:255], v[232:235], v[68:71]
    v_mfma_f32_16x16x32_bf16 v[76:79], v[252:255], v[236:239], v[76:79]
    ds_read_b64_tr_b16 v[252:253], v13 offset:0
    buffer_load_dwordx4 v[224:227], v7, s[40:43], s57 offen offset:2048 sc1
    buffer_load_dwordx4 v[228:231], v7, s[40:43], s57 offen offset:3072 sc1
    buffer_load_dwordx4 v[232:235], v8, s[40:43], s57 offen offset:2048 sc1
    buffer_load_dwordx4 v[236:239], v8, s[40:43], s57 offen offset:3072 sc1
    s_add_u32 s57, s57, 4096
    s_cmp_ge_u32 s57, 28672
    s_cselect_b32 s57, 0, s57
    s_waitcnt lgkmcnt(0)
    s_add_u32 m0, s49, 0
    s_add_u32 s56, s56, 16384
    buffer_load_dwordx4 v2, s[36:39], s56 offen lds
    buffer_load_dwordx4 v3, s[36:39], s56 offen offset:1024 lds
    s_add_u32 s53, s53, 4096
    s_cmp_ge_u32 s53, 28672
    s_cselect_b32 s53, 0, s53
    s_waitcnt vmcnt(8)
    ds_read_b64_tr_b16 v[242:243], v4 offset:2048
    ds_read_b64_tr_b16 v[246:247], v5 offset:2048
    ds_read_b64_tr_b16 v[250:251], v12 offset:2048
    ds_read_b64_tr_b16 v[254:255], v13 offset:2048
    s_waitcnt lgkmcnt(3)
    v_mfma_f32_16x16x32_bf16 v[16:19], v[240:243], v[208:211], v[16:19]
    v_mfma_f32_16x16x32_bf16 v[24:27], v[240:243], v[212:215], v[24:27]
    v_mfma_f32_16x16x32_bf16 v[48:51], v[240:243], v[216:219], v[48:51]
    v_mfma_f32_16x16x32_bf16 v[56:59], v[240:243], v[220:223], v[56:59]
    s_waitcnt lgkmcnt(0)
    s_add_u32 m0, s49, 2048
    s_lshl4_add_u32 s56, s53, s55
    buffer_load_dwordx4 v2, s[36:39], s56 offen lds
    buffer_load_dwordx4 v3, s[36:39], s56 offen offset:1024 lds
    s_waitcnt vmcnt(8)
    ds_read_b64_tr_b16 v[240:241], v4 offset:4096
    v_mfma_f32_16x16x32_bf16 v[20:23], v[244:247], v[208:211], v[20:23]
    v_mfma_f32_16x16x32_bf16 v[28:31], v[244:247], v[212:215], v[28:31]
    v_mfma_f32_16x16x32_bf16 v[52:55], v[244:247], v[216:219], v[52:55]
    v_mfma_f32_16x16x32_bf16 v[60:63], v[244:247], v[220:223], v[60:63]
    ds_read_b64_tr_b16 v[244:245], v5 offset:4096
    v_mfma_f32_16x16x32_bf16 v[32:35], v[248:251], v[208:211], v[32:35]
    v_mfma_f32_16x16x32_bf16 v[40:43], v[248:251], v[212:215], v[40:43]
    v_mfma_f32_16x16x32_bf16 v[64:67], v[248:251], v[216:219], v[64:67]
    v_mfma_f32_16x16x32_bf16 v[72:75], v[248:251], v[220:223], v[72:75]
    ds_read_b64_tr_b16 v[248:249], v12 offset:4096
    v_mfma_f32_16x16x32_bf16 v[36:39], v[252:255], v[208:211], v[36:39]
    v_mfma_f32_16x16x32_bf16 v[44:47], v[252:255], v[212:215], v[44:47]
    v_mfma_f32_16x16x32_bf16 v[68:71], v[252:255], v[216:219], v[68:71]
    v_mfma_f32_16x16x32_bf16 v[76:79], v[252:255], v[220:223], v[76:79]
    ds_read_b64_tr_b16 v[252:253], v13 offset:4096
    buffer_load_dwordx4 v[208:211], v7, s[40:43], s57 offen offset:0 sc1
    buffer_load_dwordx4 v[212:215], v7, s[40:43], s57 offen offset:1024 sc1
    buffer_load_dwordx4 v[216:219], v8, s[40:43], s57 offen offset:0 sc1
    buffer_load_dwordx4 v[220:223], v8, s[40:43], s57 offen offset:1024 sc1
    s_waitcnt lgkmcnt(0)
    s_add_u32 m0, s49, 4096
    s_add_u32 s56, s56, 16384
    buffer_load_dwordx4 v2, s[36:39], s56 offen lds
    buffer_load_dwordx4 v3, s[36:39], s56 offen offset:1024 lds
    s_waitcnt vmcnt(8)
    ds_read_b64_tr_b16 v[242:243], v4 offset:0
    ds_read_b64_tr_b16 v[246:247], v5 offset:0
    ds_read_b64_tr_b16 v[250:251], v12 offset:0
    ds_read_b64_tr_b16 v[254:255], v13 offset:0
    s_waitcnt lgkmcnt(3)
    v_mfma_f32_16x16x32_bf16 v[16:19], v[240:243], v[224:227], v[16:19]
    v_mfma_f32_16x16x32_bf16 v[24:27], v[240:243], v[228:231], v[24:27]
    v_mfma_f32_16x16x32_bf16 v[48:51], v[240:243], v[232:235], v[48:51]
    v_mfma_f32_16x16x32_bf16 v[56:59], v[240:243], v[236:239], v[56:59]
    s_waitcnt lgkmcnt(0)
    s_add_u32 m0, s49, 0
    s_add_u32 s56, s56, 16384
    buffer_load_dwordx4 v2, s[36:39], s56 offen lds
    buffer_load_dwordx4 v3, s[36:39], s56 offen offset:1024 lds
    s_waitcnt vmcnt(8)
    ds_read_b64_tr_b16 v[240:241], v4 offset:2048
    v_mfma_f32_16x16x32_bf16 v[20:23], v[244:247], v[224:227], v[20:23]
    v_mfma_f32_16x16x32_bf16 v[28:31], v[244:247], v[228:231], v[28:31]
    v_mfma_f32_16x16x32_bf16 v[52:55], v[244:247], v[232:235], v[52:55]
    v_mfma_f32_16x16x32_bf16 v[60:63], v[244:247], v[236:239], v[60:63]
    ds_read_b64_tr_b16 v[244:245], v5 offset:2048
    v_mfma_f32_16x16x32_bf16 v[32:35], v[248:251], v[224:227], v[32:35]
    v_mfma_f32_16x16x32_bf16 v[40:43], v[248:251], v[228:231], v[40:43]
    v_mfma_f32_16x16x32_bf16 v[64:67], v[248:251], v[232:235], v[64:67]
    v_mfma_f32_16x16x32_bf16 v[72:75], v[248:251], v[236:239], v[72:75]
    ds_read_b64_tr_b16 v[248:249], v12 offset:2048
    v_mfma_f32_16x16x32_bf16 v[36:39], v[252:255], v[224:227], v[36:39]
    v_mfma_f32_16x16x32_bf16 v[44:47], v[252:255], v[228:231], v[44:47]
    v_mfma_f32_16x16x32_bf16 v[68:71], v[252:255], v[232:235], v[68:71]
    v_mfma_f32_16x16x32_bf16 v[76:79], v[252:255], v[236:239], v[76:79]
    ds_read_b64_tr_b16 v[252:253], v13 offset:2048
    buffer_load_dwordx4 v[224:227], v7, s[40:43], s57 offen offset:2048 sc1
    buffer_load_dwordx4 v[228:231], v7, s[40:43], s57 offen offset:3072 sc1
    buffer_load_dwordx4 v[232:235], v8, s[40:43], s57 offen offset:2048 sc1
    buffer_load_dwordx4 v[236:239], v8, s[40:43], s57 offen offset:3072 sc1
    s_add_u32 s57, s57, 4096
    s_cmp_ge_u32 s57, 28672
    s_cselect_b32 s57, 0, s57
    s_waitcnt lgkmcnt(0)
    s_add_u32 m0, s49, 2048
    s_add_u32 s56, s56, 16384
    buffer_load_dwordx4 v2, s[36:39], s56 offen lds
    buffer_load_dwordx4 v3, s[36:39], s56 offen offset:1024 lds
    s_add_u32 s53, s53, 4096
    s_cmp_ge_u32 s53, 28672
    s_cselect_b32 s53, 0, s53
    s_waitcnt vmcnt(8)
    ds_read_b64_tr_b16 v[242:243], v4 offset:4096
    ds_read_b64_tr_b16 v[246:247], v5 offset:4096
    ds_read_b64_tr_b16 v[250:251], v12 offset:4096
    ds_read_b64_tr_b16 v[254:255], v13 offset:4096
    s_waitcnt lgkmcnt(3)
    v_mfma_f32_16x16x32_bf16 v[16:19], v[240:243], v[208:211], v[16:19]
    v_mfma_f32_16x16x32_bf16 v[24:27], v[240:243], v[212:215], v[24:27]
    v_mfma_f32_16x16x32_bf16 v[48:51], v[240:243], v[216:219], v[48:51]
    v_mfma_f32_16x16x32_bf16 v[56:59], v[240:243], v[220:223], v[56:59]
    s_waitcnt lgkmcnt(0)
    s_add_u32 m0, s49, 4096
    s_lshl4_add_u32 s56, s53, s55
    buffer_load_dwordx4 v2, s[36:39], s56 offen lds
    buffer_load_dwordx4 v3, s[36:39], s56 offen offset:1024 lds
    s_waitcnt vmcnt(8)
    ds_read_b64_tr_b16 v[240:241], v4 offset:0
    v_mfma_f32_16x16x32_bf16 v[20:23], v[244:247], v[208:211], v[20:23]
    v_mfma_f32_16x16x32_bf16 v[28:31], v[244:247], v[212:215], v[28:31]
    v_mfma_f32_16x16x32_bf16 v[52:55], v[244:247], v[216:219], v[52:55]
    v_mfma_f32_16x16x32_bf16 v[60:63], v[244:247], v[220:223], v[60:63]
    ds_read_b64_tr_b16 v[244:245], v5 offset:0
    v_mfma_f32_16x16x32_bf16 v[32:35], v[248:251], v[208:211], v[32:35]
    v_mfma_f32_16x16x32_bf16 v[40:43], v[248:251], v[212:215], v[40:43]
    v_mfma_f32_16x16x32_bf16 v[64:67], v[248:251], v[216:219], v[64:67]
    v_mfma_f32_16x16x32_bf16 v[72:75], v[248:251], v[220:223], v[72:75]
    ds_read_b64_tr_b16 v[248:249], v12 offset:0
    v_mfma_f32_16x16x32_bf16 v[36:39], v[252:255], v[208:211], v[36:39]
    v_mfma_f32_16x16x32_bf16 v[44:47], v[252:255], v[212:215], v[44:47]
    v_mfma_f32_16x16x32_bf16 v[68:71], v[252:255], v[216:219], v[68:71]
    v_mfma_f32_16x16x32_bf16 v[76:79], v[252:255], v[220:223], v[76:79]
    ds_read_b64_tr_b16 v[252:253], v13 offset:0
    buffer_load_dwordx4 v[208:211], v7, s[40:43], s57 offen offset:0 sc1
    buffer_load_dwordx4 v[212:215], v7, s[40:43], s57 offen offset:1024 sc1
    buffer_load_dwordx4 v[216:219], v8, s[40:43], s57 offen offset:0 sc1
    buffer_load_dwordx4 v[220:223], v8, s[40:43], s57 offen offset:1024 sc1
    s_waitcnt lgkmcnt(0)
    s_add_u32 m0, s49, 0
    s_add_u32 s56, s56, 16384
    buffer_load_dwordx4 v2, s[36:39], s56 offen lds
    buffer_load_dwordx4 v3, s[36:39], s56 offen offset:1024 lds
    s_waitcnt vmcnt(8)
    ds_read_b64_tr_b16 v[242:243], v4 offset:2048
    ds_read_b64_tr_b16 v[246:247], v5 offset:2048
    ds_read_b64_tr_b16 v[250:251], v12 offset:2048
    ds_read_b64_tr_b16 v[254:255], v13 offset:2048
    s_waitcnt lgkmcnt(3)
    v_mfma_f32_16x16x32_bf16 v[16:19], v[240:243], v[224:227], v[16:19]
    v_mfma_f32_16x16x32_bf16 v[24:27], v[240:243], v[228:231], v[24:27]
    v_mfma_f32_16x16x32_bf16 v[48:51], v[240:243], v[232:235], v[48:51]
    v_mfma_f32_16x16x32_bf16 v[56:59], v[240:243], v[236:239], v[56:59]
    s_waitcnt lgkmcnt(0)
    s_add_u32 m0, s49, 2048
    s_add_u32 s56, s56, 16384
    buffer_load_dwordx4 v2, s[36:39], s56 offen lds
    buffer_load_dwordx4 v3, s[36:39], s56 offen offset:1024 lds
    s_waitcnt vmcnt(8)
    ds_read_b64_tr_b16 v[240:241], v4 offset:4096
    v_mfma_f32_16x16x32_bf16 v[20:23], v[244:247], v[224:227], v[20:23]
    v_mfma_f32_16x16x32_bf16 v[28:31], v[244:247], v[228:231], v[28:31]
    v_mfma_f32_16x16x32_bf16 v[52:55], v[244:247], v[232:235], v[52:55]
    v_mfma_f32_16x16x32_bf16 v[60:63], v[244:247], v[236:239], v[60:63]
    ds_read_b64_tr_b16 v[244:245], v5 offset:4096
    v_mfma_f32_16x16x32_bf16 v[32:35], v[248:251], v[224:227], v[32:35]
    v_mfma_f32_16x16x32_bf16 v[40:43], v[248:251], v[228:231], v[40:43]
    v_mfma_f32_16x16x32_bf16 v[64:67], v[248:251], v[232:235], v[64:67]
    v_mfma_f32_16x16x32_bf16 v[72:75], v[248:251], v[236:239], v[72:75]
    ds_read_b64_tr_b16 v[248:249], v12 offset:4096
    v_mfma_f32_16x16x32_bf16 v[36:39], v[252:255], v[224:227], v[36:39]
    v_mfma_f32_16x16x32_bf16 v[44:47], v[252:255], v[228:231], v[44:47]
    v_mfma_f32_16x16x32_bf16 v[68:71], v[252:255], v[232:235], v[68:71]
    v_mfma_f32_16x16x32_bf16 v[76:79], v[252:255], v[236:239], v[76:79]
    ds_read_b64_tr_b16 v[252:253], v13 offset:4096
    buffer_load_dwordx4 v[224:227], v7, s[40:43], s57 offen offset:2048 sc1
    buffer_load_dwordx4 v[228:231], v7, s[40:43], s57 offen offset:3072 sc1
    buffer_load_dwordx4 v[232:235], v8, s[40:43], s57 offen offset:2048 sc1
    buffer_load_dwordx4 v[236:239], v8, s[40:43], s57 offen offset:3072 sc1
    s_add_u32 s57, s57, 4096
    s_cmp_ge_u32 s57, 28672
    s_cselect_b32 s57, 0, s57
    s_waitcnt lgkmcnt(0)
    s_add_u32 m0, s49, 4096
    s_add_u32 s56, s56, 16384
    buffer_load_dwordx4 v2, s[36:39], s56 offen lds
    buffer_load_dwordx4 v3, s[36:39], s56 offen offset:1024 lds
    s_add_u32 s53, s53, 4096
    s_cmp_ge_u32 s53, 28672
    s_cselect_b32 s53, 0, s53
    s_waitcnt vmcnt(8)
    ds_read_b64_tr_b16 v[242:243], v4 offset:0
    ds_read_b64_tr_b16 v[246:247], v5 offset:0
    ds_read_b64_tr_b16 v[250:251], v12 offset:0
    ds_read_b64_tr_b16 v[254:255], v13 offset:0
    s_waitcnt lgkmcnt(3)
    v_mfma_f32_16x16x32_bf16 v[16:19], v[240:243], v[208:211], v[16:19]
    v_mfma_f32_16x16x32_bf16 v[24:27], v[240:243], v[212:215], v[24:27]
    v_mfma_f32_16x16x32_bf16 v[48:51], v[240:243], v[216:219], v[48:51]
    v_mfma_f32_16x16x32_bf16 v[56:59], v[240:243], v[220:223], v[56:59]
    s_waitcnt lgkmcnt(0)
    s_add_u32 m0, s49, 0
    s_lshl4_add_u32 s56, s53, s55
    buffer_load_dwordx4 v2, s[36:39], s56 offen lds
    buffer_load_dwordx4 v3, s[36:39], s56 offen offset:1024 lds
    s_waitcnt vmcnt(8)
    ds_read_b64_tr_b16 v[240:241], v4 offset:2048
    v_mfma_f32_16x16x32_bf16 v[20:23], v[244:247], v[208:211], v[20:23]
    v_mfma_f32_16x16x32_bf16 v[28:31], v[244:247], v[212:215], v[28:31]
    v_mfma_f32_16x16x32_bf16 v[52:55], v[244:247], v[216:219], v[52:55]
    v_mfma_f32_16x16x32_bf16 v[60:63], v[244:247], v[220:223], v[60:63]
    ds_read_b64_tr_b16 v[244:245], v5 offset:2048
    v_mfma_f32_16x16x32_bf16 v[32:35], v[248:251], v[208:211], v[32:35]
    v_mfma_f32_16x16x32_bf16 v[40:43], v[248:251], v[212:215], v[40:43]
    v_mfma_f32_16x16x32_bf16 v[64:67], v[248:251], v[216:219], v[64:67]
    v_mfma_f32_16x16x32_bf16 v[72:75], v[248:251], v[220:223], v[72:75]
    ds_read_b64_tr_b16 v[248:249], v12 offset:2048
    v_mfma_f32_16x16x32_bf16 v[36:39], v[252:255], v[208:211], v[36:39]
    v_mfma_f32_16x16x32_bf16 v[44:47], v[252:255], v[212:215], v[44:47]
    v_mfma_f32_16x16x32_bf16 v[68:71], v[252:255], v[216:219], v[68:71]
    v_mfma_f32_16x16x32_bf16 v[76:79], v[252:255], v[220:223], v[76:79]
    ds_read_b64_tr_b16 v[252:253], v13 offset:2048
    buffer_load_dwordx4 v[208:211], v7, s[40:43], s57 offen offset:0 sc1
    buffer_load_dwordx4 v[212:215], v7, s[40:43], s57 offen offset:1024 sc1
    buffer_load_dwordx4 v[216:219], v8, s[40:43], s57 offen offset:0 sc1
    buffer_load_dwordx4 v[220:223], v8, s[40:43], s57 offen offset:1024 sc1
    s_waitcnt lgkmcnt(0)
    s_add_u32 m0, s49, 2048
    s_add_u32 s56, s56, 16384
    buffer_load_dwordx4 v2, s[36:39], s56 offen lds
    buffer_load_dwordx4 v3, s[36:39], s56 offen offset:1024 lds
    s_waitcnt vmcnt(8)
    ds_read_b64_tr_b16 v[242:243], v4 offset:4096
    ds_read_b64_tr_b16 v[246:247], v5 offset:4096
    ds_read_b64_tr_b16 v[250:251], v12 offset:4096
    ds_read_b64_tr_b16 v[254:255], v13 offset:4096
    s_waitcnt lgkmcnt(3)
    v_mfma_f32_16x16x32_bf16 v[16:19], v[240:243], v[224:227], v[16:19]
    v_mfma_f32_16x16x32_bf16 v[24:27], v[240:243], v[228:231], v[24:27]
    v_mfma_f32_16x16x32_bf16 v[48:51], v[240:243], v[232:235], v[48:51]
    v_mfma_f32_16x16x32_bf16 v[56:59], v[240:243], v[236:239], v[56:59]
    s_waitcnt lgkmcnt(0)
    s_add_u32 m0, s49, 4096
    s_add_u32 s56, s56, 16384
    buffer_load_dwordx4 v2, s[36:39], s56 offen lds
    buffer_load_dwordx4 v3, s[36:39], s56 offen offset:1024 lds
    s_waitcnt vmcnt(8)
    ds_read_b64_tr_b16 v[240:241], v4 offset:0
    v_mfma_f32_16x16x32_bf16 v[20:23], v[244:247], v[224:227], v[20:23]
    v_mfma_f32_16x16x32_bf16 v[28:31], v[244:247], v[228:231], v[28:31]
    v_mfma_f32_16x16x32_bf16 v[52:55], v[244:247], v[232:235], v[52:55]
    v_mfma_f32_16x16x32_bf16 v[60:63], v[244:247], v[236:239], v[60:63]
    ds_read_b64_tr_b16 v[244:245], v5 offset:0
    v_mfma_f32_16x16x32_bf16 v[32:35], v[248:251], v[224:227], v[32:35]
    v_mfma_f32_16x16x32_bf16 v[40:43], v[248:251], v[228:231], v[40:43]
    v_mfma_f32_16x16x32_bf16 v[64:67], v[248:251], v[232:235], v[64:67]
    v_mfma_f32_16x16x32_bf16 v[72:75], v[248:251], v[236:239], v[72:75]
    ds_read_b64_tr_b16 v[248:249], v12 offset:0
    v_mfma_f32_16x16x32_bf16 v[36:39], v[252:255], v[224:227], v[36:39]
    v_mfma_f32_16x16x32_bf16 v[44:47], v[252:255], v[228:231], v[44:47]
    v_mfma_f32_16x16x32_bf16 v[68:71], v[252:255], v[232:235], v[68:71]
    v_mfma_f32_16x16x32_bf16 v[76:79], v[252:255], v[236:239], v[76:79]
    ds_read_b64_tr_b16 v[252:253], v13 offset:0
    buffer_load_dwordx4 v[224:227], v7, s[40:43], s57 offen offset:2048 sc1
    buffer_load_dwordx4 v[228:231], v7, s[40:43], s57 offen offset:3072 sc1
    buffer_load_dwordx4 v[232:235], v8, s[40:43], s57 offen offset:2048 sc1
    buffer_load_dwordx4 v[236:239], v8, s[40:43], s57 offen offset:3072 sc1
    s_add_u32 s57, s57, 4096
    s_cmp_ge_u32 s57, 28672
    s_cselect_b32 s57, 0, s57
    s_waitcnt lgkmcnt(0)
    s_add_u32 m0, s49, 0
    s_add_u32 s56, s56, 16384
    buffer_load_dwordx4 v2, s[36:39], s56 offen lds
    buffer_load_dwordx4 v3, s[36:39], s56 offen offset:1024 lds
    s_add_u32 s53, s53, 4096
    s_cmp_ge_u32 s53, 28672
    s_cselect_b32 s53, 0, s53
    s_waitcnt vmcnt(8)
    ds_read_b64_tr_b16 v[242:243], v4 offset:2048
    ds_read_b64_tr_b16 v[246:247], v5 offset:2048
    ds_read_b64_tr_b16 v[250:251], v12 offset:2048
    ds_read_b64_tr_b16 v[254:255], v13 offset:2048
    s_waitcnt lgkmcnt(3)
    v_mfma_f32_16x16x32_bf16 v[16:19], v[240:243], v[208:211], v[16:19]
    v_mfma_f32_16x16x32_bf16 v[24:27], v[240:243], v[212:215], v[24:27]
    v_mfma_f32_16x16x32_bf16 v[48:51], v[240:243], v[216:219], v[48:51]
    v_mfma_f32_16x16x32_bf16 v[56:59], v[240:243], v[220:223], v[56:59]
    s_waitcnt lgkmcnt(0)
    s_waitcnt vmcnt(6)
    ds_read_b64_tr_b16 v[240:241], v4 offset:4096
    v_mfma_f32_16x16x32_bf16 v[20:23], v[244:247], v[208:211], v[20:23]
    v_mfma_f32_16x16x32_bf16 v[28:31], v[244:247], v[212:215], v[28:31]
    v_mfma_f32_16x16x32_bf16 v[52:55], v[244:247], v[216:219], v[52:55]
    v_mfma_f32_16x16x32_bf16 v[60:63], v[244:247], v[220:223], v[60:63]
    ds_read_b64_tr_b16 v[244:245], v5 offset:4096
    v_mfma_f32_16x16x32_bf16 v[32:35], v[248:251], v[208:211], v[32:35]
    v_mfma_f32_16x16x32_bf16 v[40:43], v[248:251], v[212:215], v[40:43]
    v_mfma_f32_16x16x32_bf16 v[64:67], v[248:251], v[216:219], v[64:67]
    v_mfma_f32_16x16x32_bf16 v[72:75], v[248:251], v[220:223], v[72:75]
    ds_read_b64_tr_b16 v[248:249], v12 offset:4096
    v_mfma_f32_16x16x32_bf16 v[36:39], v[252:255], v[208:211], v[36:39]
    v_mfma_f32_16x16x32_bf16 v[44:47], v[252:255], v[212:215], v[44:47]
    v_mfma_f32_16x16x32_bf16 v[68:71], v[252:255], v[216:219], v[68:71]
    v_mfma_f32_16x16x32_bf16 v[76:79], v[252:255], v[220:223], v[76:79]
    ds_read_b64_tr_b16 v[252:253], v13 offset:4096
    s_waitcnt lgkmcnt(0)
    s_waitcnt vmcnt(0)
    ds_read_b64_tr_b16 v[242:243], v4 offset:0
    ds_read_b64_tr_b16 v[246:247], v5 offset:0
    ds_read_b64_tr_b16 v[250:251], v12 offset:0
    ds_read_b64_tr_b16 v[254:255], v13 offset:0
    s_waitcnt lgkmcnt(3)
    v_mfma_f32_16x16x32_bf16 v[16:19], v[240:243], v[224:227], v[16:19]
    v_mfma_f32_16x16x32_bf16 v[24:27], v[240:243], v[228:231], v[24:27]
    v_mfma_f32_16x16x32_bf16 v[48:51], v[240:243], v[232:235], v[48:51]
    v_mfma_f32_16x16x32_bf16 v[56:59], v[240:243], v[236:239], v[56:59]
    s_waitcnt lgkmcnt(0)
    v_mfma_f32_16x16x32_bf16 v[20:23], v[244:247], v[224:227], v[20:23]
    v_mfma_f32_16x16x32_bf16 v[28:31], v[244:247], v[228:231], v[28:31]
    v_mfma_f32_16x16x32_bf16 v[52:55], v[244:247], v[232:235], v[52:55]
    v_mfma_f32_16x16x32_bf16 v[60:63], v[244:247], v[236:239], v[60:63]
    v_mfma_f32_16x16x32_bf16 v[32:35], v[248:251], v[224:227], v[32:35]
    v_mfma_f32_16x16x32_bf16 v[40:43], v[248:251], v[228:231], v[40:43]
    v_mfma_f32_16x16x32_bf16 v[64:67], v[248:251], v[232:235], v[64:67]
    v_mfma_f32_16x16x32_bf16 v[72:75], v[248:251], v[236:239], v[72:75]
    v_mfma_f32_16x16x32_bf16 v[36:39], v[252:255], v[224:227], v[36:39]
    v_mfma_f32_16x16x32_bf16 v[44:47], v[252:255], v[228:231], v[44:47]
    v_mfma_f32_16x16x32_bf16 v[68:71], v[252:255], v[232:235], v[68:71]
    v_mfma_f32_16x16x32_bf16 v[76:79], v[252:255], v[236:239], v[76:79]
    s_setprio 2
    s_mov_b32 s44, s26
    s_mov_b32 s45, s27
    s_mov_b32 s46, 0x200000
    s_mov_b32 s47, 0x00020000
    v_and_b32 v2, 15, v0
    v_lshrrev_b32 v3, 4, v0
    v_lshlrev_b32 v2, 10, v2
    v_lshl_add_u32 v2, v3, 3, v2
    v_mov_b32 v3, v9
    s_lshl1_add_u32 s55, s18, s51
    s_lshl_b32 s55, s55, 15
    s_lshl1_add_u32 s60, s7, s50
    s_lshl_b32 s60, s60, 6
    s_add_u32 s55, s55, s60
    s_add_u32 s53, s55, 16384
    v_add_u32 v1, s68, v6
    v_add_u32 v208, s69, v6
    v_add_u32 v209, s70, v6
    v_mov_b32 v4, 163824
    v_mov_b32 v7, 1
    v_mov_b32 v6, v10
    s_setprio 0
    buffer_load_dwordx2 v[8:9], v2, s[32:35], s55 offen offset:0
    buffer_load_dwordx2 v[10:11], v2, s[32:35], s55 offen offset:32
    buffer_load_dwordx2 v[12:13], v2, s[32:35], s53 offen offset:0
    buffer_load_dwordx2 v[14:15], v2, s[32:35], s53 offen offset:32
    ds_write_b128 v3, v[32:35] offset:0
    ds_write_b128 v3, v[36:39] offset:1024
    ds_write_b128 v3, v[48:51] offset:2048
    ds_write_b128 v3, v[52:55] offset:3072
    ds_write_b128 v3, v[64:67] offset:4096
    ds_write_b128 v3, v[68:71] offset:5120
    s_waitcnt lgkmcnt(0)
    s_mov_b64 exec, 1
    ds_add_u32 v4, v7 offset:12
    s_mov_b64 exec, -1
    s_setprio 2
    s_mov_b32 s62, 1048576
L_lw_23:
    ds_read_b32 v5, v4 offset:12
    s_waitcnt lgkmcnt(0)
    v_readfirstlane_b32 s63, v5
    s_sub_u32 s62, s62, 1
    s_nop 2
    s_cmp_ge_u32 s63, 12
    s_cbranch_scc1 L_lwd_24
    s_sleep 3
    s_cmp_lg_u32 s62, 0
    s_cbranch_scc1 L_lw_23
L_lwd_24:
    s_setprio 0
    ds_read_b128 v[32:35], v1 offset:0
    ds_read_b128 v[36:39], v1 offset:1024
    ds_read_b128 v[48:51], v208 offset:0
    ds_read_b128 v[52:55], v208 offset:1024
    ds_read_b128 v[64:67], v209 offset:0
    ds_read_b128 v[68:71], v209 offset:1024
    s_waitcnt lgkmcnt(0)
    s_mov_b64 exec, 1
    ds_add_u32 v4, v7 offset:12
    s_mov_b64 exec, -1
    s_setprio 2
    s_mov_b32 s62, 1048576
L_lw_25:
    ds_read_b32 v5, v4 offset:12
    s_waitcnt lgkmcnt(0)
    v_readfirstlane_b32 s63, v5
    s_sub_u32 s62, s62, 1
    s_nop 2
    s_cmp_ge_u32 s63, 16
    s_cbranch_scc1 L_lwd_26
    s_sleep 3
    s_cmp_lg_u32 s62, 0
    s_cbranch_scc1 L_lw_25
L_lwd_26:
    s_setprio 0
    ds_write_b128 v3, v[40:43] offset:0
    ds_write_b128 v3, v[44:47] offset:1024
    ds_write_b128 v3, v[56:59] offset:2048
    ds_write_b128 v3, v[60:63] offset:3072
    ds_write_b128 v3, v[72:75] offset:4096
    ds_write_b128 v3, v[76:79] offset:5120
    s_waitcnt lgkmcnt(0)
    s_mov_b64 exec, 1
    ds_add_u32 v4, v7 offset:12
    s_mov_b64 exec, -1
    s_setprio 2
    s_mov_b32 s62, 1048576
L_lw_27:
    ds_read_b32 v5, v4 offset:12
    s_waitcnt lgkmcnt(0)
    v_readfirstlane_b32 s63, v5
    s_sub_u32 s62, s62, 1
    s_nop 2
    s_cmp_ge_u32 s63, 20
    s_cbranch_scc1 L_lwd_28
    s_sleep 3
    s_cmp_lg_u32 s62, 0
    s_cbranch_scc1 L_lw_27
L_lwd_28:
    s_setprio 0
    ds_read_b128 v[40:43], v1 offset:0
    ds_read_b128 v[44:47], v1 offset:1024
    ds_read_b128 v[56:59], v208 offset:0
    ds_read_b128 v[60:63], v208 offset:1024
    ds_read_b128 v[72:75], v209 offset:0
    ds_read_b128 v[76:79], v209 offset:1024
    s_waitcnt lgkmcnt(0)
    s_lshl1_add_u32 s60, s18, s51
    s_lshl1_add_u32 s60, s60, s50
    s_lshl_b32 s60, s60, 14
    s_add_u32 s60, s60, 2097152
    s_mov_b32 s66, s60
    s_xor_b32 s61, s54, 3
    s_lshl_b32 s61, s61, 12
    s_add_u32 s56, s60, s61
    s_xor_b32 s61, s54, 2
    s_lshl_b32 s61, s61, 12
    s_add_u32 s57, s60, s61
    s_xor_b32 s61, s54, 1
    s_lshl_b32 s61, s61, 12
    s_add_u32 s58, s60, s61
    s_xor_b32 s61, s54, 0
    s_lshl_b32 s61, s61, 12
    s_add_u32 s59, s60, s61
    s_mov_b32 s60, 0xbfb8aa3b
    s_mov_b32 s64, 0xffff0000
    s_mul_i32 s65, s48, 2560
    s_add_u32 s65, s65, 32768
    s_mov_b32 s62, 1048576
L_lw_29:
    ds_read_b32 v5, v4 offset:8
    s_waitcnt lgkmcnt(0)
    v_readfirstlane_b32 s63, v5
    s_sub_u32 s62, s62, 1
    s_nop 2
    s_cmp_ge_u32 s63, 4
    s_cbranch_scc1 L_lwd_30
    s_sleep 1
    s_cmp_lg_u32 s62, 0
    s_cbranch_scc1 L_lw_29
L_lwd_30:
    v_pk_add_f32 v[16:17], v[16:17], v[64:65]
    v_pk_add_f32 v[18:19], v[18:19], v[66:67]
    v_pk_add_f32 v[20:21], v[20:21], v[68:69]
    v_pk_add_f32 v[22:23], v[22:23], v[70:71]
    v_pk_add_f32 v[24:25], v[24:25], v[72:73]
    v_pk_add_f32 v[26:27], v[26:27], v[74:75]
    v_pk_add_f32 v[28:29], v[28:29], v[76:77]
    v_pk_add_f32 v[30:31], v[30:31], v[78:79]
    v_pk_add_f32 v[16:17], v[16:17], v[48:49]
    v_pk_add_f32 v[18:19], v[18:19], v[50:51]
    v_pk_add_f32 v[20:21], v[20:21], v[52:53]
    v_pk_add_f32 v[22:23], v[22:23], v[54:55]
    v_pk_add_f32 v[24:25], v[24:25], v[56:57]
    v_pk_add_f32 v[26:27], v[26:27], v[58:59]
    v_pk_add_f32 v[28:29], v[28:29], v[60:61]
    v_pk_add_f32 v[30:31], v[30:31], v[62:63]
    v_pk_add_f32 v[16:17], v[16:17], v[32:33]
    v_pk_add_f32 v[18:19], v[18:19], v[34:35]
    v_pk_add_f32 v[20:21], v[20:21], v[36:37]
    v_pk_add_f32 v[22:23], v[22:23], v[38:39]
    v_pk_add_f32 v[24:25], v[24:25], v[40:41]
    v_pk_add_f32 v[26:27], v[26:27], v[42:43]
    v_pk_add_f32 v[28:29], v[28:29], v[44:45]
    v_pk_add_f32 v[30:31], v[30:31], v[46:47]
    v_subrev_u32 v3, 135168, v3
    v_subrev_u32 v1, 135168, v1
    v_mul_f32 v64, s60, v16
    v_mul_f32 v65, s60, v17
    v_mul_f32 v66, s60, v18
    v_mul_f32 v67, s60, v19
    v_mul_f32 v68, s60, v20
    v_mul_f32 v69, s60, v21
    v_mul_f32 v70, s60, v22
    v_mul_f32 v71, s60, v23
    v_exp_f32 v64, v64
    v_exp_f32 v65, v65
    v_exp_f32 v66, v66
    v_exp_f32 v67, v67
    v_exp_f32 v68, v68
    v_exp_f32 v69, v69
    v_exp_f32 v70, v70
    v_exp_f32 v71, v71
    v_add_f32 v64, 1.0, v64
    v_add_f32 v65, 1.0, v65
    v_add_f32 v66, 1.0, v66
    v_add_f32 v67, 1.0, v67
    v_add_f32 v68, 1.0, v68
    v_add_f32 v69, 1.0, v69
    v_add_f32 v70, 1.0, v70
    v_add_f32 v71, 1.0, v71
    v_rcp_f32 v64, v64
    v_rcp_f32 v65, v65
    v_rcp_f32 v66, v66
    v_rcp_f32 v67, v67
    v_rcp_f32 v68, v68
    v_rcp_f32 v69, v69
    v_rcp_f32 v70, v70
    v_rcp_f32 v71, v71
    v_mul_f32 v16, v16, v64
    v_mul_f32 v17, v17, v65
    v_mul_f32 v18, v18, v66
    v_mul_f32 v19, v19, v67
    v_mul_f32 v32, s60, v24
    v_mul_f32 v33, s60, v25
    v_mul_f32 v34, s60, v26
    v_mul_f32 v35, s60, v27
    v_mul_f32 v36, s60, v28
    v_mul_f32 v37, s60, v29
    v_mul_f32 v38, s60, v30
    v_mul_f32 v39, s60, v31
    v_exp_f32 v32, v32
    v_exp_f32 v33, v33
    v_exp_f32 v34, v34
    v_exp_f32 v35, v35
    v_exp_f32 v36, v36
    v_exp_f32 v37, v37
    v_exp_f32 v38, v38
    v_exp_f32 v39, v39
    v_add_f32 v32, 1.0, v32
    v_add_f32 v33, 1.0, v33
    v_add_f32 v34, 1.0, v34
    v_add_f32 v35, 1.0, v35
    v_add_f32 v36, 1.0, v36
    v_add_f32 v37, 1.0, v37
    v_add_f32 v38, 1.0, v38
    v_add_f32 v39, 1.0, v39
    v_rcp_f32 v32, v32
    v_rcp_f32 v33, v33
    v_rcp_f32 v34, v34
    v_rcp_f32 v35, v35
    v_rcp_f32 v36, v36
    v_rcp_f32 v37, v37
    v_rcp_f32 v38, v38
    v_rcp_f32 v39, v39
    v_mul_f32 v24, v24, v32
    v_mul_f32 v25, v25, v33
    v_mul_f32 v26, v26, v34
    v_mul_f32 v27, v27, v35
    v_mul_f32 v28, v28, v36
    v_mul_f32 v29, v29, v37
    v_mul_f32 v30, v30, v38
    v_mul_f32 v31, v31, v39
    s_mov_b32 s62, 1048576
L_lw_31:
    ds_read_b32 v5, v4 offset:0
    s_waitcnt lgkmcnt(0)
    v_readfirstlane_b32 s63, v5
    s_sub_u32 s62, s62, 1
    s_nop 2
    s_cmp_ge_u32 s63, 8
    s_cbranch_scc1 L_lwd_32
    s_cmp_lg_u32 s62, 0
    s_cbranch_scc1 L_lw_31
L_lwd_32:
    buffer_load_dwordx4 v[208:211], v6, s[40:43], s56 offen offset:0 sc1
    buffer_load_dwordx4 v[212:215], v6, s[40:43], s56 offen offset:256 sc1
    buffer_load_dwordx4 v[216:219], v6, s[40:43], s56 offen offset:2048 sc1
    buffer_load_dwordx4 v[220:223], v6, s[40:43], s56 offen offset:2304 sc1
    buffer_load_dwordx4 v[224:227], v6, s[40:43], s57 offen offset:0 sc1
    buffer_load_dwordx4 v[228:231], v6, s[40:43], s57 offen offset:256 sc1
    buffer_load_dwordx4 v[232:235], v6, s[40:43], s57 offen offset:2048 sc1
    buffer_load_dwordx4 v[236:239], v6, s[40:43], s57 offen offset:2304 sc1
    s_waitcnt vmcnt(4)
    v_max3_u32 v5, v208, v212, v216
    v_max_u32 v5, v5, v220
    v_cmp_eq_u32 vcc, -1, v5
    v_mul_f32 v20, v20, v68
    v_mul_f32 v21, v21, v69
    v_mul_f32 v22, v22, v70
    v_mul_f32 v23, v23, v71
    s_cbranch_vccnz L_obad0
    v_mfma_f32_16x16x32_bf16 v[48:51], v[88:91], v[208:211], 0
    buffer_load_dwordx4 v[240:243], v6, s[40:43], s58 offen offset:0 sc1
    v_mfma_f32_16x16x32_bf16 v[52:55], v[92:95], v[208:211], 0
    v_mfma_f32_16x16x32_bf16 v[32:35], v[80:83], v[208:211], 0
    buffer_load_dwordx4 v[244:247], v6, s[40:43], s58 offen offset:256 sc1
L_pad_x761:
    s_cbranch_execz L_ret_x761
    v_mfma_f32_16x16x32_bf16 v[36:39], v[84:87], v[208:211], 0
    v_mfma_f32_16x16x32_bf16 v[56:59], v[88:91], v[212:215], 0
    buffer_load_dwordx4 v[248:251], v6, s[40:43], s58 offen offset:2048 sc1
    v_mfma_f32_16x16x32_bf16 v[60:63], v[92:95], v[212:215], 0
    v_mfma_f32_16x16x32_bf16 v[40:43], v[80:83], v[212:215], 0
    buffer_load_dwordx4 v[252:255], v6, s[40:43], s58 offen offset:2304 sc1
    v_mfma_f32_16x16x32_bf16 v[44:47], v[84:87], v[212:215], 0
    buffer_load_dwordx4 v[64:67], v6, s[40:43], s59 offen offset:0 sc1
    v_mfma_f32_16x16x32_bf16 v[48:51], v[104:107], v[216:219], v[48:51]
    buffer_load_dwordx4 v[68:71], v6, s[40:43], s59 offen offset:256 sc1
    v_mfma_f32_16x16x32_bf16 v[52:55], v[108:111], v[216:219], v[52:55]
    buffer_load_dwordx4 v[72:75], v6, s[40:43], s59 offen offset:2048 sc1
    v_mfma_f32_16x16x32_bf16 v[32:35], v[96:99], v[216:219], v[32:35]
    buffer_load_dwordx4 v[76:79], v6, s[40:43], s59 offen offset:2304 sc1
    v_mfma_f32_16x16x32_bf16 v[36:39], v[100:103], v[216:219], v[36:39]
    s_waitcnt vmcnt(8)
    v_max3_u32 v5, v224, v228, v232
    v_max_u32 v5, v5, v236
    v_cmp_eq_u32 vcc, -1, v5
    v_mfma_f32_16x16x32_bf16 v[56:59], v[104:107], v[220:223], v[56:59]
    v_mfma_f32_16x16x32_bf16 v[60:63], v[108:111], v[220:223], v[60:63]
    v_mfma_f32_16x16x32_bf16 v[40:43], v[96:99], v[220:223], v[40:43]
    v_mfma_f32_16x16x32_bf16 v[44:47], v[100:103], v[220:223], v[44:47]
    s_cbranch_vccnz L_obad1
    v_mfma_f32_16x16x32_bf16 v[48:51], v[120:123], v[224:227], v[48:51]
    v_lshlrev_b32 v96, 16, v8
    v_and_b32 v97, s64, v8
    v_mfma_f32_16x16x32_bf16 v[52:55], v[124:127], v[224:227], v[52:55]
    v_lshlrev_b32 v98, 16, v9
    v_and_b32 v99, s64, v9
    v_mfma_f32_16x16x32_bf16 v[32:35], v[112:115], v[224:227], v[32:35]
    v_lshlrev_b32 v100, 16, v10
    v_and_b32 v101, s64, v10
    v_mfma_f32_16x16x32_bf16 v[36:39], v[116:119], v[224:227], v[36:39]
    v_lshlrev_b32 v102, 16, v11
    v_and_b32 v103, s64, v11
    v_mfma_f32_16x16x32_bf16 v[56:59], v[120:123], v[228:231], v[56:59]
    v_lshlrev_b32 v104, 16, v12
    v_and_b32 v105, s64, v12
    v_mfma_f32_16x16x32_bf16 v[60:63], v[124:127], v[228:231], v[60:63]
    v_lshlrev_b32 v106, 16, v13
    v_and_b32 v107, s64, v13
    v_mfma_f32_16x16x32_bf16 v[40:43], v[112:115], v[228:231], v[40:43]
    v_lshlrev_b32 v108, 16, v14
    v_and_b32 v109, s64, v14
    v_mfma_f32_16x16x32_bf16 v[44:47], v[116:119], v[228:231], v[44:47]
    v_lshlrev_b32 v110, 16, v15
    v_and_b32 v111, s64, v15
    v_mfma_f32_16x16x32_bf16 v[48:51], v[136:139], v[232:235], v[48:51]
    v_and_b32 v88, 15, v0
    v_lshrrev_b32 v89, 4, v0
    v_mfma_f32_16x16x32_bf16 v[52:55], v[140:143], v[232:235], v[52:55]
    v_mul_u32_u24 v88, 80, v88
    v_lshl_add_u32 v88, v89, 3, v88
    v_mfma_f32_16x16x32_bf16 v[32:35], v[128:131], v[232:235], v[32:35]
    v_lshrrev_b32 v89, 2, v0
    v_and_b32 v90, 3, v0
    v_mfma_f32_16x16x32_bf16 v[36:39], v[132:135], v[232:235], v[36:39]
    s_waitcnt vmcnt(4)
    v_max3_u32 v5, v240, v244, v248
    v_max_u32 v5, v5, v252
    v_cmp_eq_u32 vcc, -1, v5
    v_mfma_f32_16x16x32_bf16 v[56:59], v[136:139], v[236:239], v[56:59]
    v_add_u32 v88, s65, v88
    v_lshlrev_b32 v90, 4, v90
    v_mfma_f32_16x16x32_bf16 v[60:63], v[140:143], v[236:239], v[60:63]
    v_lshl_add_u32 v91, v89, 10, v90
    v_mul_u32_u24 v89, 80, v89
    v_mfma_f32_16x16x32_bf16 v[40:43], v[128:131], v[236:239], v[40:43]
    v_add3_u32 v89, v89, v90, s65
    v_mfma_f32_16x16x32_bf16 v[44:47], v[132:135], v[236:239], v[44:47]
    s_cbranch_vccnz L_obad2
    v_mfma_f32_16x16x32_bf16 v[48:51], v[152:155], v[240:243], v[48:51]
    v_mfma_f32_16x16x32_bf16 v[52:55], v[156:159], v[240:243], v[52:55]
    v_mfma_f32_16x16x32_bf16 v[32:35], v[144:147], v[240:243], v[32:35]
    v_mfma_f32_16x16x32_bf16 v[36:39], v[148:151], v[240:243], v[36:39]
    v_mfma_f32_16x16x32_bf16 v[56:59], v[152:155], v[244:247], v[56:59]
    v_mfma_f32_16x16x32_bf16 v[60:63], v[156:159], v[244:247], v[60:63]
    v_mfma_f32_16x16x32_bf16 v[40:43], v[144:147], v[244:247], v[40:43]
    v_mfma_f32_16x16x32_bf16 v[44:47], v[148:151], v[244:247], v[44:47]
    v_mfma_f32_16x16x32_bf16 v[48:51], v[168:171], v[248:251], v[48:51]
    v_mfma_f32_16x16x32_bf16 v[52:55], v[172:175], v[248:251], v[52:55]
    v_mfma_f32_16x16x32_bf16 v[32:35], v[160:163], v[248:251], v[32:35]
    v_mfma_f32_16x16x32_bf16 v[36:39], v[164:167], v[248:251], v[36:39]
    s_waitcnt vmcnt(0)
    v_max3_u32 v5, v64, v68, v72
    v_max_u32 v5, v5, v76
    v_cmp_eq_u32 vcc, -1, v5
    v_mfma_f32_16x16x32_bf16 v[56:59], v[168:171], v[252:255], v[56:59]
    v_mfma_f32_16x16x32_bf16 v[60:63], v[172:175], v[252:255], v[60:63]
    v_mfma_f32_16x16x32_bf16 v[40:43], v[160:163], v[252:255], v[40:43]
    v_mfma_f32_16x16x32_bf16 v[44:47], v[164:167], v[252:255], v[44:47]
    s_cbranch_vccnz L_obad3
    v_mfma_f32_16x16x32_bf16 v[48:51], v[184:187], v[64:67], v[48:51]
    v_mfma_f32_16x16x32_bf16 v[52:55], v[188:191], v[64:67], v[52:55]
    v_mfma_f32_16x16x32_bf16 v[56:59], v[184:187], v[68:71], v[56:59]
    v_mfma_f32_16x16x32_bf16 v[60:63], v[188:191], v[68:71], v[60:63]
    v_mfma_f32_16x16x32_bf16 v[48:51], v[200:203], v[72:75], v[48:51]
    v_mfma_f32_16x16x32_bf16 v[52:55], v[204:207], v[72:75], v[52:55]
    v_mfma_f32_16x16x32_bf16 v[56:59], v[200:203], v[76:79], v[56:59]
    v_mfma_f32_16x16x32_bf16 v[60:63], v[204:207], v[76:79], v[60:63]
    v_mfma_f32_16x16x32_bf16 v[32:35], v[176:179], v[64:67], v[32:35]
    v_mfma_f32_16x16x32_bf16 v[36:39], v[180:183], v[64:67], v[36:39]
    v_mfma_f32_16x16x32_bf16 v[40:43], v[176:179], v[68:71], v[40:43]
    v_mfma_f32_16x16x32_bf16 v[44:47], v[180:183], v[68:71], v[44:47]
    v_mfma_f32_16x16x32_bf16 v[32:35], v[192:195], v[72:75], v[32:35]
    ds_write_b128 v3, v[48:51] offset:0
    v_mfma_f32_16x16x32_bf16 v[36:39], v[196:199], v[72:75], v[36:39]
    ds_write_b128 v3, v[52:55] offset:1024
    v_mfma_f32_16x16x32_bf16 v[40:43], v[192:195], v[76:79], v[40:43]
    ds_write_b128 v3, v[56:59] offset:2048
    v_mfma_f32_16x16x32_bf16 v[44:47], v[196:199], v[76:79], v[44:47]
    ds_write_b128 v3, v[60:63] offset:3072
L_ofin:
    s_nop 3
    v_pk_fma_f32 v[96:97], v[32:33], v[16:17], v[96:97]
    v_pk_fma_f32 v[98:99], v[34:35], v[18:19], v[98:99]
    v_pk_fma_f32 v[100:101], v[36:37], v[20:21], v[100:101]
    v_pk_fma_f32 v[102:103], v[38:39], v[22:23], v[102:103]
    v_pk_fma_f32 v[104:105], v[40:41], v[24:25], v[104:105]
    v_pk_fma_f32 v[106:107], v[42:43], v[26:27], v[106:107]
    v_pk_fma_f32 v[108:109], v[44:45], v[28:29], v[108:109]
    v_pk_fma_f32 v[110:111], v[46:47], v[30:31], v[110:111]
    s_waitcnt lgkmcnt(0)
    s_barrier
    ds_read_b128 v[112:115], v1 offset:0
    ds_read_b128 v[116:119], v1 offset:1024
    ds_read_b128 v[120:123], v1 offset:2048
    ds_read_b128 v[124:127], v1 offset:3072
    s_waitcnt lgkmcnt(2)
    v_pk_fma_f32 v[96:97], v[112:113], v[16:17], v[96:97]
    v_pk_fma_f32 v[98:99], v[114:115], v[18:19], v[98:99]
    v_pk_fma_f32 v[100:101], v[116:117], v[20:21], v[100:101]
    v_pk_fma_f32 v[102:103], v[118:119], v[22:23], v[102:103]
    v_cvt_pk_bf16_f32 v128, v96, v97
    v_cvt_pk_bf16_f32 v129, v98, v99
    v_cvt_pk_bf16_f32 v130, v100, v101
    v_cvt_pk_bf16_f32 v131, v102, v103
    ds_write_b64 v88, v[128:129] offset:0
    ds_write_b64 v88, v[130:131] offset:32
    s_waitcnt lgkmcnt(2)
    v_pk_fma_f32 v[104:105], v[120:121], v[24:25], v[104:105]
    v_pk_fma_f32 v[106:107], v[122:123], v[26:27], v[106:107]
    v_pk_fma_f32 v[108:109], v[124:125], v[28:29], v[108:109]
    v_pk_fma_f32 v[110:111], v[126:127], v[30:31], v[110:111]
    v_cvt_pk_bf16_f32 v132, v104, v105
    v_cvt_pk_bf16_f32 v133, v106, v107
    v_cvt_pk_bf16_f32 v134, v108, v109
    v_cvt_pk_bf16_f32 v135, v110, v111
    ds_write_b64 v88, v[132:133] offset:1280
    ds_write_b64 v88, v[134:135] offset:1312
    ds_read_b128 v[136:139], v89
    ds_read_b128 v[140:143], v89 offset:1280
    s_waitcnt lgkmcnt(1)
    buffer_store_dwordx4 v[136:139], v91, s[44:47], s55 offen sc1
    s_waitcnt lgkmcnt(0)
    buffer_store_dwordx4 v[140:143], v91, s[44:47], s53 offen sc1
L_end:
    s_endpgm
.p2align 12
L_ck:
L_pad_ck:
    s_cbranch_execz L_ret_ck
    s_barrier
    ds_read_b128 v[144:147], v20 offset:0
    ds_read_b64_tr_b16 v[148:149], v24 offset:0
    ds_read_b64_tr_b16 v[150:151], v24 offset:128
    ds_read_b128 v[152:155], v21 offset:0
    ds_read_b64_tr_b16 v[156:157], v24 offset:1024
    ds_read_b64_tr_b16 v[158:159], v24 offset:1152
    ds_read_b128 v[192:195], v244 offset:0
    ds_read_b64_tr_b16 v[208:209], v240 offset:0
    ds_read_b64_tr_b16 v[210:211], v240 offset:512
    ds_read_b64_tr_b16 v[212:213], v241 offset:0
    ds_read_b64_tr_b16 v[214:215], v241 offset:512
    ds_read_b64_tr_b16 v[216:217], v240 offset:8192
    ds_read_b64_tr_b16 v[218:219], v240 offset:8704
    ds_read_b64_tr_b16 v[220:221], v241 offset:8192
    ds_read_b64_tr_b16 v[222:223], v241 offset:8704
    ds_read_b128 v[196:199], v244 offset:2048
    ds_read_b128 v[200:203], v244 offset:4096
    ds_read_b128 v[204:207], v244 offset:6144
    s_waitcnt lgkmcnt(2)
    v_mfma_f32_16x16x32_bf16 v[128:131], v[148:151], v[144:147], 0
    ds_read_b128 v[160:163], v20 offset:8192
    v_mfma_f32_16x16x32_bf16 v[128:131], v[156:159], v[152:155], v[128:131]
    ds_read_b64_tr_b16 v[164:165], v24 offset:2048
    v_mfma_f32_16x16x32_bf16 v[64:67], v[208:211], v[192:195], 0
    s_barrier
    ds_read_b64_tr_b16 v[224:225], v240 offset:16384
    ds_read_b64_tr_b16 v[166:167], v24 offset:2176
    v_mfma_f32_16x16x32_bf16 v[68:71], v[212:215], v[192:195], 0
    ds_read_b64_tr_b16 v[226:227], v240 offset:16896
    v_mfma_f32_16x16x32_bf16 v[72:75], v[216:219], v[192:195], 0
    ds_read_b64_tr_b16 v[228:229], v241 offset:16384
    ds_read_b128 v[168:171], v21 offset:8192
    v_mfma_f32_16x16x32_bf16 v[76:79], v[220:223], v[192:195], 0
    ds_read_b128 v[192:195], v245 offset:0
    v_mfma_f32_16x16x32_bf16 v[80:83], v[208:211], v[196:199], 0
    ds_read_b64_tr_b16 v[230:231], v241 offset:16896
    v_mfma_f32_16x16x32_bf16 v[84:87], v[212:215], v[196:199], 0
    ds_read_b64_tr_b16 v[232:233], v240 offset:24576
    ds_read_b64_tr_b16 v[172:173], v24 offset:3072
    v_mfma_f32_16x16x32_bf16 v[88:91], v[216:219], v[196:199], 0
    ds_read_b64_tr_b16 v[234:235], v240 offset:25088
    v_mfma_f32_16x16x32_bf16 v[92:95], v[220:223], v[196:199], 0
    s_waitcnt lgkmcnt(12)
    ds_read_b128 v[196:199], v245 offset:2048
    v_mfma_f32_16x16x32_bf16 v[96:99], v[208:211], v[200:203], 0
    ds_read_b64_tr_b16 v[236:237], v241 offset:24576
    v_mfma_f32_16x16x32_bf16 v[100:103], v[212:215], v[200:203], 0
    ds_read_b64_tr_b16 v[238:239], v241 offset:25088
    ds_read_b64_tr_b16 v[174:175], v24 offset:3200
    v_mfma_f32_16x16x32_bf16 v[104:107], v[216:219], v[200:203], 0
    v_mfma_f32_16x16x32_bf16 v[108:111], v[220:223], v[200:203], 0
    ds_read_b128 v[200:203], v245 offset:4096
    v_mfma_f32_16x16x32_bf16 v[112:115], v[208:211], v[204:207], 0
    v_mfma_f32_16x16x32_bf16 v[116:119], v[212:215], v[204:207], 0
    buffer_load_dword v15, v13, s[8:11], 0 offen sc1
    v_mfma_f32_16x16x32_bf16 v[120:123], v[216:219], v[204:207], 0
    v_mfma_f32_16x16x32_bf16 v[124:127], v[220:223], v[204:207], 0
    s_waitcnt lgkmcnt(1)
    ds_read_b128 v[204:207], v245 offset:6144
    v_mfma_f32_16x16x32_bf16 v[128:131], v[164:167], v[160:163], v[128:131]
    ds_read_b128 v[144:147], v20 offset:16384
    v_mfma_f32_16x16x32_bf16 v[128:131], v[172:175], v[168:171], v[128:131]
    ds_read_b64_tr_b16 v[148:149], v24 offset:4096
    v_mfma_f32_16x16x32_bf16 v[64:67], v[224:227], v[192:195], v[64:67]
    s_barrier
    ds_read_b64_tr_b16 v[208:209], v240 offset:32768
    ds_read_b64_tr_b16 v[150:151], v24 offset:4224
    v_mfma_f32_16x16x32_bf16 v[68:71], v[228:231], v[192:195], v[68:71]
    ds_read_b64_tr_b16 v[210:211], v240 offset:33280
    v_mov_b32 v248, 0xc0135761
    v_mfma_f32_16x16x32_bf16 v[72:75], v[232:235], v[192:195], v[72:75]
    ds_read_b64_tr_b16 v[212:213], v241 offset:32768
    ds_read_b128 v[152:155], v21 offset:16384
    v_mfma_f32_16x16x32_bf16 v[76:79], v[236:239], v[192:195], v[76:79]
    ds_read_b128 v[192:195], v244 offset:8192
    v_mov_b32 v249, 0xbdd2d3e8
    v_mfma_f32_16x16x32_bf16 v[80:83], v[224:227], v[196:199], v[80:83]
    ds_read_b64_tr_b16 v[214:215], v241 offset:33280
    v_mov_b32 v250, 1.0
    v_mfma_f32_16x16x32_bf16 v[84:87], v[228:231], v[196:199], v[84:87]
    ds_read_b64_tr_b16 v[216:217], v240 offset:40960
    ds_read_b64_tr_b16 v[156:157], v24 offset:5120
    v_mfma_f32_16x16x32_bf16 v[88:91], v[232:235], v[196:199], v[88:91]
    ds_read_b64_tr_b16 v[218:219], v240 offset:41472
    s_mul_i32 s49, s48, 6144
    v_mfma_f32_16x16x32_bf16 v[92:95], v[236:239], v[196:199], v[92:95]
    s_waitcnt lgkmcnt(12)
    ds_read_b128 v[196:199], v244 offset:10240
    s_add_u32 s49, s49, 135168
    v_mfma_f32_16x16x32_bf16 v[96:99], v[224:227], v[200:203], v[96:99]
    ds_read_b64_tr_b16 v[220:221], v241 offset:40960
    v_and_b32 v22, 6, v1
    v_mfma_f32_16x16x32_bf16 v[100:103], v[228:231], v[200:203], v[100:103]
    ds_read_b64_tr_b16 v[222:223], v241 offset:41472
    ds_read_b64_tr_b16 v[158:159], v24 offset:5248
    v_mfma_f32_16x16x32_bf16 v[104:107], v[232:235], v[200:203], v[104:107]
    v_xor_b32 v22, v22, v2
    v_mfma_f32_16x16x32_bf16 v[108:111], v[236:239], v[200:203], v[108:111]
    ds_read_b128 v[200:203], v244 offset:12288
    s_lshl_b32 s60, s7, 7
    v_mfma_f32_16x16x32_bf16 v[112:115], v[224:227], v[204:207], v[112:115]
    v_lshlrev_b32 v2, 10, v1
    v_mfma_f32_16x16x32_bf16 v[116:119], v[228:231], v[204:207], v[116:119]
    v_lshl_add_u32 v2, v22, 4, v2
    v_mfma_f32_16x16x32_bf16 v[120:123], v[232:235], v[204:207], v[120:123]
    v_add_u32 v2, s60, v2
    v_mfma_f32_16x16x32_bf16 v[124:127], v[236:239], v[204:207], v[124:127]
    s_waitcnt lgkmcnt(1)
    ds_read_b128 v[204:207], v244 offset:14336
    v_add_u32 v3, 7168, v2
    v_mfma_f32_16x16x32_bf16 v[128:131], v[148:151], v[144:147], v[128:131]
    ds_read_b128 v[160:163], v20 offset:24576
    v_mfma_f32_16x16x32_bf16 v[128:131], v[156:159], v[152:155], v[128:131]
    ds_read_b64_tr_b16 v[164:165], v24 offset:6144
    v_mfma_f32_16x16x32_bf16 v[64:67], v[208:211], v[192:195], v[64:67]
    s_barrier
    ds_read_b64_tr_b16 v[224:225], v242 offset:0
    ds_read_b64_tr_b16 v[166:167], v24 offset:6272
    v_mfma_f32_16x16x32_bf16 v[68:71], v[212:215], v[192:195], v[68:71]
    ds_read_b64_tr_b16 v[226:227], v242 offset:512
    v_bfe_u32 v22, v0, 3, 2
    v_mfma_f32_16x16x32_bf16 v[72:75], v[216:219], v[192:195], v[72:75]
    ds_read_b64_tr_b16 v[228:229], v243 offset:0
    ds_read_b128 v[168:171], v21 offset:24576
    v_mfma_f32_16x16x32_bf16 v[76:79], v[220:223], v[192:195], v[76:79]
    ds_read_b128 v[192:195], v245 offset:8192
    s_lshl_b32 s60, s50, 1
    v_mfma_f32_16x16x32_bf16 v[80:83], v[208:211], v[196:199], v[80:83]
    ds_read_b64_tr_b16 v[230:231], v243 offset:512
    v_xor_b32 v22, s60, v22
    v_mfma_f32_16x16x32_bf16 v[84:87], v[212:215], v[196:199], v[84:87]
    ds_read_b64_tr_b16 v[232:233], v242 offset:8192
    ds_read_b64_tr_b16 v[172:173], v24 offset:7168
    v_mfma_f32_16x16x32_bf16 v[88:91], v[216:219], v[196:199], v[88:91]
    ds_read_b64_tr_b16 v[234:235], v242 offset:8704
    v_lshrrev_b32 v23, 2, v0
    v_mfma_f32_16x16x32_bf16 v[92:95], v[220:223], v[196:199], v[92:95]
    s_waitcnt lgkmcnt(12)
    ds_read_b128 v[196:199], v245 offset:10240
    v_lshlrev_b32 v23, 7, v23
    v_mfma_f32_16x16x32_bf16 v[96:99], v[208:211], v[200:203], v[96:99]
    ds_read_b64_tr_b16 v[236:237], v243 offset:8192
    v_lshl_add_u32 v23, v22, 5, v23
    v_mfma_f32_16x16x32_bf16 v[100:103], v[212:215], v[200:203], v[100:103]
    ds_read_b64_tr_b16 v[238:239], v243 offset:8704
    ds_read_b64_tr_b16 v[174:175], v24 offset:7296
    v_mfma_f32_16x16x32_bf16 v[104:107], v[216:219], v[200:203], v[104:107]
    v_and_b32 v22, 3, v0
    v_mfma_f32_16x16x32_bf16 v[108:111], v[220:223], v[200:203], v[108:111]
    ds_read_b128 v[200:203], v245 offset:12288
    v_lshl_add_u32 v23, v22, 3, v23
    v_mfma_f32_16x16x32_bf16 v[112:115], v[208:211], v[204:207], v[112:115]
    v_add_u32 v4, s49, v23
    v_mfma_f32_16x16x32_bf16 v[116:119], v[212:215], v[204:207], v[116:119]
    v_xor_b32 v5, 32, v4
    v_mfma_f32_16x16x32_bf16 v[120:123], v[216:219], v[204:207], v[120:123]
    s_lshl_b32 s61, s50, 15
    v_mfma_f32_16x16x32_bf16 v[124:127], v[220:223], v[204:207], v[124:127]
    s_waitcnt lgkmcnt(1)
    ds_read_b128 v[204:207], v245 offset:14336
    s_add_u32 s61, s61, 86016
    v_mfma_f32_16x16x32_bf16 v[128:131], v[164:167], v[160:163], v[128:131]
    ds_read_b128 v[144:147], v20 offset:32768
    v_mfma_f32_16x16x32_bf16 v[128:131], v[172:175], v[168:171], v[128:131]
    ds_read_b64_tr_b16 v[148:149], v24 offset:8192
    v_mfma_f32_16x16x32_bf16 v[64:67], v[224:227], v[192:195], v[64:67]
    s_barrier
    ds_read_b64_tr_b16 v[208:209], v242 offset:16384
    ds_read_b64_tr_b16 v[150:151], v24 offset:8320
    v_mfma_f32_16x16x32_bf16 v[68:71], v[228:231], v[192:195], v[68:71]
    ds_read_b64_tr_b16 v[210:211], v242 offset:16896
    v_lshrrev_b32 v22, 5, v0
    v_mfma_f32_16x16x32_bf16 v[72:75], v[232:235], v[192:195], v[72:75]
    ds_read_b64_tr_b16 v[212:213], v243 offset:16384
    ds_read_b128 v[152:155], v21 offset:32768
    v_mfma_f32_16x16x32_bf16 v[76:79], v[236:239], v[192:195], v[76:79]
    ds_read_b128 v[192:195], v244 offset:16384
    v_lshl_add_u32 v23, v22, 10, v23
    v_mfma_f32_16x16x32_bf16 v[80:83], v[224:227], v[196:199], v[80:83]
    ds_read_b64_tr_b16 v[214:215], v243 offset:16896
    v_add_u32 v56, s61, v23
    v_mfma_f32_16x16x32_bf16 v[84:87], v[228:231], v[196:199], v[84:87]
    ds_read_b64_tr_b16 v[216:217], v242 offset:24576
    ds_read_b64_tr_b16 v[156:157], v24 offset:9216
    v_mfma_f32_16x16x32_bf16 v[88:91], v[232:235], v[196:199], v[88:91]
    ds_read_b64_tr_b16 v[218:219], v242 offset:25088
    v_xor_b32 v57, 32, v56
    v_mfma_f32_16x16x32_bf16 v[92:95], v[236:239], v[196:199], v[92:95]
    s_waitcnt lgkmcnt(12)
    ds_read_b128 v[196:199], v244 offset:18432
    v_xor_b32 v58, 64, v56
    v_mfma_f32_16x16x32_bf16 v[96:99], v[224:227], v[200:203], v[96:99]
    ds_read_b64_tr_b16 v[220:221], v243 offset:24576
    v_xor_b32 v59, 96, v56
    v_mfma_f32_16x16x32_bf16 v[100:103], v[228:231], v[200:203], v[100:103]
    ds_read_b64_tr_b16 v[222:223], v243 offset:25088
    ds_read_b64_tr_b16 v[158:159], v24 offset:9344
    v_mfma_f32_16x16x32_bf16 v[104:107], v[232:235], v[200:203], v[104:107]
    s_mul_i32 s60, s18, 224
    v_mfma_f32_16x16x32_bf16 v[108:111], v[236:239], v[200:203], v[108:111]
    ds_read_b128 v[200:203], v244 offset:20480
    s_mul_i32 s61, s48, 28
    v_mfma_f32_16x16x32_bf16 v[112:115], v[224:227], v[204:207], v[112:115]
    s_add_u32 s61, s60, s61
    v_mfma_f32_16x16x32_bf16 v[116:119], v[228:231], v[204:207], v[116:119]
    s_lshl_b32 s61, s61, 10
    v_mfma_f32_16x16x32_bf16 v[120:123], v[232:235], v[204:207], v[120:123]
    s_add_u32 s61, s61, 5242880
    v_mfma_f32_16x16x32_bf16 v[124:127], v[236:239], v[204:207], v[124:127]
    s_waitcnt lgkmcnt(1)
    ds_read_b128 v[204:207], v244 offset:22528
    s_mul_i32 s63, s51, 114688
    v_mfma_f32_16x16x32_bf16 v[128:131], v[148:151], v[144:147], v[128:131]
    ds_read_b128 v[160:163], v20 offset:40960
    v_mfma_f32_16x16x32_bf16 v[128:131], v[156:159], v[152:155], v[128:131]
    ds_read_b64_tr_b16 v[164:165], v24 offset:10240
    v_mfma_f32_16x16x32_bf16 v[64:67], v[208:211], v[192:195], v[64:67]
    s_barrier
    ds_read_b64_tr_b16 v[224:225], v240 offset:0
    ds_read_b64_tr_b16 v[166:167], v24 offset:10368
    v_mfma_f32_16x16x32_bf16 v[68:71], v[212:215], v[192:195], v[68:71]
    ds_read_b64_tr_b16 v[226:227], v240 offset:512
    s_add_u32 s55, s61, s63
    v_mfma_f32_16x16x32_bf16 v[72:75], v[216:219], v[192:195], v[72:75]
    ds_read_b64_tr_b16 v[228:229], v241 offset:0
    ds_read_b128 v[168:171], v21 offset:40960
    v_mfma_f32_16x16x32_bf16 v[76:79], v[220:223], v[192:195], v[76:79]
    ds_read_b128 v[192:195], v245 offset:16384
    v_add_u32 v7, s55, v6
    v_mfma_f32_16x16x32_bf16 v[80:83], v[208:211], v[196:199], v[80:83]
    ds_read_b64_tr_b16 v[230:231], v241 offset:512
    s_add_u32 s61, s61, 114688
    v_mfma_f32_16x16x32_bf16 v[84:87], v[212:215], v[196:199], v[84:87]
    ds_read_b64_tr_b16 v[232:233], v240 offset:8192
    ds_read_b64_tr_b16 v[172:173], v24 offset:11264
    v_mfma_f32_16x16x32_bf16 v[88:91], v[216:219], v[196:199], v[88:91]
    ds_read_b64_tr_b16 v[234:235], v240 offset:8704
    s_sub_u32 s61, s61, s63
    v_mfma_f32_16x16x32_bf16 v[92:95], v[220:223], v[196:199], v[92:95]
    s_waitcnt lgkmcnt(12)
    ds_read_b128 v[196:199], v245 offset:18432
    v_add_u32 v8, s61, v6
    v_mfma_f32_16x16x32_bf16 v[96:99], v[208:211], v[200:203], v[96:99]
    ds_read_b64_tr_b16 v[236:237], v241 offset:8192
    s_mul_i32 s60, s6, 224
    v_mfma_f32_16x16x32_bf16 v[100:103], v[212:215], v[200:203], v[100:103]
    ds_read_b64_tr_b16 v[238:239], v241 offset:8704
    ds_read_b64_tr_b16 v[174:175], v24 offset:11392
    v_mfma_f32_16x16x32_bf16 v[104:107], v[216:219], v[200:203], v[104:107]
    s_add_u32 s61, s97, s51
    v_mfma_f32_16x16x32_bf16 v[108:111], v[220:223], v[200:203], v[108:111]
    ds_read_b128 v[200:203], v245 offset:20480
    s_lshl2_add_u32 s60, s61, s60
    v_mfma_f32_16x16x32_bf16 v[112:115], v[208:211], v[204:207], v[112:115]
    s_lshl1_add_u32 s60, s50, s60
    v_mfma_f32_16x16x32_bf16 v[116:119], v[212:215], v[204:207], v[116:119]
    s_lshl_b32 s60, s60, 10
    v_mfma_f32_16x16x32_bf16 v[120:123], v[216:219], v[204:207], v[120:123]
    s_add_u32 s98, s60, 5242880
    v_mfma_f32_16x16x32_bf16 v[124:127], v[220:223], v[204:207], v[124:127]
    s_waitcnt lgkmcnt(1)
    ds_read_b128 v[204:207], v245 offset:22528
    s_add_u32 s99, s98, 114688
    v_mfma_f32_16x16x32_bf16 v[128:131], v[164:167], v[160:163], v[128:131]
    ds_read_b128 v[144:147], v20 offset:49152
    v_mfma_f32_16x16x32_bf16 v[128:131], v[172:175], v[168:171], v[128:131]
    ds_read_b64_tr_b16 v[148:149], v24 offset:12288
    v_mfma_f32_16x16x32_bf16 v[64:67], v[224:227], v[192:195], v[64:67]
    s_barrier
    ds_read_b64_tr_b16 v[208:209], v240 offset:16384
    ds_read_b64_tr_b16 v[150:151], v24 offset:12416
    v_mfma_f32_16x16x32_bf16 v[68:71], v[228:231], v[192:195], v[68:71]
    ds_read_b64_tr_b16 v[210:211], v240 offset:16896
    s_add_u32 s60, s79, 1
    v_mfma_f32_16x16x32_bf16 v[72:75], v[232:235], v[192:195], v[72:75]
    ds_read_b64_tr_b16 v[212:213], v241 offset:16384
    ds_read_b128 v[152:155], v21 offset:49152
    v_mfma_f32_16x16x32_bf16 v[76:79], v[236:239], v[192:195], v[76:79]
    ds_read_b128 v[192:195], v244 offset:24576
    s_lshl_b32 s60, s60, 12
    v_mfma_f32_16x16x32_bf16 v[80:83], v[224:227], v[196:199], v[80:83]
    ds_read_b64_tr_b16 v[214:215], v241 offset:16896
    s_sub_u32 s75, s98, s60
    v_mfma_f32_16x16x32_bf16 v[84:87], v[228:231], v[196:199], v[84:87]
    ds_read_b64_tr_b16 v[216:217], v240 offset:24576
    ds_read_b64_tr_b16 v[156:157], v24 offset:13312
    v_mfma_f32_16x16x32_bf16 v[88:91], v[232:235], v[196:199], v[88:91]
    ds_read_b64_tr_b16 v[218:219], v240 offset:25088
    s_sub_u32 s76, s99, s60
    v_mfma_f32_16x16x32_bf16 v[92:95], v[236:239], v[196:199], v[92:95]
    s_waitcnt lgkmcnt(12)
    ds_read_b128 v[196:199], v244 offset:26624
    v_mfma_f32_16x16x32_bf16 v[96:99], v[224:227], v[200:203], v[96:99]
    ds_read_b64_tr_b16 v[220:221], v241 offset:24576
    v_mfma_f32_16x16x32_bf16 v[100:103], v[228:231], v[200:203], v[100:103]
    ds_read_b64_tr_b16 v[222:223], v241 offset:25088
    ds_read_b64_tr_b16 v[158:159], v24 offset:13440
    v_mfma_f32_16x16x32_bf16 v[104:107], v[232:235], v[200:203], v[104:107]
    v_mfma_f32_16x16x32_bf16 v[108:111], v[236:239], v[200:203], v[108:111]
    ds_read_b128 v[200:203], v244 offset:28672
    v_mfma_f32_16x16x32_bf16 v[112:115], v[224:227], v[204:207], v[112:115]
    v_mfma_f32_16x16x32_bf16 v[116:119], v[228:231], v[204:207], v[116:119]
    v_mfma_f32_16x16x32_bf16 v[120:123], v[232:235], v[204:207], v[120:123]
    v_mfma_f32_16x16x32_bf16 v[124:127], v[236:239], v[204:207], v[124:127]
    s_waitcnt lgkmcnt(1)
    ds_read_b128 v[204:207], v244 offset:30720
    v_mfma_f32_16x16x32_bf16 v[128:131], v[148:151], v[144:147], v[128:131]
    ds_read_b128 v[160:163], v20 offset:57344
    v_mfma_f32_16x16x32_bf16 v[128:131], v[156:159], v[152:155], v[128:131]
    ds_read_b64_tr_b16 v[164:165], v24 offset:14336
    v_mfma_f32_16x16x32_bf16 v[64:67], v[208:211], v[192:195], v[64:67]
    s_barrier
    ds_read_b64_tr_b16 v[224:225], v240 offset:32768
    ds_read_b64_tr_b16 v[166:167], v24 offset:14464
    v_mfma_f32_16x16x32_bf16 v[68:71], v[212:215], v[192:195], v[68:71]
    ds_read_b64_tr_b16 v[226:227], v240 offset:33280
    v_mfma_f32_16x16x32_bf16 v[72:75], v[216:219], v[192:195], v[72:75]
    ds_read_b64_tr_b16 v[228:229], v241 offset:32768
    ds_read_b128 v[168:171], v21 offset:57344
    v_mfma_f32_16x16x32_bf16 v[76:79], v[220:223], v[192:195], v[76:79]
    ds_read_b128 v[192:195], v245 offset:24576
    v_mfma_f32_16x16x32_bf16 v[80:83], v[208:211], v[196:199], v[80:83]
    ds_read_b64_tr_b16 v[230:231], v241 offset:33280
    v_mfma_f32_16x16x32_bf16 v[84:87], v[212:215], v[196:199], v[84:87]
    ds_read_b64_tr_b16 v[232:233], v240 offset:40960
    ds_read_b64_tr_b16 v[172:173], v24 offset:15360
    v_mfma_f32_16x16x32_bf16 v[88:91], v[216:219], v[196:199], v[88:91]
    ds_read_b64_tr_b16 v[234:235], v240 offset:41472
    v_mfma_f32_16x16x32_bf16 v[92:95], v[220:223], v[196:199], v[92:95]
    s_waitcnt lgkmcnt(12)
    ds_read_b128 v[196:199], v245 offset:26624
    v_mfma_f32_16x16x32_bf16 v[96:99], v[208:211], v[200:203], v[96:99]
    ds_read_b64_tr_b16 v[236:237], v241 offset:40960
    v_mfma_f32_16x16x32_bf16 v[100:103], v[212:215], v[200:203], v[100:103]
    ds_read_b64_tr_b16 v[238:239], v241 offset:41472
    ds_read_b64_tr_b16 v[174:175], v24 offset:15488
    v_mfma_f32_16x16x32_bf16 v[104:107], v[216:219], v[200:203], v[104:107]
    v_mfma_f32_16x16x32_bf16 v[108:111], v[220:223], v[200:203], v[108:111]
    ds_read_b128 v[200:203], v245 offset:28672
    v_mfma_f32_16x16x32_bf16 v[112:115], v[208:211], v[204:207], v[112:115]
    v_mfma_f32_16x16x32_bf16 v[116:119], v[212:215], v[204:207], v[116:119]
    v_mfma_f32_16x16x32_bf16 v[120:123], v[216:219], v[204:207], v[120:123]
    v_mfma_f32_16x16x32_bf16 v[124:127], v[220:223], v[204:207], v[124:127]
    s_waitcnt lgkmcnt(1)
    ds_read_b128 v[204:207], v245 offset:30720
    v_mfma_f32_16x16x32_bf16 v[128:131], v[164:167], v[160:163], v[128:131]
    v_mfma_f32_16x16x32_bf16 v[128:131], v[172:175], v[168:171], v[128:131]
    v_mfma_f32_16x16x32_bf16 v[64:67], v[224:227], v[192:195], v[64:67]
    s_barrier
    ds_read_b64_tr_b16 v[208:209], v242 offset:0
    v_mfma_f32_16x16x32_bf16 v[68:71], v[228:231], v[192:195], v[68:71]
    ds_read_b64_tr_b16 v[210:211], v242 offset:512
    v_mfma_f32_16x16x32_bf16 v[72:75], v[232:235], v[192:195], v[72:75]
    ds_read_b64_tr_b16 v[212:213], v243 offset:0
    v_mfma_f32_16x16x32_bf16 v[76:79], v[236:239], v[192:195], v[76:79]
    ds_read_b128 v[192:195], v244 offset:32768
    v_mfma_f32_16x16x32_bf16 v[80:83], v[224:227], v[196:199], v[80:83]
    ds_read_b64_tr_b16 v[214:215], v243 offset:512
    v_mfma_f32_16x16x32_bf16 v[84:87], v[228:231], v[196:199], v[84:87]
    ds_read_b64_tr_b16 v[216:217], v242 offset:8192
    v_mfma_f32_16x16x32_bf16 v[88:91], v[232:235], v[196:199], v[88:91]
    ds_read_b64_tr_b16 v[218:219], v242 offset:8704
    v_mfma_f32_16x16x32_bf16 v[92:95], v[236:239], v[196:199], v[92:95]
    s_waitcnt lgkmcnt(7)
    ds_read_b128 v[196:199], v244 offset:34816
    v_mfma_f32_16x16x32_bf16 v[96:99], v[224:227], v[200:203], v[96:99]
    ds_read_b64_tr_b16 v[220:221], v243 offset:8192
    v_mul_f32 v128, 0x3eb8aa3b, v128
    v_mfma_f32_16x16x32_bf16 v[100:103], v[228:231], v[200:203], v[100:103]
    ds_read_b64_tr_b16 v[222:223], v243 offset:8704
    v_mul_f32 v129, 0x3eb8aa3b, v129
    v_mfma_f32_16x16x32_bf16 v[104:107], v[232:235], v[200:203], v[104:107]
    v_mul_f32 v130, 0x3eb8aa3b, v130
    v_mul_f32 v131, 0x3eb8aa3b, v131
    v_cvt_pk_bf16_f32 v132, v128, v129
    v_mfma_f32_16x16x32_bf16 v[108:111], v[236:239], v[200:203], v[108:111]
    ds_read_b128 v[200:203], v244 offset:36864
    v_cvt_pk_bf16_f32 v133, v130, v131
    v_mfma_f32_16x16x32_bf16 v[112:115], v[224:227], v[204:207], v[112:115]
    buffer_store_dwordx2 v[132:133], v25, s[40:43], s64 offen sc1
    v_mfma_f32_16x16x32_bf16 v[116:119], v[228:231], v[204:207], v[116:119]
    v_mfma_f32_16x16x32_bf16 v[120:123], v[232:235], v[204:207], v[120:123]
    v_mfma_f32_16x16x32_bf16 v[124:127], v[236:239], v[204:207], v[124:127]
    s_waitcnt lgkmcnt(1)
    ds_read_b128 v[204:207], v244 offset:38912
    v_mfma_f32_16x16x32_bf16 v[64:67], v[208:211], v[192:195], v[64:67]
    s_barrier
    ds_read_b64_tr_b16 v[224:225], v242 offset:16384
    v_mfma_f32_16x16x32_bf16 v[68:71], v[212:215], v[192:195], v[68:71]
    ds_read_b64_tr_b16 v[226:227], v242 offset:16896
    v_mfma_f32_16x16x32_bf16 v[72:75], v[216:219], v[192:195], v[72:75]
    ds_read_b64_tr_b16 v[228:229], v243 offset:16384
    v_mfma_f32_16x16x32_bf16 v[76:79], v[220:223], v[192:195], v[76:79]
    ds_read_b128 v[192:195], v245 offset:32768
    v_mfma_f32_16x16x32_bf16 v[80:83], v[208:211], v[196:199], v[80:83]
    ds_read_b64_tr_b16 v[230:231], v243 offset:16896
    v_mfma_f32_16x16x32_bf16 v[84:87], v[212:215], v[196:199], v[84:87]
    ds_read_b64_tr_b16 v[232:233], v242 offset:24576
    v_mfma_f32_16x16x32_bf16 v[88:91], v[216:219], v[196:199], v[88:91]
    ds_read_b64_tr_b16 v[234:235], v242 offset:25088
    v_mfma_f32_16x16x32_bf16 v[92:95], v[220:223], v[196:199], v[92:95]
    s_waitcnt lgkmcnt(7)
    ds_read_b128 v[196:199], v245 offset:34816
    v_mfma_f32_16x16x32_bf16 v[96:99], v[208:211], v[200:203], v[96:99]
    ds_read_b64_tr_b16 v[236:237], v243 offset:24576
    v_mfma_f32_16x16x32_bf16 v[100:103], v[212:215], v[200:203], v[100:103]
    ds_read_b64_tr_b16 v[238:239], v243 offset:25088
    v_mfma_f32_16x16x32_bf16 v[104:107], v[216:219], v[200:203], v[104:107]
    v_mfma_f32_16x16x32_bf16 v[108:111], v[220:223], v[200:203], v[108:111]
    ds_read_b128 v[200:203], v245 offset:36864
    v_mfma_f32_16x16x32_bf16 v[112:115], v[208:211], v[204:207], v[112:115]
    v_mfma_f32_16x16x32_bf16 v[116:119], v[212:215], v[204:207], v[116:119]
    v_mfma_f32_16x16x32_bf16 v[120:123], v[216:219], v[204:207], v[120:123]
    v_mfma_f32_16x16x32_bf16 v[124:127], v[220:223], v[204:207], v[124:127]
    s_waitcnt lgkmcnt(1)
    ds_read_b128 v[204:207], v245 offset:38912
    v_mfma_f32_16x16x32_bf16 v[64:67], v[224:227], v[192:195], v[64:67]
    s_barrier
    ds_read_b64_tr_b16 v[208:209], v240 offset:0
    v_mfma_f32_16x16x32_bf16 v[68:71], v[228:231], v[192:195], v[68:71]
    ds_read_b64_tr_b16 v[210:211], v240 offset:512
    v_mfma_f32_16x16x32_bf16 v[72:75], v[232:235], v[192:195], v[72:75]
    ds_read_b64_tr_b16 v[212:213], v241 offset:0
    v_mfma_f32_16x16x32_bf16 v[76:79], v[236:239], v[192:195], v[76:79]
    ds_read_b128 v[192:195], v244 offset:40960
    v_mfma_f32_16x16x32_bf16 v[80:83], v[224:227], v[196:199], v[80:83]
    ds_read_b64_tr_b16 v[214:215], v241 offset:512
    v_mfma_f32_16x16x32_bf16 v[84:87], v[228:231], v[196:199], v[84:87]
    ds_read_b64_tr_b16 v[216:217], v240 offset:8192
    v_mfma_f32_16x16x32_bf16 v[88:91], v[232:235], v[196:199], v[88:91]
    ds_read_b64_tr_b16 v[218:219], v240 offset:8704
    v_mfma_f32_16x16x32_bf16 v[92:95], v[236:239], v[196:199], v[92:95]
    s_waitcnt lgkmcnt(7)
    ds_read_b128 v[196:199], v244 offset:43008
    v_mfma_f32_16x16x32_bf16 v[96:99], v[224:227], v[200:203], v[96:99]
    ds_read_b64_tr_b16 v[220:221], v241 offset:8192
    v_mfma_f32_16x16x32_bf16 v[100:103], v[228:231], v[200:203], v[100:103]
    ds_read_b64_tr_b16 v[222:223], v241 offset:8704
    v_mfma_f32_16x16x32_bf16 v[104:107], v[232:235], v[200:203], v[104:107]
    v_mfma_f32_16x16x32_bf16 v[108:111], v[236:239], v[200:203], v[108:111]
    ds_read_b128 v[200:203], v244 offset:45056
    v_mfma_f32_16x16x32_bf16 v[112:115], v[224:227], v[204:207], v[112:115]
    v_mfma_f32_16x16x32_bf16 v[116:119], v[228:231], v[204:207], v[116:119]
    s_cmp_gt_u32 s51, s79
    s_cselect_b32 s77, 1, 0
    s_mul_i32 s55, s48, 458752
    s_and_b32 s61, s18, 3
    s_lshl1_add_u32 s60, s61, s7
    s_cmp_ge_u32 s60, 7
    s_cselect_b32 s61, 7, 0
    s_sub_u32 s60, s60, s61
    s_lshl_b32 s53, s60, 12
    s_lshl2_add_u32 s60, s6, s5
    s_lshl_b32 s60, s60, 7
    s_lshl4_add_u32 s60, s79, s60
    s_lshl2_add_u32 s60, s48, s60
    s_add_u32 s67, s60, 4718592
    s_lshl2_add_u32 s60, s18, s48
    s_lshl_b32 s60, s60, 7
    s_add_u32 s66, s60, 4718592
    v_and_b32 v11, 7, v0
    v_lshlrev_b32 v11, 2, v11
    v_bfe_u32 v22, v0, 3, 1
    v_lshl_add_u32 v11, v22, 14, v11
    s_lshl1_add_u32 s60, s18, s50
    s_lshr_b32 s61, s7, 2
    s_lshl1_add_u32 s60, s60, s61
    s_lshl_b32 s60, s60, 7
    s_lshl3_add_u32 s60, s54, s60
    s_lshl2_add_u32 s60, s51, s60
    s_add_u32 s72, s60, 4734976
    v_add_u32 v9, s49, v6
    v_mov_b32 v1, 1
    s_waitcnt vmcnt(1)
    v_readfirstlane_b32 s4, v15
    s_nop 3
    s_cmp_eq_u32 s4, 0
    s_cbranch_scc1 L_nspin_33
L_ngot_34:
    v_mfma_f32_16x16x32_bf16 v[120:123], v[232:235], v[204:207], v[120:123]
    v_mfma_f32_16x16x32_bf16 v[124:127], v[236:239], v[204:207], v[124:127]
    s_waitcnt lgkmcnt(1)
    ds_read_b128 v[204:207], v244 offset:47104
    s_branch L_kvjoin
L_cv:
L_pad_cv:
    s_cbranch_execz L_ret_cv
    s_barrier
    ds_read_b128 v[144:147], v20 offset:0
    ds_read_b64_tr_b16 v[148:149], v24 offset:0
    ds_read_b64_tr_b16 v[150:151], v24 offset:128
    ds_read_b128 v[152:155], v21 offset:0
    ds_read_b64_tr_b16 v[156:157], v24 offset:1024
    ds_read_b64_tr_b16 v[158:159], v24 offset:1152
    ds_read_b128 v[192:195], v244 offset:0
    ds_read_b64_tr_b16 v[208:209], v240 offset:0
    ds_read_b64_tr_b16 v[210:211], v240 offset:512
    ds_read_b64_tr_b16 v[212:213], v241 offset:0
    ds_read_b64_tr_b16 v[214:215], v241 offset:512
    ds_read_b64_tr_b16 v[216:217], v240 offset:8192
    ds_read_b64_tr_b16 v[218:219], v240 offset:8704
    ds_read_b64_tr_b16 v[220:221], v241 offset:8192
    ds_read_b64_tr_b16 v[222:223], v241 offset:8704
    ds_read_b128 v[196:199], v244 offset:2048
    ds_read_b128 v[200:203], v244 offset:4096
    ds_read_b128 v[204:207], v244 offset:6144
    s_waitcnt lgkmcnt(2)
    v_mfma_f32_16x16x32_bf16 v[128:131], v[144:147], v[148:151], 0
    ds_read_b128 v[160:163], v20 offset:8192
    v_mfma_f32_16x16x32_bf16 v[128:131], v[152:155], v[156:159], v[128:131]
    ds_read_b64_tr_b16 v[164:165], v24 offset:2048
    v_mfma_f32_16x16x32_bf16 v[64:67], v[208:211], v[192:195], 0
    s_barrier
    ds_read_b64_tr_b16 v[224:225], v240 offset:16384
    ds_read_b64_tr_b16 v[166:167], v24 offset:2176
    v_mfma_f32_16x16x32_bf16 v[68:71], v[212:215], v[192:195], 0
    ds_read_b64_tr_b16 v[226:227], v240 offset:16896
    v_mfma_f32_16x16x32_bf16 v[72:75], v[216:219], v[192:195], 0
    ds_read_b64_tr_b16 v[228:229], v241 offset:16384
    ds_read_b128 v[168:171], v21 offset:8192
    v_mfma_f32_16x16x32_bf16 v[76:79], v[220:223], v[192:195], 0
    ds_read_b128 v[192:195], v245 offset:0
    v_mfma_f32_16x16x32_bf16 v[80:83], v[208:211], v[196:199], 0
    ds_read_b64_tr_b16 v[230:231], v241 offset:16896
    v_mfma_f32_16x16x32_bf16 v[84:87], v[212:215], v[196:199], 0
    ds_read_b64_tr_b16 v[232:233], v240 offset:24576
    ds_read_b64_tr_b16 v[172:173], v24 offset:3072
    v_mfma_f32_16x16x32_bf16 v[88:91], v[216:219], v[196:199], 0
    ds_read_b64_tr_b16 v[234:235], v240 offset:25088
    v_mfma_f32_16x16x32_bf16 v[92:95], v[220:223], v[196:199], 0
    s_waitcnt lgkmcnt(12)
    ds_read_b128 v[196:199], v245 offset:2048
    v_mfma_f32_16x16x32_bf16 v[96:99], v[208:211], v[200:203], 0
    ds_read_b64_tr_b16 v[236:237], v241 offset:24576
    v_mfma_f32_16x16x32_bf16 v[100:103], v[212:215], v[200:203], 0
    ds_read_b64_tr_b16 v[238:239], v241 offset:25088
    ds_read_b64_tr_b16 v[174:175], v24 offset:3200
    v_mfma_f32_16x16x32_bf16 v[104:107], v[216:219], v[200:203], 0
    v_mfma_f32_16x16x32_bf16 v[108:111], v[220:223], v[200:203], 0
    ds_read_b128 v[200:203], v245 offset:4096
    v_mfma_f32_16x16x32_bf16 v[112:115], v[208:211], v[204:207], 0
    v_mfma_f32_16x16x32_bf16 v[116:119], v[212:215], v[204:207], 0
    buffer_load_dword v15, v13, s[8:11], 0 offen sc1
    v_mfma_f32_16x16x32_bf16 v[120:123], v[216:219], v[204:207], 0
    v_mfma_f32_16x16x32_bf16 v[124:127], v[220:223], v[204:207], 0
    s_waitcnt lgkmcnt(1)
    ds_read_b128 v[204:207], v245 offset:6144
    v_mfma_f32_16x16x32_bf16 v[128:131], v[160:163], v[164:167], v[128:131]
    ds_read_b128 v[144:147], v20 offset:16384
    v_mfma_f32_16x16x32_bf16 v[128:131], v[168:171], v[172:175], v[128:131]
    ds_read_b64_tr_b16 v[148:149], v24 offset:4096
    v_mfma_f32_16x16x32_bf16 v[64:67], v[224:227], v[192:195], v[64:67]
    s_barrier
    ds_read_b64_tr_b16 v[208:209], v240 offset:32768
    ds_read_b64_tr_b16 v[150:151], v24 offset:4224
    v_mfma_f32_16x16x32_bf16 v[68:71], v[228:231], v[192:195], v[68:71]
    ds_read_b64_tr_b16 v[210:211], v240 offset:33280
    v_mov_b32 v248, 0xc0135761
    v_mfma_f32_16x16x32_bf16 v[72:75], v[232:235], v[192:195], v[72:75]
    ds_read_b64_tr_b16 v[212:213], v241 offset:32768
    ds_read_b128 v[152:155], v21 offset:16384
    v_mfma_f32_16x16x32_bf16 v[76:79], v[236:239], v[192:195], v[76:79]
    ds_read_b128 v[192:195], v244 offset:8192
    v_mov_b32 v249, 0xbdd2d3e8
    v_mfma_f32_16x16x32_bf16 v[80:83], v[224:227], v[196:199], v[80:83]
L_pad_x968:
    s_cbranch_execz L_ret_x968
    ds_read_b64_tr_b16 v[214:215], v241 offset:33280
    v_mov_b32 v250, 1.0
    v_mfma_f32_16x16x32_bf16 v[84:87], v[228:231], v[196:199], v[84:87]
    ds_read_b64_tr_b16 v[216:217], v240 offset:40960
    ds_read_b64_tr_b16 v[156:157], v24 offset:5120
    v_mfma_f32_16x16x32_bf16 v[88:91], v[232:235], v[196:199], v[88:91]
    ds_read_b64_tr_b16 v[218:219], v240 offset:41472
    s_mul_i32 s49, s48, 6144
    v_mfma_f32_16x16x32_bf16 v[92:95], v[236:239], v[196:199], v[92:95]
    s_waitcnt lgkmcnt(12)
    ds_read_b128 v[196:199], v244 offset:10240
    s_add_u32 s49, s49, 135168
    v_mfma_f32_16x16x32_bf16 v[96:99], v[224:227], v[200:203], v[96:99]
    ds_read_b64_tr_b16 v[220:221], v241 offset:40960
    v_and_b32 v22, 6, v1
    v_mfma_f32_16x16x32_bf16 v[100:103], v[228:231], v[200:203], v[100:103]
    ds_read_b64_tr_b16 v[222:223], v241 offset:41472
    ds_read_b64_tr_b16 v[158:159], v24 offset:5248
    v_mfma_f32_16x16x32_bf16 v[104:107], v[232:235], v[200:203], v[104:107]
    v_xor_b32 v22, v22, v2
    v_mfma_f32_16x16x32_bf16 v[108:111], v[236:239], v[200:203], v[108:111]
    ds_read_b128 v[200:203], v244 offset:12288
    s_lshl_b32 s60, s7, 7
    v_mfma_f32_16x16x32_bf16 v[112:115], v[224:227], v[204:207], v[112:115]
    v_lshlrev_b32 v2, 10, v1
    v_mfma_f32_16x16x32_bf16 v[116:119], v[228:231], v[204:207], v[116:119]
    v_lshl_add_u32 v2, v22, 4, v2
    v_mfma_f32_16x16x32_bf16 v[120:123], v[232:235], v[204:207], v[120:123]
    v_add_u32 v2, s60, v2
    v_mfma_f32_16x16x32_bf16 v[124:127], v[236:239], v[204:207], v[124:127]
    s_waitcnt lgkmcnt(1)
    ds_read_b128 v[204:207], v244 offset:14336
    v_add_u32 v3, 7168, v2
    v_mfma_f32_16x16x32_bf16 v[128:131], v[144:147], v[148:151], v[128:131]
    ds_read_b128 v[160:163], v20 offset:24576
    v_mfma_f32_16x16x32_bf16 v[128:131], v[152:155], v[156:159], v[128:131]
    ds_read_b64_tr_b16 v[164:165], v24 offset:6144
    v_mfma_f32_16x16x32_bf16 v[64:67], v[208:211], v[192:195], v[64:67]
    s_barrier
    ds_read_b64_tr_b16 v[224:225], v242 offset:0
    ds_read_b64_tr_b16 v[166:167], v24 offset:6272
    v_mfma_f32_16x16x32_bf16 v[68:71], v[212:215], v[192:195], v[68:71]
    ds_read_b64_tr_b16 v[226:227], v242 offset:512
    v_bfe_u32 v22, v0, 3, 2
    v_mfma_f32_16x16x32_bf16 v[72:75], v[216:219], v[192:195], v[72:75]
    ds_read_b64_tr_b16 v[228:229], v243 offset:0
    ds_read_b128 v[168:171], v21 offset:24576
    v_mfma_f32_16x16x32_bf16 v[76:79], v[220:223], v[192:195], v[76:79]
    ds_read_b128 v[192:195], v245 offset:8192
    s_lshl_b32 s60, s50, 1
    v_mfma_f32_16x16x32_bf16 v[80:83], v[208:211], v[196:199], v[80:83]
    ds_read_b64_tr_b16 v[230:231], v243 offset:512
    v_xor_b32 v22, s60, v22
    v_mfma_f32_16x16x32_bf16 v[84:87], v[212:215], v[196:199], v[84:87]
    ds_read_b64_tr_b16 v[232:233], v242 offset:8192
    ds_read_b64_tr_b16 v[172:173], v24 offset:7168
    v_mfma_f32_16x16x32_bf16 v[88:91], v[216:219], v[196:199], v[88:91]
    ds_read_b64_tr_b16 v[234:235], v242 offset:8704
    v_lshrrev_b32 v23, 2, v0
    v_mfma_f32_16x16x32_bf16 v[92:95], v[220:223], v[196:199], v[92:95]
    s_waitcnt lgkmcnt(12)
    ds_read_b128 v[196:199], v245 offset:10240
    v_lshlrev_b32 v23, 7, v23
    v_mfma_f32_16x16x32_bf16 v[96:99], v[208:211], v[200:203], v[96:99]
    ds_read_b64_tr_b16 v[236:237], v243 offset:8192
    v_lshl_add_u32 v23, v22, 5, v23
    v_mfma_f32_16x16x32_bf16 v[100:103], v[212:215], v[200:203], v[100:103]
    ds_read_b64_tr_b16 v[238:239], v243 offset:8704
    ds_read_b64_tr_b16 v[174:175], v24 offset:7296
    v_mfma_f32_16x16x32_bf16 v[104:107], v[216:219], v[200:203], v[104:107]
    v_and_b32 v22, 3, v0
    v_mfma_f32_16x16x32_bf16 v[108:111], v[220:223], v[200:203], v[108:111]
    ds_read_b128 v[200:203], v245 offset:12288
    v_lshl_add_u32 v23, v22, 3, v23
    v_mfma_f32_16x16x32_bf16 v[112:115], v[208:211], v[204:207], v[112:115]
    v_add_u32 v4, s49, v23
    v_mfma_f32_16x16x32_bf16 v[116:119], v[212:215], v[204:207], v[116:119]
    v_xor_b32 v5, 32, v4
    v_mfma_f32_16x16x32_bf16 v[120:123], v[216:219], v[204:207], v[120:123]
    s_lshl_b32 s61, s50, 15
    v_mfma_f32_16x16x32_bf16 v[124:127], v[220:223], v[204:207], v[124:127]
    s_waitcnt lgkmcnt(1)
    ds_read_b128 v[204:207], v245 offset:14336
    s_add_u32 s61, s61, 86016
    v_mfma_f32_16x16x32_bf16 v[128:131], v[160:163], v[164:167], v[128:131]
    ds_read_b128 v[144:147], v20 offset:32768
    v_mfma_f32_16x16x32_bf16 v[128:131], v[168:171], v[172:175], v[128:131]
    ds_read_b64_tr_b16 v[148:149], v24 offset:8192
    v_mfma_f32_16x16x32_bf16 v[64:67], v[224:227], v[192:195], v[64:67]
    s_barrier
    ds_read_b64_tr_b16 v[208:209], v242 offset:16384
    ds_read_b64_tr_b16 v[150:151], v24 offset:8320
    v_mfma_f32_16x16x32_bf16 v[68:71], v[228:231], v[192:195], v[68:71]
    ds_read_b64_tr_b16 v[210:211], v242 offset:16896
    v_lshrrev_b32 v22, 5, v0
    v_mfma_f32_16x16x32_bf16 v[72:75], v[232:235], v[192:195], v[72:75]
    ds_read_b64_tr_b16 v[212:213], v243 offset:16384
    ds_read_b128 v[152:155], v21 offset:32768
    v_mfma_f32_16x16x32_bf16 v[76:79], v[236:239], v[192:195], v[76:79]
    ds_read_b128 v[192:195], v244 offset:16384
    v_lshl_add_u32 v23, v22, 10, v23
    v_mfma_f32_16x16x32_bf16 v[80:83], v[224:227], v[196:199], v[80:83]
    ds_read_b64_tr_b16 v[214:215], v243 offset:16896
    v_add_u32 v56, s61, v23
    v_mfma_f32_16x16x32_bf16 v[84:87], v[228:231], v[196:199], v[84:87]
    ds_read_b64_tr_b16 v[216:217], v242 offset:24576
    ds_read_b64_tr_b16 v[156:157], v24 offset:9216
    v_mfma_f32_16x16x32_bf16 v[88:91], v[232:235], v[196:199], v[88:91]
    ds_read_b64_tr_b16 v[218:219], v242 offset:25088
    v_xor_b32 v57, 32, v56
    v_mfma_f32_16x16x32_bf16 v[92:95], v[236:239], v[196:199], v[92:95]
    s_waitcnt lgkmcnt(12)
    ds_read_b128 v[196:199], v244 offset:18432
    v_xor_b32 v58, 64, v56
    v_mfma_f32_16x16x32_bf16 v[96:99], v[224:227], v[200:203], v[96:99]
    ds_read_b64_tr_b16 v[220:221], v243 offset:24576
    v_xor_b32 v59, 96, v56
    v_mfma_f32_16x16x32_bf16 v[100:103], v[228:231], v[200:203], v[100:103]
    ds_read_b64_tr_b16 v[222:223], v243 offset:25088
    ds_read_b64_tr_b16 v[158:159], v24 offset:9344
    v_mfma_f32_16x16x32_bf16 v[104:107], v[232:235], v[200:203], v[104:107]
    s_mul_i32 s60, s18, 224
    v_mfma_f32_16x16x32_bf16 v[108:111], v[236:239], v[200:203], v[108:111]
    ds_read_b128 v[200:203], v244 offset:20480
    s_mul_i32 s61, s48, 28
    v_mfma_f32_16x16x32_bf16 v[112:115], v[224:227], v[204:207], v[112:115]
    s_add_u32 s61, s60, s61
    v_mfma_f32_16x16x32_bf16 v[116:119], v[228:231], v[204:207], v[116:119]
    s_lshl_b32 s61, s61, 10
    v_mfma_f32_16x16x32_bf16 v[120:123], v[232:235], v[204:207], v[120:123]
    s_add_u32 s61, s61, 5242880
    v_mfma_f32_16x16x32_bf16 v[124:127], v[236:239], v[204:207], v[124:127]
    s_waitcnt lgkmcnt(1)
    ds_read_b128 v[204:207], v244 offset:22528
    s_mul_i32 s63, s51, 114688
    v_mfma_f32_16x16x32_bf16 v[128:131], v[144:147], v[148:151], v[128:131]
    ds_read_b128 v[160:163], v20 offset:40960
    v_mfma_f32_16x16x32_bf16 v[128:131], v[152:155], v[156:159], v[128:131]
    ds_read_b64_tr_b16 v[164:165], v24 offset:10240
    v_mfma_f32_16x16x32_bf16 v[64:67], v[208:211], v[192:195], v[64:67]
    s_barrier
    ds_read_b64_tr_b16 v[224:225], v240 offset:0
    ds_read_b64_tr_b16 v[166:167], v24 offset:10368
    v_mfma_f32_16x16x32_bf16 v[68:71], v[212:215], v[192:195], v[68:71]
    ds_read_b64_tr_b16 v[226:227], v240 offset:512
    s_add_u32 s55, s61, s63
    v_mfma_f32_16x16x32_bf16 v[72:75], v[216:219], v[192:195], v[72:75]
    ds_read_b64_tr_b16 v[228:229], v241 offset:0
    ds_read_b128 v[168:171], v21 offset:40960
    v_mfma_f32_16x16x32_bf16 v[76:79], v[220:223], v[192:195], v[76:79]
    ds_read_b128 v[192:195], v245 offset:16384
    v_add_u32 v7, s55, v6
    v_mfma_f32_16x16x32_bf16 v[80:83], v[208:211], v[196:199], v[80:83]
    ds_read_b64_tr_b16 v[230:231], v241 offset:512
    s_add_u32 s61, s61, 114688
    v_mfma_f32_16x16x32_bf16 v[84:87], v[212:215], v[196:199], v[84:87]
    ds_read_b64_tr_b16 v[232:233], v240 offset:8192
    ds_read_b64_tr_b16 v[172:173], v24 offset:11264
    v_mfma_f32_16x16x32_bf16 v[88:91], v[216:219], v[196:199], v[88:91]
    ds_read_b64_tr_b16 v[234:235], v240 offset:8704
    s_sub_u32 s61, s61, s63
    v_mfma_f32_16x16x32_bf16 v[92:95], v[220:223], v[196:199], v[92:95]
    s_waitcnt lgkmcnt(12)
    ds_read_b128 v[196:199], v245 offset:18432
    v_add_u32 v8, s61, v6
    v_mfma_f32_16x16x32_bf16 v[96:99], v[208:211], v[200:203], v[96:99]
    ds_read_b64_tr_b16 v[236:237], v241 offset:8192
    s_mul_i32 s60, s6, 224
    v_mfma_f32_16x16x32_bf16 v[100:103], v[212:215], v[200:203], v[100:103]
    ds_read_b64_tr_b16 v[238:239], v241 offset:8704
    ds_read_b64_tr_b16 v[174:175], v24 offset:11392
    v_mfma_f32_16x16x32_bf16 v[104:107], v[216:219], v[200:203], v[104:107]
    s_add_u32 s61, s97, s51
    v_mfma_f32_16x16x32_bf16 v[108:111], v[220:223], v[200:203], v[108:111]
    ds_read_b128 v[200:203], v245 offset:20480
    s_lshl2_add_u32 s60, s61, s60
    v_mfma_f32_16x16x32_bf16 v[112:115], v[208:211], v[204:207], v[112:115]
    s_lshl1_add_u32 s60, s50, s60
    v_mfma_f32_16x16x32_bf16 v[116:119], v[212:215], v[204:207], v[116:119]
    s_lshl_b32 s60, s60, 10
    v_mfma_f32_16x16x32_bf16 v[120:123], v[216:219], v[204:207], v[120:123]
    s_add_u32 s98, s60, 5242880
    v_mfma_f32_16x16x32_bf16 v[124:127], v[220:223], v[204:207], v[124:127]
    s_waitcnt lgkmcnt(1)
    ds_read_b128 v[204:207], v245 offset:22528
    s_add_u32 s99, s98, 114688
    v_mfma_f32_16x16x32_bf16 v[128:131], v[160:163], v[164:167], v[128:131]
    ds_read_b128 v[144:147], v20 offset:49152
    v_mfma_f32_16x16x32_bf16 v[128:131], v[168:171], v[172:175], v[128:131]
    ds_read_b64_tr_b16 v[148:149], v24 offset:12288
    v_mfma_f32_16x16x32_bf16 v[64:67], v[224:227], v[192:195], v[64:67]
    s_barrier
    ds_read_b64_tr_b16 v[208:209], v240 offset:16384
    ds_read_b64_tr_b16 v[150:151], v24 offset:12416
    v_mfma_f32_16x16x32_bf16 v[68:71], v[228:231], v[192:195], v[68:71]
    ds_read_b64_tr_b16 v[210:211], v240 offset:16896
    s_add_u32 s60, s79, 1
    v_mfma_f32_16x16x32_bf16 v[72:75], v[232:235], v[192:195], v[72:75]
    ds_read_b64_tr_b16 v[212:213], v241 offset:16384
    ds_read_b128 v[152:155], v21 offset:49152
    v_mfma_f32_16x16x32_bf16 v[76:79], v[236:239], v[192:195], v[76:79]
    ds_read_b128 v[192:195], v244 offset:24576
    s_lshl_b32 s60, s60, 12
    v_mfma_f32_16x16x32_bf16 v[80:83], v[224:227], v[196:199], v[80:83]
    ds_read_b64_tr_b16 v[214:215], v241 offset:16896
    s_sub_u32 s75, s98, s60
    v_mfma_f32_16x16x32_bf16 v[84:87], v[228:231], v[196:199], v[84:87]
    ds_read_b64_tr_b16 v[216:217], v240 offset:24576
    ds_read_b64_tr_b16 v[156:157], v24 offset:13312
    v_mfma_f32_16x16x32_bf16 v[88:91], v[232:235], v[196:199], v[88:91]
    ds_read_b64_tr_b16 v[218:219], v240 offset:25088
    s_sub_u32 s76, s99, s60
    v_mfma_f32_16x16x32_bf16 v[92:95], v[236:239], v[196:199], v[92:95]
    s_waitcnt lgkmcnt(12)
    ds_read_b128 v[196:199], v244 offset:26624
    v_mfma_f32_16x16x32_bf16 v[96:99], v[224:227], v[200:203], v[96:99]
    ds_read_b64_tr_b16 v[220:221], v241 offset:24576
    v_mfma_f32_16x16x32_bf16 v[100:103], v[228:231], v[200:203], v[100:103]
    ds_read_b64_tr_b16 v[222:223], v241 offset:25088
    ds_read_b64_tr_b16 v[158:159], v24 offset:13440
    v_mfma_f32_16x16x32_bf16 v[104:107], v[232:235], v[200:203], v[104:107]
    v_mfma_f32_16x16x32_bf16 v[108:111], v[236:239], v[200:203], v[108:111]
    ds_read_b128 v[200:203], v244 offset:28672
    v_mfma_f32_16x16x32_bf16 v[112:115], v[224:227], v[204:207], v[112:115]
    v_mfma_f32_16x16x32_bf16 v[116:119], v[228:231], v[204:207], v[116:119]
    v_mfma_f32_16x16x32_bf16 v[120:123], v[232:235], v[204:207], v[120:123]
    v_mfma_f32_16x16x32_bf16 v[124:127], v[236:239], v[204:207], v[124:127]
    s_waitcnt lgkmcnt(1)
    ds_read_b128 v[204:207], v244 offset:30720
    v_mfma_f32_16x16x32_bf16 v[128:131], v[144:147], v[148:151], v[128:131]
    ds_read_b128 v[160:163], v20 offset:57344
    v_mfma_f32_16x16x32_bf16 v[128:131], v[152:155], v[156:159], v[128:131]
    ds_read_b64_tr_b16 v[164:165], v24 offset:14336
    v_mfma_f32_16x16x32_bf16 v[64:67], v[208:211], v[192:195], v[64:67]
    s_barrier
    ds_read_b64_tr_b16 v[224:225], v240 offset:32768
    ds_read_b64_tr_b16 v[166:167], v24 offset:14464
    v_mfma_f32_16x16x32_bf16 v[68:71], v[212:215], v[192:195], v[68:71]
    ds_read_b64_tr_b16 v[226:227], v240 offset:33280
    v_mfma_f32_16x16x32_bf16 v[72:75], v[216:219], v[192:195], v[72:75]
    ds_read_b64_tr_b16 v[228:229], v241 offset:32768
    ds_read_b128 v[168:171], v21 offset:57344
    v_mfma_f32_16x16x32_bf16 v[76:79], v[220:223], v[192:195], v[76:79]
    ds_read_b128 v[192:195], v245 offset:24576
    v_mfma_f32_16x16x32_bf16 v[80:83], v[208:211], v[196:199], v[80:83]
    ds_read_b64_tr_b16 v[230:231], v241 offset:33280
    v_mfma_f32_16x16x32_bf16 v[84:87], v[212:215], v[196:199], v[84:87]
    ds_read_b64_tr_b16 v[232:233], v240 offset:40960
    ds_read_b64_tr_b16 v[172:173], v24 offset:15360
    v_mfma_f32_16x16x32_bf16 v[88:91], v[216:219], v[196:199], v[88:91]
    ds_read_b64_tr_b16 v[234:235], v240 offset:41472
    v_mfma_f32_16x16x32_bf16 v[92:95], v[220:223], v[196:199], v[92:95]
    s_waitcnt lgkmcnt(12)
    ds_read_b128 v[196:199], v245 offset:26624
    v_mfma_f32_16x16x32_bf16 v[96:99], v[208:211], v[200:203], v[96:99]
    ds_read_b64_tr_b16 v[236:237], v241 offset:40960
    v_mfma_f32_16x16x32_bf16 v[100:103], v[212:215], v[200:203], v[100:103]
    ds_read_b64_tr_b16 v[238:239], v241 offset:41472
    ds_read_b64_tr_b16 v[174:175], v24 offset:15488
    v_mfma_f32_16x16x32_bf16 v[104:107], v[216:219], v[200:203], v[104:107]
    v_mfma_f32_16x16x32_bf16 v[108:111], v[220:223], v[200:203], v[108:111]
    ds_read_b128 v[200:203], v245 offset:28672
    v_mfma_f32_16x16x32_bf16 v[112:115], v[208:211], v[204:207], v[112:115]
    v_mfma_f32_16x16x32_bf16 v[116:119], v[212:215], v[204:207], v[116:119]
    v_mfma_f32_16x16x32_bf16 v[120:123], v[216:219], v[204:207], v[120:123]
    v_mfma_f32_16x16x32_bf16 v[124:127], v[220:223], v[204:207], v[124:127]
    s_waitcnt lgkmcnt(1)
    ds_read_b128 v[204:207], v245 offset:30720
    v_mfma_f32_16x16x32_bf16 v[128:131], v[160:163], v[164:167], v[128:131]
    v_mfma_f32_16x16x32_bf16 v[128:131], v[168:171], v[172:175], v[128:131]
    v_mfma_f32_16x16x32_bf16 v[64:67], v[224:227], v[192:195], v[64:67]
    s_barrier
    ds_read_b64_tr_b16 v[208:209], v242 offset:0
    v_mfma_f32_16x16x32_bf16 v[68:71], v[228:231], v[192:195], v[68:71]
    ds_read_b64_tr_b16 v[210:211], v242 offset:512
    v_mfma_f32_16x16x32_bf16 v[72:75], v[232:235], v[192:195], v[72:75]
    ds_read_b64_tr_b16 v[212:213], v243 offset:0
    v_mfma_f32_16x16x32_bf16 v[76:79], v[236:239], v[192:195], v[76:79]
    ds_read_b128 v[192:195], v244 offset:32768
    v_mfma_f32_16x16x32_bf16 v[80:83], v[224:227], v[196:199], v[80:83]
    ds_read_b64_tr_b16 v[214:215], v243 offset:512
    v_mfma_f32_16x16x32_bf16 v[84:87], v[228:231], v[196:199], v[84:87]
    ds_read_b64_tr_b16 v[216:217], v242 offset:8192
    v_mfma_f32_16x16x32_bf16 v[88:91], v[232:235], v[196:199], v[88:91]
    ds_read_b64_tr_b16 v[218:219], v242 offset:8704
    v_mfma_f32_16x16x32_bf16 v[92:95], v[236:239], v[196:199], v[92:95]
    s_waitcnt lgkmcnt(7)
    ds_read_b128 v[196:199], v244 offset:34816
    v_mfma_f32_16x16x32_bf16 v[96:99], v[224:227], v[200:203], v[96:99]
    ds_read_b64_tr_b16 v[220:221], v243 offset:8192
    v_cmp_eq_u32 vcc, 0, v0
    v_mfma_f32_16x16x32_bf16 v[100:103], v[228:231], v[200:203], v[100:103]
    ds_read_b64_tr_b16 v[222:223], v243 offset:8704
    v_mov_b32 v30, 0x3f803f80
    v_mfma_f32_16x16x32_bf16 v[104:107], v[232:235], v[200:203], v[104:107]
    v_cvt_pk_bf16_f32 v132, v128, v129
    v_cvt_pk_bf16_f32 v133, v130, v131
    v_cndmask_b32 v136, 0, v30, vcc
    v_mfma_f32_16x16x32_bf16 v[108:111], v[236:239], v[200:203], v[108:111]
    ds_read_b128 v[200:203], v244 offset:36864
    v_cndmask_b32 v137, 0, v30, vcc
    v_mfma_f32_16x16x32_bf16 v[112:115], v[224:227], v[204:207], v[112:115]
    v_cndmask_b32 v138, 0, v30, vcc
    v_cndmask_b32 v139, 0, v30, vcc
    v_mfma_f32_16x16x32_bf16 v[116:119], v[228:231], v[204:207], v[116:119]
    buffer_store_dwordx2 v[132:133], v25, s[40:43], s64 offen sc1
    s_mov_b64 exec, 3
    buffer_store_dwordx4 v[136:139], v6, s[40:43], s64 offen offset:512 sc1
    s_mov_b64 exec, -1
    v_mfma_f32_16x16x32_bf16 v[120:123], v[232:235], v[204:207], v[120:123]
    v_mfma_f32_16x16x32_bf16 v[124:127], v[236:239], v[204:207], v[124:127]
    s_waitcnt lgkmcnt(1)
    ds_read_b128 v[204:207], v244 offset:38912
    v_mfma_f32_16x16x32_bf16 v[64:67], v[208:211], v[192:195], v[64:67]
    s_barrier
    ds_read_b64_tr_b16 v[224:225], v242 offset:16384
    v_mfma_f32_16x16x32_bf16 v[68:71], v[212:215], v[192:195], v[68:71]
    ds_read_b64_tr_b16 v[226:227], v242 offset:16896
    v_mfma_f32_16x16x32_bf16 v[72:75], v[216:219], v[192:195], v[72:75]
    ds_read_b64_tr_b16 v[228:229], v243 offset:16384
    v_mfma_f32_16x16x32_bf16 v[76:79], v[220:223], v[192:195], v[76:79]
    ds_read_b128 v[192:195], v245 offset:32768
    v_mfma_f32_16x16x32_bf16 v[80:83], v[208:211], v[196:199], v[80:83]
    ds_read_b64_tr_b16 v[230:231], v243 offset:16896
    v_mfma_f32_16x16x32_bf16 v[84:87], v[212:215], v[196:199], v[84:87]
    ds_read_b64_tr_b16 v[232:233], v242 offset:24576
    v_mfma_f32_16x16x32_bf16 v[88:91], v[216:219], v[196:199], v[88:91]
    ds_read_b64_tr_b16 v[234:235], v242 offset:25088
    v_mfma_f32_16x16x32_bf16 v[92:95], v[220:223], v[196:199], v[92:95]
    s_waitcnt lgkmcnt(7)
    ds_read_b128 v[196:199], v245 offset:34816
    v_mfma_f32_16x16x32_bf16 v[96:99], v[208:211], v[200:203], v[96:99]
    ds_read_b64_tr_b16 v[236:237], v243 offset:24576
    v_mfma_f32_16x16x32_bf16 v[100:103], v[212:215], v[200:203], v[100:103]
    ds_read_b64_tr_b16 v[238:239], v243 offset:25088
    v_mfma_f32_16x16x32_bf16 v[104:107], v[216:219], v[200:203], v[104:107]
    v_mfma_f32_16x16x32_bf16 v[108:111], v[220:223], v[200:203], v[108:111]
    ds_read_b128 v[200:203], v245 offset:36864
    v_mfma_f32_16x16x32_bf16 v[112:115], v[208:211], v[204:207], v[112:115]
    v_mfma_f32_16x16x32_bf16 v[116:119], v[212:215], v[204:207], v[116:119]
    v_mfma_f32_16x16x32_bf16 v[120:123], v[216:219], v[204:207], v[120:123]
    v_mfma_f32_16x16x32_bf16 v[124:127], v[220:223], v[204:207], v[124:127]
    s_waitcnt lgkmcnt(1)
    ds_read_b128 v[204:207], v245 offset:38912
    v_mfma_f32_16x16x32_bf16 v[64:67], v[224:227], v[192:195], v[64:67]
    s_barrier
    ds_read_b64_tr_b16 v[208:209], v240 offset:0
    v_mfma_f32_16x16x32_bf16 v[68:71], v[228:231], v[192:195], v[68:71]
    ds_read_b64_tr_b16 v[210:211], v240 offset:512
    v_mfma_f32_16x16x32_bf16 v[72:75], v[232:235], v[192:195], v[72:75]
    ds_read_b64_tr_b16 v[212:213], v241 offset:0
    v_mfma_f32_16x16x32_bf16 v[76:79], v[236:239], v[192:195], v[76:79]
    ds_read_b128 v[192:195], v244 offset:40960
    v_mfma_f32_16x16x32_bf16 v[80:83], v[224:227], v[196:199], v[80:83]
    ds_read_b64_tr_b16 v[214:215], v241 offset:512
    v_mfma_f32_16x16x32_bf16 v[84:87], v[228:231], v[196:199], v[84:87]
    ds_read_b64_tr_b16 v[216:217], v240 offset:8192
    v_mfma_f32_16x16x32_bf16 v[88:91], v[232:235], v[196:199], v[88:91]
    ds_read_b64_tr_b16 v[218:219], v240 offset:8704
    v_mfma_f32_16x16x32_bf16 v[92:95], v[236:239], v[196:199], v[92:95]
    s_waitcnt lgkmcnt(7)
    ds_read_b128 v[196:199], v244 offset:43008
    v_mfma_f32_16x16x32_bf16 v[96:99], v[224:227], v[200:203], v[96:99]
    ds_read_b64_tr_b16 v[220:221], v241 offset:8192
    v_mfma_f32_16x16x32_bf16 v[100:103], v[228:231], v[200:203], v[100:103]
    ds_read_b64_tr_b16 v[222:223], v241 offset:8704
    v_mfma_f32_16x16x32_bf16 v[104:107], v[232:235], v[200:203], v[104:107]
    v_mfma_f32_16x16x32_bf16 v[108:111], v[236:239], v[200:203], v[108:111]
    ds_read_b128 v[200:203], v244 offset:45056
    v_mfma_f32_16x16x32_bf16 v[112:115], v[224:227], v[204:207], v[112:115]
    v_mfma_f32_16x16x32_bf16 v[116:119], v[228:231], v[204:207], v[116:119]
    s_cmp_gt_u32 s51, s79
    s_cselect_b32 s77, 1, 0
    s_mul_i32 s55, s48, 458752
    s_and_b32 s61, s18, 3
    s_lshl1_add_u32 s60, s61, s7
    s_cmp_ge_u32 s60, 7
    s_cselect_b32 s61, 7, 0
    s_sub_u32 s60, s60, s61
    s_lshl_b32 s53, s60, 12
    s_lshl2_add_u32 s60, s6, s5
    s_lshl_b32 s60, s60, 7
    s_lshl4_add_u32 s60, s79, s60
    s_lshl2_add_u32 s60, s48, s60
    s_add_u32 s67, s60, 4718592
    s_lshl2_add_u32 s60, s18, s48
    s_lshl_b32 s60, s60, 7
    s_add_u32 s66, s60, 4718592
    v_and_b32 v11, 7, v0
    v_lshlrev_b32 v11, 2, v11
    v_bfe_u32 v22, v0, 3, 1
    v_lshl_add_u32 v11, v22, 14, v11
    s_lshl1_add_u32 s60, s18, s50
    s_lshr_b32 s61, s7, 2
    s_lshl1_add_u32 s60, s60, s61
    s_lshl_b32 s60, s60, 7
    s_lshl3_add_u32 s60, s54, s60
    s_lshl2_add_u32 s60, s51, s60
    s_add_u32 s72, s60, 4734976
    v_add_u32 v9, s49, v6
    v_mov_b32 v1, 1
    s_waitcnt vmcnt(2)
    v_readfirstlane_b32 s4, v15
    s_nop 3
    s_cmp_eq_u32 s4, 0
    s_cbranch_scc1 L_nspin_36
L_ngot_37:
    v_mfma_f32_16x16x32_bf16 v[120:123], v[232:235], v[204:207], v[120:123]
    v_mfma_f32_16x16x32_bf16 v[124:127], v[236:239], v[204:207], v[124:127]
    s_waitcnt lgkmcnt(1)
    ds_read_b128 v[204:207], v244 offset:47104
    s_branch L_kvjoin
.p2align 12
L_p1q:
L_pad_p1q:
    s_cbranch_execz L_ret_p1q
    v_mfma_f32_16x16x32_bf16 v[128:131], v[208:211], v[192:195], 0
    s_barrier
    ds_read_b64_tr_b16 v[224:225], v240 offset:32768
    v_mfma_f32_16x16x32_bf16 v[132:135], v[212:215], v[192:195], 0
    ds_read_b64_tr_b16 v[226:227], v240 offset:33280
    v_mfma_f32_16x16x32_bf16 v[136:139], v[216:219], v[192:195], 0
    ds_read_b64_tr_b16 v[228:229], v241 offset:32768
    v_cvt_pk_bf16_f32 v64, v64, v65
    v_mfma_f32_16x16x32_bf16 v[140:143], v[220:223], v[192:195], 0
    ds_read_b128 v[192:195], v245 offset:0
    v_cvt_pk_bf16_f32 v65, v66, v67
    v_mfma_f32_16x16x32_bf16 v[144:147], v[208:211], v[196:199], 0
    ds_read_b64_tr_b16 v[230:231], v241 offset:33280
    v_cvt_pk_bf16_f32 v66, v68, v69
    v_mfma_f32_16x16x32_bf16 v[148:151], v[212:215], v[196:199], 0
    ds_read_b64_tr_b16 v[232:233], v240 offset:40960
    v_cvt_pk_bf16_f32 v67, v70, v71
    v_mfma_f32_16x16x32_bf16 v[152:155], v[216:219], v[196:199], 0
    ds_read_b64_tr_b16 v[234:235], v240 offset:41472
    v_cvt_pk_bf16_f32 v68, v72, v73
    v_mfma_f32_16x16x32_bf16 v[156:159], v[220:223], v[196:199], 0
    s_waitcnt lgkmcnt(7)
    ds_read_b128 v[196:199], v245 offset:2048
    v_cvt_pk_bf16_f32 v69, v74, v75
    v_mfma_f32_16x16x32_bf16 v[160:163], v[208:211], v[200:203], 0
    ds_read_b64_tr_b16 v[236:237], v241 offset:40960
    v_cvt_pk_bf16_f32 v70, v76, v77
    v_mfma_f32_16x16x32_bf16 v[164:167], v[212:215], v[200:203], 0
    ds_read_b64_tr_b16 v[238:239], v241 offset:41472
    v_cvt_pk_bf16_f32 v71, v78, v79
    v_mfma_f32_16x16x32_bf16 v[168:171], v[216:219], v[200:203], 0
    buffer_store_dwordx4 v[64:67], v10, s[40:43], s20 offen offset:0 sc1
    buffer_store_dwordx4 v[68:71], v10, s[40:43], s22 offen offset:0 sc1
    v_cvt_pk_bf16_f32 v80, v80, v81
    v_mfma_f32_16x16x32_bf16 v[172:175], v[220:223], v[200:203], 0
    ds_read_b128 v[200:203], v245 offset:4096
    v_cvt_pk_bf16_f32 v81, v82, v83
    v_mfma_f32_16x16x32_bf16 v[176:179], v[208:211], v[204:207], 0
    v_cvt_pk_bf16_f32 v82, v84, v85
    v_cvt_pk_bf16_f32 v83, v86, v87
    v_cvt_pk_bf16_f32 v84, v88, v89
    v_mfma_f32_16x16x32_bf16 v[180:183], v[212:215], v[204:207], 0
    v_cvt_pk_bf16_f32 v85, v90, v91
    v_cvt_pk_bf16_f32 v86, v92, v93
    v_cvt_pk_bf16_f32 v87, v94, v95
    v_mfma_f32_16x16x32_bf16 v[184:187], v[216:219], v[204:207], 0
    buffer_store_dwordx4 v[80:83], v10, s[40:43], s20 offen offset:256 sc1
    buffer_store_dwordx4 v[84:87], v10, s[40:43], s22 offen offset:256 sc1
    v_cvt_pk_bf16_f32 v96, v96, v97
    v_mfma_f32_16x16x32_bf16 v[188:191], v[220:223], v[204:207], 0
    s_waitcnt lgkmcnt(1)
    ds_read_b128 v[204:207], v245 offset:6144
    v_cvt_pk_bf16_f32 v97, v98, v99
    v_mfma_f32_16x16x32_bf16 v[128:131], v[224:227], v[192:195], v[128:131]
    s_barrier
    ds_read_b64_tr_b16 v[208:209], v242 offset:0
    v_cvt_pk_bf16_f32 v98, v100, v101
    v_mfma_f32_16x16x32_bf16 v[132:135], v[228:231], v[192:195], v[132:135]
    ds_read_b64_tr_b16 v[210:211], v242 offset:512
    v_cvt_pk_bf16_f32 v99, v102, v103
    v_mfma_f32_16x16x32_bf16 v[136:139], v[232:235], v[192:195], v[136:139]
    ds_read_b64_tr_b16 v[212:213], v243 offset:0
    v_cvt_pk_bf16_f32 v100, v104, v105
    v_mfma_f32_16x16x32_bf16 v[140:143], v[236:239], v[192:195], v[140:143]
    ds_read_b128 v[192:195], v244 offset:8192
    v_cvt_pk_bf16_f32 v101, v106, v107
    v_mfma_f32_16x16x32_bf16 v[144:147], v[224:227], v[196:199], v[144:147]
    ds_read_b64_tr_b16 v[214:215], v243 offset:512
    v_cvt_pk_bf16_f32 v102, v108, v109
    v_mfma_f32_16x16x32_bf16 v[148:151], v[228:231], v[196:199], v[148:151]
    ds_read_b64_tr_b16 v[216:217], v242 offset:8192
    v_cvt_pk_bf16_f32 v103, v110, v111
    v_mfma_f32_16x16x32_bf16 v[152:155], v[232:235], v[196:199], v[152:155]
    ds_read_b64_tr_b16 v[218:219], v242 offset:8704
    buffer_store_dwordx4 v[96:99], v10, s[40:43], s21 offen offset:0 sc1
    v_mfma_f32_16x16x32_bf16 v[156:159], v[236:239], v[196:199], v[156:159]
    s_waitcnt lgkmcnt(7)
    ds_read_b128 v[196:199], v244 offset:10240
    buffer_store_dwordx4 v[100:103], v10, s[40:43], s23 offen offset:0 sc1
    v_mfma_f32_16x16x32_bf16 v[160:163], v[224:227], v[200:203], v[160:163]
    ds_read_b64_tr_b16 v[220:221], v243 offset:8192
    v_cvt_pk_bf16_f32 v112, v112, v113
    v_mfma_f32_16x16x32_bf16 v[164:167], v[228:231], v[200:203], v[164:167]
    ds_read_b64_tr_b16 v[222:223], v243 offset:8704
    v_cvt_pk_bf16_f32 v113, v114, v115
    v_mfma_f32_16x16x32_bf16 v[168:171], v[232:235], v[200:203], v[168:171]
    v_cvt_pk_bf16_f32 v114, v116, v117
    v_cvt_pk_bf16_f32 v115, v118, v119
    v_cvt_pk_bf16_f32 v116, v120, v121
    v_mfma_f32_16x16x32_bf16 v[172:175], v[236:239], v[200:203], v[172:175]
    ds_read_b128 v[200:203], v244 offset:12288
    v_cvt_pk_bf16_f32 v117, v122, v123
    v_mfma_f32_16x16x32_bf16 v[176:179], v[224:227], v[204:207], v[176:179]
    v_cvt_pk_bf16_f32 v118, v124, v125
    v_cvt_pk_bf16_f32 v119, v126, v127
    buffer_store_dwordx4 v[112:115], v10, s[40:43], s21 offen offset:256 sc1
    v_mfma_f32_16x16x32_bf16 v[180:183], v[228:231], v[204:207], v[180:183]
    buffer_store_dwordx4 v[116:119], v10, s[40:43], s23 offen offset:256 sc1
    v_mfma_f32_16x16x32_bf16 v[184:187], v[232:235], v[204:207], v[184:187]
    v_mfma_f32_16x16x32_bf16 v[188:191], v[236:239], v[204:207], v[188:191]
    s_waitcnt lgkmcnt(1)
    ds_read_b128 v[204:207], v244 offset:14336
    v_mfma_f32_16x16x32_bf16 v[128:131], v[208:211], v[192:195], v[128:131]
    s_barrier
    ds_read_b64_tr_b16 v[224:225], v242 offset:16384
    v_mfma_f32_16x16x32_bf16 v[132:135], v[212:215], v[192:195], v[132:135]
    ds_read_b64_tr_b16 v[226:227], v242 offset:16896
    v_mfma_f32_16x16x32_bf16 v[136:139], v[216:219], v[192:195], v[136:139]
    ds_read_b64_tr_b16 v[228:229], v243 offset:16384
    v_mfma_f32_16x16x32_bf16 v[140:143], v[220:223], v[192:195], v[140:143]
    ds_read_b128 v[192:195], v245 offset:8192
    v_mfma_f32_16x16x32_bf16 v[144:147], v[208:211], v[196:199], v[144:147]
    ds_read_b64_tr_b16 v[230:231], v243 offset:16896
    v_mfma_f32_16x16x32_bf16 v[148:151], v[212:215], v[196:199], v[148:151]
    ds_read_b64_tr_b16 v[232:233], v242 offset:24576
    v_mfma_f32_16x16x32_bf16 v[152:155], v[216:219], v[196:199], v[152:155]
    ds_read_b64_tr_b16 v[234:235], v242 offset:25088
    v_mfma_f32_16x16x32_bf16 v[156:159], v[220:223], v[196:199], v[156:159]
    s_waitcnt lgkmcnt(7)
    ds_read_b128 v[196:199], v245 offset:10240
    v_mfma_f32_16x16x32_bf16 v[160:163], v[208:211], v[200:203], v[160:163]
    ds_read_b64_tr_b16 v[236:237], v243 offset:24576
    v_mfma_f32_16x16x32_bf16 v[164:167], v[212:215], v[200:203], v[164:167]
    ds_read_b64_tr_b16 v[238:239], v243 offset:25088
    v_mfma_f32_16x16x32_bf16 v[168:171], v[216:219], v[200:203], v[168:171]
    v_mfma_f32_16x16x32_bf16 v[172:175], v[220:223], v[200:203], v[172:175]
    ds_read_b128 v[200:203], v245 offset:12288
    v_mfma_f32_16x16x32_bf16 v[176:179], v[208:211], v[204:207], v[176:179]
    v_mfma_f32_16x16x32_bf16 v[180:183], v[212:215], v[204:207], v[180:183]
    v_mfma_f32_16x16x32_bf16 v[184:187], v[216:219], v[204:207], v[184:187]
    v_mfma_f32_16x16x32_bf16 v[188:191], v[220:223], v[204:207], v[188:191]
    s_waitcnt lgkmcnt(1)
    ds_read_b128 v[204:207], v245 offset:14336
    v_mfma_f32_16x16x32_bf16 v[128:131], v[224:227], v[192:195], v[128:131]
    s_barrier
    ds_read_b64_tr_b16 v[208:209], v240 offset:0
    v_mfma_f32_16x16x32_bf16 v[132:135], v[228:231], v[192:195], v[132:135]
    ds_read_b64_tr_b16 v[210:211], v240 offset:512
    v_mfma_f32_16x16x32_bf16 v[136:139], v[232:235], v[192:195], v[136:139]
    ds_read_b64_tr_b16 v[212:213], v241 offset:0
    v_mfma_f32_16x16x32_bf16 v[140:143], v[236:239], v[192:195], v[140:143]
    ds_read_b128 v[192:195], v244 offset:16384
    v_mfma_f32_16x16x32_bf16 v[144:147], v[224:227], v[196:199], v[144:147]
    ds_read_b64_tr_b16 v[214:215], v241 offset:512
    v_mfma_f32_16x16x32_bf16 v[148:151], v[228:231], v[196:199], v[148:151]
    ds_read_b64_tr_b16 v[216:217], v240 offset:8192
    v_mfma_f32_16x16x32_bf16 v[152:155], v[232:235], v[196:199], v[152:155]
    ds_read_b64_tr_b16 v[218:219], v240 offset:8704
    v_mfma_f32_16x16x32_bf16 v[156:159], v[236:239], v[196:199], v[156:159]
    s_waitcnt lgkmcnt(7)
    ds_read_b128 v[196:199], v244 offset:18432
    v_mfma_f32_16x16x32_bf16 v[160:163], v[224:227], v[200:203], v[160:163]
    ds_read_b64_tr_b16 v[220:221], v241 offset:8192
    v_mfma_f32_16x16x32_bf16 v[164:167], v[228:231], v[200:203], v[164:167]
    ds_read_b64_tr_b16 v[222:223], v241 offset:8704
    v_mfma_f32_16x16x32_bf16 v[168:171], v[232:235], v[200:203], v[168:171]
    v_mfma_f32_16x16x32_bf16 v[172:175], v[236:239], v[200:203], v[172:175]
    ds_read_b128 v[200:203], v244 offset:20480
    v_mfma_f32_16x16x32_bf16 v[176:179], v[224:227], v[204:207], v[176:179]
    v_mfma_f32_16x16x32_bf16 v[180:183], v[228:231], v[204:207], v[180:183]
    v_mfma_f32_16x16x32_bf16 v[184:187], v[232:235], v[204:207], v[184:187]
    v_mfma_f32_16x16x32_bf16 v[188:191], v[236:239], v[204:207], v[188:191]
    s_waitcnt lgkmcnt(1)
    ds_read_b128 v[204:207], v244 offset:22528
    v_mfma_f32_16x16x32_bf16 v[128:131], v[208:211], v[192:195], v[128:131]
    s_barrier
    ds_read_b64_tr_b16 v[224:225], v240 offset:16384
    v_mfma_f32_16x16x32_bf16 v[132:135], v[212:215], v[192:195], v[132:135]
    ds_read_b64_tr_b16 v[226:227], v240 offset:16896
    v_mfma_f32_16x16x32_bf16 v[136:139], v[216:219], v[192:195], v[136:139]
    ds_read_b64_tr_b16 v[228:229], v241 offset:16384
    v_mfma_f32_16x16x32_bf16 v[140:143], v[220:223], v[192:195], v[140:143]
    ds_read_b128 v[192:195], v245 offset:16384
    v_mfma_f32_16x16x32_bf16 v[144:147], v[208:211], v[196:199], v[144:147]
    ds_read_b64_tr_b16 v[230:231], v241 offset:16896
    v_mfma_f32_16x16x32_bf16 v[148:151], v[212:215], v[196:199], v[148:151]
    ds_read_b64_tr_b16 v[232:233], v240 offset:24576
    v_mfma_f32_16x16x32_bf16 v[152:155], v[216:219], v[196:199], v[152:155]
    ds_read_b64_tr_b16 v[234:235], v240 offset:25088
    v_mfma_f32_16x16x32_bf16 v[156:159], v[220:223], v[196:199], v[156:159]
    s_waitcnt lgkmcnt(7)
    ds_read_b128 v[196:199], v245 offset:18432
    v_mfma_f32_16x16x32_bf16 v[160:163], v[208:211], v[200:203], v[160:163]
    ds_read_b64_tr_b16 v[236:237], v241 offset:24576
    v_mfma_f32_16x16x32_bf16 v[164:167], v[212:215], v[200:203], v[164:167]
    ds_read_b64_tr_b16 v[238:239], v241 offset:25088
    v_mfma_f32_16x16x32_bf16 v[168:171], v[216:219], v[200:203], v[168:171]
    v_mfma_f32_16x16x32_bf16 v[172:175], v[220:223], v[200:203], v[172:175]
    ds_read_b128 v[200:203], v245 offset:20480
    v_mfma_f32_16x16x32_bf16 v[176:179], v[208:211], v[204:207], v[176:179]
    v_mfma_f32_16x16x32_bf16 v[180:183], v[212:215], v[204:207], v[180:183]
    v_mfma_f32_16x16x32_bf16 v[184:187], v[216:219], v[204:207], v[184:187]
    v_mfma_f32_16x16x32_bf16 v[188:191], v[220:223], v[204:207], v[188:191]
    s_waitcnt lgkmcnt(1)
    ds_read_b128 v[204:207], v245 offset:22528
    s_mov_b64 exec, 1
    s_waitcnt vmcnt(0)
    buffer_store_dword v12, v13, s[40:43], s19 offen sc1
    s_mov_b64 exec, -1
    v_mfma_f32_16x16x32_bf16 v[128:131], v[224:227], v[192:195], v[128:131]
    s_barrier
    ds_read_b64_tr_b16 v[208:209], v240 offset:32768
    v_mfma_f32_16x16x32_bf16 v[132:135], v[228:231], v[192:195], v[132:135]
    ds_read_b64_tr_b16 v[210:211], v240 offset:33280
    v_mfma_f32_16x16x32_bf16 v[136:139], v[232:235], v[192:195], v[136:139]
    ds_read_b64_tr_b16 v[212:213], v241 offset:32768
    v_mfma_f32_16x16x32_bf16 v[140:143], v[236:239], v[192:195], v[140:143]
    ds_read_b128 v[192:195], v244 offset:24576
    v_mfma_f32_16x16x32_bf16 v[144:147], v[224:227], v[196:199], v[144:147]
    ds_read_b64_tr_b16 v[214:215], v241 offset:33280
    v_mfma_f32_16x16x32_bf16 v[148:151], v[228:231], v[196:199], v[148:151]
    ds_read_b64_tr_b16 v[216:217], v240 offset:40960
    v_mfma_f32_16x16x32_bf16 v[152:155], v[232:235], v[196:199], v[152:155]
    ds_read_b64_tr_b16 v[218:219], v240 offset:41472
    v_mfma_f32_16x16x32_bf16 v[156:159], v[236:239], v[196:199], v[156:159]
    s_waitcnt lgkmcnt(7)
    ds_read_b128 v[196:199], v244 offset:26624
    v_mfma_f32_16x16x32_bf16 v[160:163], v[224:227], v[200:203], v[160:163]
    ds_read_b64_tr_b16 v[220:221], v241 offset:40960
    v_mfma_f32_16x16x32_bf16 v[164:167], v[228:231], v[200:203], v[164:167]
    ds_read_b64_tr_b16 v[222:223], v241 offset:41472
    v_mfma_f32_16x16x32_bf16 v[168:171], v[232:235], v[200:203], v[168:171]
    v_mfma_f32_16x16x32_bf16 v[172:175], v[236:239], v[200:203], v[172:175]
    ds_read_b128 v[200:203], v244 offset:28672
    v_mfma_f32_16x16x32_bf16 v[176:179], v[224:227], v[204:207], v[176:179]
    v_mfma_f32_16x16x32_bf16 v[180:183], v[228:231], v[204:207], v[180:183]
    v_mfma_f32_16x16x32_bf16 v[184:187], v[232:235], v[204:207], v[184:187]
    v_mfma_f32_16x16x32_bf16 v[188:191], v[236:239], v[204:207], v[188:191]
    s_waitcnt lgkmcnt(1)
    ds_read_b128 v[204:207], v244 offset:30720
    v_mfma_f32_16x16x32_bf16 v[128:131], v[208:211], v[192:195], v[128:131]
    s_barrier
    ds_read_b64_tr_b16 v[224:225], v242 offset:0
    v_mfma_f32_16x16x32_bf16 v[132:135], v[212:215], v[192:195], v[132:135]
    ds_read_b64_tr_b16 v[226:227], v242 offset:512
    v_mfma_f32_16x16x32_bf16 v[136:139], v[216:219], v[192:195], v[136:139]
    ds_read_b64_tr_b16 v[228:229], v243 offset:0
    v_mfma_f32_16x16x32_bf16 v[140:143], v[220:223], v[192:195], v[140:143]
    ds_read_b128 v[192:195], v245 offset:24576
    v_mfma_f32_16x16x32_bf16 v[144:147], v[208:211], v[196:199], v[144:147]
    ds_read_b64_tr_b16 v[230:231], v243 offset:512
    v_mfma_f32_16x16x32_bf16 v[148:151], v[212:215], v[196:199], v[148:151]
    ds_read_b64_tr_b16 v[232:233], v242 offset:8192
    v_mfma_f32_16x16x32_bf16 v[152:155], v[216:219], v[196:199], v[152:155]
    ds_read_b64_tr_b16 v[234:235], v242 offset:8704
    v_mfma_f32_16x16x32_bf16 v[156:159], v[220:223], v[196:199], v[156:159]
    s_waitcnt lgkmcnt(7)
    ds_read_b128 v[196:199], v245 offset:26624
    v_mfma_f32_16x16x32_bf16 v[160:163], v[208:211], v[200:203], v[160:163]
    ds_read_b64_tr_b16 v[236:237], v243 offset:8192
    v_mfma_f32_16x16x32_bf16 v[164:167], v[212:215], v[200:203], v[164:167]
    ds_read_b64_tr_b16 v[238:239], v243 offset:8704
    v_mfma_f32_16x16x32_bf16 v[168:171], v[216:219], v[200:203], v[168:171]
    v_mfma_f32_16x16x32_bf16 v[172:175], v[220:223], v[200:203], v[172:175]
    ds_read_b128 v[200:203], v245 offset:28672
    v_mfma_f32_16x16x32_bf16 v[176:179], v[208:211], v[204:207], v[176:179]
    v_mfma_f32_16x16x32_bf16 v[180:183], v[212:215], v[204:207], v[180:183]
    v_mfma_f32_16x16x32_bf16 v[184:187], v[216:219], v[204:207], v[184:187]
    v_mfma_f32_16x16x32_bf16 v[188:191], v[220:223], v[204:207], v[188:191]
    s_waitcnt lgkmcnt(1)
    ds_read_b128 v[204:207], v245 offset:30720
    v_mfma_f32_16x16x32_bf16 v[128:131], v[224:227], v[192:195], v[128:131]
    s_barrier
    ds_read_b64_tr_b16 v[208:209], v242 offset:16384
    v_mfma_f32_16x16x32_bf16 v[132:135], v[228:231], v[192:195], v[132:135]
    ds_read_b64_tr_b16 v[210:211], v242 offset:16896
    v_mfma_f32_16x16x32_bf16 v[136:139], v[232:235], v[192:195], v[136:139]
    ds_read_b64_tr_b16 v[212:213], v243 offset:16384
    v_mfma_f32_16x16x32_bf16 v[140:143], v[236:239], v[192:195], v[140:143]
    ds_read_b128 v[192:195], v244 offset:32768
    v_mfma_f32_16x16x32_bf16 v[144:147], v[224:227], v[196:199], v[144:147]
    ds_read_b64_tr_b16 v[214:215], v243 offset:16896
    v_mfma_f32_16x16x32_bf16 v[148:151], v[228:231], v[196:199], v[148:151]
    ds_read_b64_tr_b16 v[216:217], v242 offset:24576
    v_mfma_f32_16x16x32_bf16 v[152:155], v[232:235], v[196:199], v[152:155]
    ds_read_b64_tr_b16 v[218:219], v242 offset:25088
    v_mfma_f32_16x16x32_bf16 v[156:159], v[236:239], v[196:199], v[156:159]
    s_waitcnt lgkmcnt(7)
    ds_read_b128 v[196:199], v244 offset:34816
    v_mfma_f32_16x16x32_bf16 v[160:163], v[224:227], v[200:203], v[160:163]
    ds_read_b64_tr_b16 v[220:221], v243 offset:24576
    v_mfma_f32_16x16x32_bf16 v[164:167], v[228:231], v[200:203], v[164:167]
    ds_read_b64_tr_b16 v[222:223], v243 offset:25088
    v_mfma_f32_16x16x32_bf16 v[168:171], v[232:235], v[200:203], v[168:171]
    v_mfma_f32_16x16x32_bf16 v[172:175], v[236:239], v[200:203], v[172:175]
    ds_read_b128 v[200:203], v244 offset:36864
    v_mfma_f32_16x16x32_bf16 v[176:179], v[224:227], v[204:207], v[176:179]
    v_mfma_f32_16x16x32_bf16 v[180:183], v[228:231], v[204:207], v[180:183]
    v_mfma_f32_16x16x32_bf16 v[184:187], v[232:235], v[204:207], v[184:187]
    v_mfma_f32_16x16x32_bf16 v[188:191], v[236:239], v[204:207], v[188:191]
    s_waitcnt lgkmcnt(1)
    ds_read_b128 v[204:207], v244 offset:38912
    v_mfma_f32_16x16x32_bf16 v[128:131], v[208:211], v[192:195], v[128:131]
    s_barrier
    ds_read_b64_tr_b16 v[224:225], v240 offset:0
    v_mfma_f32_16x16x32_bf16 v[132:135], v[212:215], v[192:195], v[132:135]
    ds_read_b64_tr_b16 v[226:227], v240 offset:512
    v_mfma_f32_16x16x32_bf16 v[136:139], v[216:219], v[192:195], v[136:139]
    ds_read_b64_tr_b16 v[228:229], v241 offset:0
    v_mfma_f32_16x16x32_bf16 v[140:143], v[220:223], v[192:195], v[140:143]
    ds_read_b128 v[192:195], v245 offset:32768
    v_mfma_f32_16x16x32_bf16 v[144:147], v[208:211], v[196:199], v[144:147]
    ds_read_b64_tr_b16 v[230:231], v241 offset:512
    v_mfma_f32_16x16x32_bf16 v[148:151], v[212:215], v[196:199], v[148:151]
    ds_read_b64_tr_b16 v[232:233], v240 offset:8192
    v_mfma_f32_16x16x32_bf16 v[152:155], v[216:219], v[196:199], v[152:155]
    ds_read_b64_tr_b16 v[234:235], v240 offset:8704
    v_mfma_f32_16x16x32_bf16 v[156:159], v[220:223], v[196:199], v[156:159]
    s_waitcnt lgkmcnt(7)
    ds_read_b128 v[196:199], v245 offset:34816
    v_mfma_f32_16x16x32_bf16 v[160:163], v[208:211], v[200:203], v[160:163]
    ds_read_b64_tr_b16 v[236:237], v241 offset:8192
    v_mfma_f32_16x16x32_bf16 v[164:167], v[212:215], v[200:203], v[164:167]
    ds_read_b64_tr_b16 v[238:239], v241 offset:8704
    v_mfma_f32_16x16x32_bf16 v[168:171], v[216:219], v[200:203], v[168:171]
    v_mfma_f32_16x16x32_bf16 v[172:175], v[220:223], v[200:203], v[172:175]
    ds_read_b128 v[200:203], v245 offset:36864
    v_mfma_f32_16x16x32_bf16 v[176:179], v[208:211], v[204:207], v[176:179]
    v_mfma_f32_16x16x32_bf16 v[180:183], v[212:215], v[204:207], v[180:183]
    v_mfma_f32_16x16x32_bf16 v[184:187], v[216:219], v[204:207], v[184:187]
    v_mfma_f32_16x16x32_bf16 v[188:191], v[220:223], v[204:207], v[188:191]
    s_waitcnt lgkmcnt(1)
    ds_read_b128 v[204:207], v245 offset:38912
    v_mfma_f32_16x16x32_bf16 v[128:131], v[224:227], v[192:195], v[128:131]
    s_barrier
    ds_read_b64_tr_b16 v[208:209], v240 offset:16384
    v_mfma_f32_16x16x32_bf16 v[132:135], v[228:231], v[192:195], v[132:135]
    ds_read_b64_tr_b16 v[210:211], v240 offset:16896
    v_mfma_f32_16x16x32_bf16 v[136:139], v[232:235], v[192:195], v[136:139]
    ds_read_b64_tr_b16 v[212:213], v241 offset:16384
    v_mfma_f32_16x16x32_bf16 v[140:143], v[236:239], v[192:195], v[140:143]
    ds_read_b128 v[192:195], v244 offset:40960
    v_mfma_f32_16x16x32_bf16 v[144:147], v[224:227], v[196:199], v[144:147]
    ds_read_b64_tr_b16 v[214:215], v241 offset:16896
    v_mfma_f32_16x16x32_bf16 v[148:151], v[228:231], v[196:199], v[148:151]
    ds_read_b64_tr_b16 v[216:217], v240 offset:24576
    v_mfma_f32_16x16x32_bf16 v[152:155], v[232:235], v[196:199], v[152:155]
    ds_read_b64_tr_b16 v[218:219], v240 offset:25088
    v_mfma_f32_16x16x32_bf16 v[156:159], v[236:239], v[196:199], v[156:159]
    s_waitcnt lgkmcnt(7)
    ds_read_b128 v[196:199], v244 offset:43008
    v_mfma_f32_16x16x32_bf16 v[160:163], v[224:227], v[200:203], v[160:163]
    ds_read_b64_tr_b16 v[220:221], v241 offset:24576
    v_mfma_f32_16x16x32_bf16 v[164:167], v[228:231], v[200:203], v[164:167]
    ds_read_b64_tr_b16 v[222:223], v241 offset:25088
    v_mfma_f32_16x16x32_bf16 v[168:171], v[232:235], v[200:203], v[168:171]
    v_mfma_f32_16x16x32_bf16 v[172:175], v[236:239], v[200:203], v[172:175]
    ds_read_b128 v[200:203], v244 offset:45056
    v_mfma_f32_16x16x32_bf16 v[176:179], v[224:227], v[204:207], v[176:179]
    v_mfma_f32_16x16x32_bf16 v[180:183], v[228:231], v[204:207], v[180:183]
    v_mfma_f32_16x16x32_bf16 v[184:187], v[232:235], v[204:207], v[184:187]
    v_mfma_f32_16x16x32_bf16 v[188:191], v[236:239], v[204:207], v[188:191]
    s_waitcnt lgkmcnt(1)
    ds_read_b128 v[204:207], v244 offset:47104
    v_mfma_f32_16x16x32_bf16 v[128:131], v[208:211], v[192:195], v[128:131]
    s_barrier
    ds_read_b64_tr_b16 v[224:225], v240 offset:32768
    v_mfma_f32_16x16x32_bf16 v[132:135], v[212:215], v[192:195], v[132:135]
    ds_read_b64_tr_b16 v[226:227], v240 offset:33280
    v_mfma_f32_16x16x32_bf16 v[136:139], v[216:219], v[192:195], v[136:139]
    ds_read_b64_tr_b16 v[228:229], v241 offset:32768
    v_mfma_f32_16x16x32_bf16 v[140:143], v[220:223], v[192:195], v[140:143]
    ds_read_b128 v[192:195], v245 offset:40960
    v_mfma_f32_16x16x32_bf16 v[144:147], v[208:211], v[196:199], v[144:147]
    ds_read_b64_tr_b16 v[230:231], v241 offset:33280
    v_mfma_f32_16x16x32_bf16 v[148:151], v[212:215], v[196:199], v[148:151]
    ds_read_b64_tr_b16 v[232:233], v240 offset:40960
    v_mfma_f32_16x16x32_bf16 v[152:155], v[216:219], v[196:199], v[152:155]
    ds_read_b64_tr_b16 v[234:235], v240 offset:41472
    v_mfma_f32_16x16x32_bf16 v[156:159], v[220:223], v[196:199], v[156:159]
    s_waitcnt lgkmcnt(7)
    ds_read_b128 v[196:199], v245 offset:43008
    v_mfma_f32_16x16x32_bf16 v[160:163], v[208:211], v[200:203], v[160:163]
    ds_read_b64_tr_b16 v[236:237], v241 offset:40960
    v_mfma_f32_16x16x32_bf16 v[164:167], v[212:215], v[200:203], v[164:167]
    ds_read_b64_tr_b16 v[238:239], v241 offset:41472
    v_mfma_f32_16x16x32_bf16 v[168:171], v[216:219], v[200:203], v[168:171]
    v_mfma_f32_16x16x32_bf16 v[172:175], v[220:223], v[200:203], v[172:175]
    ds_read_b128 v[200:203], v245 offset:45056
    v_mfma_f32_16x16x32_bf16 v[176:179], v[208:211], v[204:207], v[176:179]
    v_mfma_f32_16x16x32_bf16 v[180:183], v[212:215], v[204:207], v[180:183]
    v_mfma_f32_16x16x32_bf16 v[184:187], v[216:219], v[204:207], v[184:187]
    v_mfma_f32_16x16x32_bf16 v[188:191], v[220:223], v[204:207], v[188:191]
    s_waitcnt lgkmcnt(1)
    ds_read_b128 v[204:207], v245 offset:47104
    v_mfma_f32_16x16x32_bf16 v[128:131], v[224:227], v[192:195], v[128:131]
    s_barrier
    ds_read_b64_tr_b16 v[208:209], v242 offset:0
    v_mfma_f32_16x16x32_bf16 v[132:135], v[228:231], v[192:195], v[132:135]
    ds_read_b64_tr_b16 v[210:211], v242 offset:512
    v_mfma_f32_16x16x32_bf16 v[136:139], v[232:235], v[192:195], v[136:139]
    ds_read_b64_tr_b16 v[212:213], v243 offset:0
    v_mfma_f32_16x16x32_bf16 v[140:143], v[236:239], v[192:195], v[140:143]
    ds_read_b128 v[192:195], v244 offset:49152
    v_mfma_f32_16x16x32_bf16 v[144:147], v[224:227], v[196:199], v[144:147]
    ds_read_b64_tr_b16 v[214:215], v243 offset:512
    v_mfma_f32_16x16x32_bf16 v[148:151], v[228:231], v[196:199], v[148:151]
    ds_read_b64_tr_b16 v[216:217], v242 offset:8192
    v_mfma_f32_16x16x32_bf16 v[152:155], v[232:235], v[196:199], v[152:155]
    ds_read_b64_tr_b16 v[218:219], v242 offset:8704
    v_mfma_f32_16x16x32_bf16 v[156:159], v[236:239], v[196:199], v[156:159]
    s_waitcnt lgkmcnt(7)
    ds_read_b128 v[196:199], v244 offset:51200
    v_mfma_f32_16x16x32_bf16 v[160:163], v[224:227], v[200:203], v[160:163]
    ds_read_b64_tr_b16 v[220:221], v243 offset:8192
    v_mfma_f32_16x16x32_bf16 v[164:167], v[228:231], v[200:203], v[164:167]
    ds_read_b64_tr_b16 v[222:223], v243 offset:8704
    v_mfma_f32_16x16x32_bf16 v[168:171], v[232:235], v[200:203], v[168:171]
    v_mfma_f32_16x16x32_bf16 v[172:175], v[236:239], v[200:203], v[172:175]
    ds_read_b128 v[200:203], v244 offset:53248
    v_mfma_f32_16x16x32_bf16 v[176:179], v[224:227], v[204:207], v[176:179]
    v_mfma_f32_16x16x32_bf16 v[180:183], v[228:231], v[204:207], v[180:183]
    v_mfma_f32_16x16x32_bf16 v[184:187], v[232:235], v[204:207], v[184:187]
    v_mfma_f32_16x16x32_bf16 v[188:191], v[236:239], v[204:207], v[188:191]
    s_waitcnt lgkmcnt(1)
    ds_read_b128 v[204:207], v244 offset:55296
    v_mfma_f32_16x16x32_bf16 v[128:131], v[208:211], v[192:195], v[128:131]
    s_barrier
    ds_read_b64_tr_b16 v[224:225], v242 offset:16384
    v_mfma_f32_16x16x32_bf16 v[132:135], v[212:215], v[192:195], v[132:135]
    ds_read_b64_tr_b16 v[226:227], v242 offset:16896
    v_mfma_f32_16x16x32_bf16 v[136:139], v[216:219], v[192:195], v[136:139]
    ds_read_b64_tr_b16 v[228:229], v243 offset:16384
    v_mfma_f32_16x16x32_bf16 v[140:143], v[220:223], v[192:195], v[140:143]
    ds_read_b128 v[192:195], v245 offset:49152
    v_mfma_f32_16x16x32_bf16 v[144:147], v[208:211], v[196:199], v[144:147]
    ds_read_b64_tr_b16 v[230:231], v243 offset:16896
    v_mfma_f32_16x16x32_bf16 v[148:151], v[212:215], v[196:199], v[148:151]
    ds_read_b64_tr_b16 v[232:233], v242 offset:24576
    v_mfma_f32_16x16x32_bf16 v[152:155], v[216:219], v[196:199], v[152:155]
    ds_read_b64_tr_b16 v[234:235], v242 offset:25088
    v_mfma_f32_16x16x32_bf16 v[156:159], v[220:223], v[196:199], v[156:159]
    s_waitcnt lgkmcnt(7)
    ds_read_b128 v[196:199], v245 offset:51200
    v_mfma_f32_16x16x32_bf16 v[160:163], v[208:211], v[200:203], v[160:163]
    ds_read_b64_tr_b16 v[236:237], v243 offset:24576
    v_mfma_f32_16x16x32_bf16 v[164:167], v[212:215], v[200:203], v[164:167]
    ds_read_b64_tr_b16 v[238:239], v243 offset:25088
    v_mfma_f32_16x16x32_bf16 v[168:171], v[216:219], v[200:203], v[168:171]
    v_mfma_f32_16x16x32_bf16 v[172:175], v[220:223], v[200:203], v[172:175]
    ds_read_b128 v[200:203], v245 offset:53248
    v_mfma_f32_16x16x32_bf16 v[176:179], v[208:211], v[204:207], v[176:179]
    v_mfma_f32_16x16x32_bf16 v[180:183], v[212:215], v[204:207], v[180:183]
    v_mfma_f32_16x16x32_bf16 v[184:187], v[216:219], v[204:207], v[184:187]
    v_mfma_f32_16x16x32_bf16 v[188:191], v[220:223], v[204:207], v[188:191]
    s_waitcnt lgkmcnt(1)
    ds_read_b128 v[204:207], v245 offset:55296
    v_mfma_f32_16x16x32_bf16 v[128:131], v[224:227], v[192:195], v[128:131]
    s_barrier
    ds_read_b64_tr_b16 v[208:209], v240 offset:0
    v_mfma_f32_16x16x32_bf16 v[132:135], v[228:231], v[192:195], v[132:135]
    ds_read_b64_tr_b16 v[210:211], v240 offset:512
    v_mfma_f32_16x16x32_bf16 v[136:139], v[232:235], v[192:195], v[136:139]
    ds_read_b64_tr_b16 v[212:213], v241 offset:0
    v_mfma_f32_16x16x32_bf16 v[140:143], v[236:239], v[192:195], v[140:143]
    ds_read_b128 v[192:195], v244 offset:57344
    v_mfma_f32_16x16x32_bf16 v[144:147], v[224:227], v[196:199], v[144:147]
    ds_read_b64_tr_b16 v[214:215], v241 offset:512
    v_mfma_f32_16x16x32_bf16 v[148:151], v[228:231], v[196:199], v[148:151]
    ds_read_b64_tr_b16 v[216:217], v240 offset:8192
    v_mfma_f32_16x16x32_bf16 v[152:155], v[232:235], v[196:199], v[152:155]
    ds_read_b64_tr_b16 v[218:219], v240 offset:8704
    v_mfma_f32_16x16x32_bf16 v[156:159], v[236:239], v[196:199], v[156:159]
    s_waitcnt lgkmcnt(7)
    ds_read_b128 v[196:199], v244 offset:59392
    v_mfma_f32_16x16x32_bf16 v[160:163], v[224:227], v[200:203], v[160:163]
    ds_read_b64_tr_b16 v[220:221], v241 offset:8192
    v_mfma_f32_16x16x32_bf16 v[164:167], v[228:231], v[200:203], v[164:167]
    ds_read_b64_tr_b16 v[222:223], v241 offset:8704
    v_mfma_f32_16x16x32_bf16 v[168:171], v[232:235], v[200:203], v[168:171]
    v_mfma_f32_16x16x32_bf16 v[172:175], v[236:239], v[200:203], v[172:175]
    ds_read_b128 v[200:203], v244 offset:61440
    v_mfma_f32_16x16x32_bf16 v[176:179], v[224:227], v[204:207], v[176:179]
    v_mfma_f32_16x16x32_bf16 v[180:183], v[228:231], v[204:207], v[180:183]
    v_mfma_f32_16x16x32_bf16 v[184:187], v[232:235], v[204:207], v[184:187]
    v_mfma_f32_16x16x32_bf16 v[188:191], v[236:239], v[204:207], v[188:191]
    s_waitcnt lgkmcnt(1)
    ds_read_b128 v[204:207], v244 offset:63488
    v_mfma_f32_16x16x32_bf16 v[128:131], v[208:211], v[192:195], v[128:131]
    s_barrier
    ds_read_b64_tr_b16 v[224:225], v240 offset:16384
    v_mfma_f32_16x16x32_bf16 v[132:135], v[212:215], v[192:195], v[132:135]
    ds_read_b64_tr_b16 v[226:227], v240 offset:16896
    v_mfma_f32_16x16x32_bf16 v[136:139], v[216:219], v[192:195], v[136:139]
    ds_read_b64_tr_b16 v[228:229], v241 offset:16384
    v_mfma_f32_16x16x32_bf16 v[140:143], v[220:223], v[192:195], v[140:143]
    ds_read_b128 v[192:195], v245 offset:57344
    v_mfma_f32_16x16x32_bf16 v[144:147], v[208:211], v[196:199], v[144:147]
    ds_read_b64_tr_b16 v[230:231], v241 offset:16896
    v_mfma_f32_16x16x32_bf16 v[148:151], v[212:215], v[196:199], v[148:151]
    ds_read_b64_tr_b16 v[232:233], v240 offset:24576
    v_mfma_f32_16x16x32_bf16 v[152:155], v[216:219], v[196:199], v[152:155]
    ds_read_b64_tr_b16 v[234:235], v240 offset:25088
    v_mfma_f32_16x16x32_bf16 v[156:159], v[220:223], v[196:199], v[156:159]
    s_waitcnt lgkmcnt(7)
    ds_read_b128 v[196:199], v245 offset:59392
    v_mfma_f32_16x16x32_bf16 v[160:163], v[208:211], v[200:203], v[160:163]
    ds_read_b64_tr_b16 v[236:237], v241 offset:24576
    v_mfma_f32_16x16x32_bf16 v[164:167], v[212:215], v[200:203], v[164:167]
    ds_read_b64_tr_b16 v[238:239], v241 offset:25088
    v_mfma_f32_16x16x32_bf16 v[168:171], v[216:219], v[200:203], v[168:171]
    v_mfma_f32_16x16x32_bf16 v[172:175], v[220:223], v[200:203], v[172:175]
    ds_read_b128 v[200:203], v245 offset:61440
    v_mfma_f32_16x16x32_bf16 v[176:179], v[208:211], v[204:207], v[176:179]
    v_mfma_f32_16x16x32_bf16 v[180:183], v[212:215], v[204:207], v[180:183]
    v_mfma_f32_16x16x32_bf16 v[184:187], v[216:219], v[204:207], v[184:187]
    v_mfma_f32_16x16x32_bf16 v[188:191], v[220:223], v[204:207], v[188:191]
    s_waitcnt lgkmcnt(1)
    ds_read_b128 v[204:207], v245 offset:63488
    v_mfma_f32_16x16x32_bf16 v[128:131], v[224:227], v[192:195], v[128:131]
    v_mfma_f32_16x16x32_bf16 v[132:135], v[228:231], v[192:195], v[132:135]
    v_mfma_f32_16x16x32_bf16 v[136:139], v[232:235], v[192:195], v[136:139]
    v_mfma_f32_16x16x32_bf16 v[140:143], v[236:239], v[192:195], v[140:143]
    v_mfma_f32_16x16x32_bf16 v[144:147], v[224:227], v[196:199], v[144:147]
    v_mfma_f32_16x16x32_bf16 v[148:151], v[228:231], v[196:199], v[148:151]
    v_mfma_f32_16x16x32_bf16 v[152:155], v[232:235], v[196:199], v[152:155]
    v_mfma_f32_16x16x32_bf16 v[156:159], v[236:239], v[196:199], v[156:159]
    s_waitcnt lgkmcnt(0)
    s_barrier
    v_mfma_f32_16x16x32_bf16 v[160:163], v[224:227], v[200:203], v[160:163]
    v_mfma_f32_16x16x32_bf16 v[164:167], v[228:231], v[200:203], v[164:167]
    v_mfma_f32_16x16x32_bf16 v[168:171], v[232:235], v[200:203], v[168:171]
    v_mfma_f32_16x16x32_bf16 v[172:175], v[236:239], v[200:203], v[172:175]
    v_mfma_f32_16x16x32_bf16 v[176:179], v[224:227], v[204:207], v[176:179]
    v_mfma_f32_16x16x32_bf16 v[180:183], v[228:231], v[204:207], v[180:183]
    v_mfma_f32_16x16x32_bf16 v[184:187], v[232:235], v[204:207], v[184:187]
    v_mfma_f32_16x16x32_bf16 v[188:191], v[236:239], v[204:207], v[188:191]
    s_branch L_p1e
L_nspin_1:
    s_mov_b32 s62, 131072
L_nloop_3:
    buffer_load_dword v9, v7, s[8:11], 0 offen sc1
    s_waitcnt vmcnt(0)
    v_readfirstlane_b32 s4, v9
    s_sub_u32 s62, s62, 1
    s_nop 3
    s_cmp_lg_u32 s4, 0
    s_cbranch_scc1 L_ngot_2
    s_sleep 2
    s_cmp_lg_u32 s62, 0
    s_cbranch_scc1 L_nloop_3
    s_branch L_ngot_2
L_nspin_10:
    s_mov_b32 s62, 131072
L_nloop_12:
    buffer_load_dword v15, v13, s[8:11], 0 offen sc1
    s_waitcnt vmcnt(0)
    v_readfirstlane_b32 s4, v15
    s_sub_u32 s62, s62, 1
    s_nop 3
    s_cmp_lg_u32 s4, 0
    s_cbranch_scc1 L_ngot_11
    s_sleep 2
    s_cmp_lg_u32 s62, 0
    s_cbranch_scc1 L_nloop_12
    s_branch L_ngot_11
L_pad_rare:
    s_cbranch_execz L_ret_rare
L_obad0:
    buffer_load_dwordx4 v[240:243], v6, s[40:43], s58 offen offset:0 sc1
    buffer_load_dwordx4 v[244:247], v6, s[40:43], s58 offen offset:256 sc1
    buffer_load_dwordx4 v[248:251], v6, s[40:43], s58 offen offset:2048 sc1
    buffer_load_dwordx4 v[252:255], v6, s[40:43], s58 offen offset:2304 sc1
    buffer_load_dwordx4 v[64:67], v6, s[40:43], s59 offen offset:0 sc1
    buffer_load_dwordx4 v[68:71], v6, s[40:43], s59 offen offset:256 sc1
    buffer_load_dwordx4 v[72:75], v6, s[40:43], s59 offen offset:2048 sc1
    buffer_load_dwordx4 v[76:79], v6, s[40:43], s59 offen offset:2304 sc1
    v_mov_b64 v[32:33], 0
    v_mov_b64 v[34:35], 0
    v_mov_b64 v[36:37], 0
    v_mov_b64 v[38:39], 0
    v_mov_b64 v[40:41], 0
    v_mov_b64 v[42:43], 0
    v_mov_b64 v[44:45], 0
    v_mov_b64 v[46:47], 0
    v_mov_b64 v[48:49], 0
    v_mov_b64 v[50:51], 0
    v_mov_b64 v[52:53], 0
    v_mov_b64 v[54:55], 0
    v_mov_b64 v[56:57], 0
    v_mov_b64 v[58:59], 0
    v_mov_b64 v[60:61], 0
    v_mov_b64 v[62:63], 0
    s_mov_b32 s61, 15
    s_mov_b32 s67, 1
    s_branch L_ogen
L_obad1:
    v_lshlrev_b32 v96, 16, v8
    v_and_b32 v97, s64, v8
    v_lshlrev_b32 v98, 16, v9
    v_and_b32 v99, s64, v9
    v_lshlrev_b32 v100, 16, v10
    v_and_b32 v101, s64, v10
    v_lshlrev_b32 v102, 16, v11
    v_and_b32 v103, s64, v11
    v_lshlrev_b32 v104, 16, v12
    v_and_b32 v105, s64, v12
    v_lshlrev_b32 v106, 16, v13
    v_and_b32 v107, s64, v13
    v_lshlrev_b32 v108, 16, v14
    v_and_b32 v109, s64, v14
    v_lshlrev_b32 v110, 16, v15
    v_and_b32 v111, s64, v15
    v_and_b32 v88, 15, v0
    v_lshrrev_b32 v89, 4, v0
    v_mul_u32_u24 v88, 80, v88
    v_lshl_add_u32 v88, v89, 3, v88
    v_lshrrev_b32 v89, 2, v0
    v_and_b32 v90, 3, v0
    v_add_u32 v88, s65, v88
    v_lshlrev_b32 v90, 4, v90
    v_lshl_add_u32 v91, v89, 10, v90
    v_mul_u32_u24 v89, 80, v89
    v_add3_u32 v89, v89, v90, s65
    s_mov_b32 s61, 14
    s_mov_b32 s67, 0
    s_branch L_ogen
L_obad2:
    s_mov_b32 s61, 12
    s_mov_b32 s67, 0
    s_branch L_ogen
L_obad3:
    s_mov_b32 s61, 8
    s_mov_b32 s67, 0
    s_branch L_ogen
L_ogen:
L_pad_ogen:
    s_cbranch_execz L_ret_ogen
    s_mov_b32 s62, 131072
L_oloop:
    s_bitcmp1_b32 s61, 0
    s_cbranch_scc0 L_onext_7001
    s_bcnt1_i32_b32 s63, s61
    s_cmp_eq_u32 s63, 4
    s_waitcnt vmcnt(12)
    s_cbranch_scc1 L_owaited_7003
    s_cmp_eq_u32 s63, 3
    s_waitcnt vmcnt(8)
    s_cbranch_scc1 L_owaited_7003
    s_cmp_eq_u32 s63, 2
    s_waitcnt vmcnt(4)
    s_cbranch_scc1 L_owaited_7003
    s_waitcnt vmcnt(0)
L_owaited_7003:
    v_max3_u32 v5, v208, v212, v216
    v_max_u32 v5, v5, v220
    v_cmp_eq_u32 vcc, -1, v5
    s_sub_u32 s62, s62, 1
    s_cmp_le_i32 s62, 0
    s_nop 2
    s_cbranch_vccz L_ogo_7002
    s_cbranch_scc1 L_ogo_7002
    buffer_load_dwordx4 v[208:211], v6, s[40:43], s56 offen offset:0 sc1
    buffer_load_dwordx4 v[212:215], v6, s[40:43], s56 offen offset:256 sc1
    buffer_load_dwordx4 v[216:219], v6, s[40:43], s56 offen offset:2048 sc1
    buffer_load_dwordx4 v[220:223], v6, s[40:43], s56 offen offset:2304 sc1
    s_branch L_onext_7001
L_ogo_7002:
    s_bitset0_b32 s61, 0
    v_mfma_f32_16x16x32_bf16 v[48:51], v[88:91], v[208:211], v[48:51]
    v_mfma_f32_16x16x32_bf16 v[52:55], v[92:95], v[208:211], v[52:55]
    v_mfma_f32_16x16x32_bf16 v[32:35], v[80:83], v[208:211], v[32:35]
    v_mfma_f32_16x16x32_bf16 v[36:39], v[84:87], v[208:211], v[36:39]
    v_mfma_f32_16x16x32_bf16 v[56:59], v[88:91], v[212:215], v[56:59]
    v_mfma_f32_16x16x32_bf16 v[60:63], v[92:95], v[212:215], v[60:63]
    v_mfma_f32_16x16x32_bf16 v[40:43], v[80:83], v[212:215], v[40:43]
    v_mfma_f32_16x16x32_bf16 v[44:47], v[84:87], v[212:215], v[44:47]
    v_mfma_f32_16x16x32_bf16 v[48:51], v[104:107], v[216:219], v[48:51]
    v_mfma_f32_16x16x32_bf16 v[52:55], v[108:111], v[216:219], v[52:55]
    v_mfma_f32_16x16x32_bf16 v[32:35], v[96:99], v[216:219], v[32:35]
    v_mfma_f32_16x16x32_bf16 v[36:39], v[100:103], v[216:219], v[36:39]
    v_mfma_f32_16x16x32_bf16 v[56:59], v[104:107], v[220:223], v[56:59]
    v_mfma_f32_16x16x32_bf16 v[60:63], v[108:111], v[220:223], v[60:63]
    v_mfma_f32_16x16x32_bf16 v[40:43], v[96:99], v[220:223], v[40:43]
    v_mfma_f32_16x16x32_bf16 v[44:47], v[100:103], v[220:223], v[44:47]
    s_cmp_eq_u32 s61, 0
    s_cbranch_scc1 L_odone
L_onext_7001:
    s_bitcmp1_b32 s61, 1
    s_cbranch_scc0 L_onext_7004
    s_bcnt1_i32_b32 s63, s61
    s_cmp_eq_u32 s63, 4
    s_waitcnt vmcnt(12)
    s_cbranch_scc1 L_owaited_7006
    s_cmp_eq_u32 s63, 3
    s_waitcnt vmcnt(8)
    s_cbranch_scc1 L_owaited_7006
    s_cmp_eq_u32 s63, 2
    s_waitcnt vmcnt(4)
    s_cbranch_scc1 L_owaited_7006
    s_waitcnt vmcnt(0)
L_owaited_7006:
    v_max3_u32 v5, v224, v228, v232
    v_max_u32 v5, v5, v236
    v_cmp_eq_u32 vcc, -1, v5
    s_sub_u32 s62, s62, 1
    s_cmp_le_i32 s62, 0
    s_nop 2
    s_cbranch_vccz L_ogo_7005
    s_cbranch_scc1 L_ogo_7005
    buffer_load_dwordx4 v[224:227], v6, s[40:43], s57 offen offset:0 sc1
    buffer_load_dwordx4 v[228:231], v6, s[40:43], s57 offen offset:256 sc1
    buffer_load_dwordx4 v[232:235], v6, s[40:43], s57 offen offset:2048 sc1
    buffer_load_dwordx4 v[236:239], v6, s[40:43], s57 offen offset:2304 sc1
    s_branch L_onext_7004
L_ogo_7005:
    s_bitset0_b32 s61, 1
    v_mfma_f32_16x16x32_bf16 v[48:51], v[120:123], v[224:227], v[48:51]
    v_mfma_f32_16x16x32_bf16 v[52:55], v[124:127], v[224:227], v[52:55]
    v_mfma_f32_16x16x32_bf16 v[32:35], v[112:115], v[224:227], v[32:35]
    v_mfma_f32_16x16x32_bf16 v[36:39], v[116:119], v[224:227], v[36:39]
    v_mfma_f32_16x16x32_bf16 v[56:59], v[120:123], v[228:231], v[56:59]
    v_mfma_f32_16x16x32_bf16 v[60:63], v[124:127], v[228:231], v[60:63]
    v_mfma_f32_16x16x32_bf16 v[40:43], v[112:115], v[228:231], v[40:43]
    v_mfma_f32_16x16x32_bf16 v[44:47], v[116:119], v[228:231], v[44:47]
    v_mfma_f32_16x16x32_bf16 v[48:51], v[136:139], v[232:235], v[48:51]
    v_mfma_f32_16x16x32_bf16 v[52:55], v[140:143], v[232:235], v[52:55]
    v_mfma_f32_16x16x32_bf16 v[32:35], v[128:131], v[232:235], v[32:35]
    v_mfma_f32_16x16x32_bf16 v[36:39], v[132:135], v[232:235], v[36:39]
    v_mfma_f32_16x16x32_bf16 v[56:59], v[136:139], v[236:239], v[56:59]
    v_mfma_f32_16x16x32_bf16 v[60:63], v[140:143], v[236:239], v[60:63]
    v_mfma_f32_16x16x32_bf16 v[40:43], v[128:131], v[236:239], v[40:43]
    v_mfma_f32_16x16x32_bf16 v[44:47], v[132:135], v[236:239], v[44:47]
    s_cmp_eq_u32 s61, 0
    s_cbranch_scc1 L_odone
L_onext_7004:
    s_bitcmp1_b32 s61, 2
    s_cbranch_scc0 L_onext_7007
    s_bcnt1_i32_b32 s63, s61
    s_cmp_eq_u32 s63, 4
    s_waitcnt vmcnt(12)
    s_cbranch_scc1 L_owaited_7009
    s_cmp_eq_u32 s63, 3
    s_waitcnt vmcnt(8)
    s_cbranch_scc1 L_owaited_7009
    s_cmp_eq_u32 s63, 2
    s_waitcnt vmcnt(4)
    s_cbranch_scc1 L_owaited_7009
    s_waitcnt vmcnt(0)
L_owaited_7009:
    v_max3_u32 v5, v240, v244, v248
    v_max_u32 v5, v5, v252
    v_cmp_eq_u32 vcc, -1, v5
    s_sub_u32 s62, s62, 1
    s_cmp_le_i32 s62, 0
    s_nop 2
    s_cbranch_vccz L_ogo_7008
    s_cbranch_scc1 L_ogo_7008
    buffer_load_dwordx4 v[240:243], v6, s[40:43], s58 offen offset:0 sc1
    buffer_load_dwordx4 v[244:247], v6, s[40:43], s58 offen offset:256 sc1
    buffer_load_dwordx4 v[248:251], v6, s[40:43], s58 offen offset:2048 sc1
    buffer_load_dwordx4 v[252:255], v6, s[40:43], s58 offen offset:2304 sc1
    s_branch L_onext_7007
L_ogo_7008:
    s_bitset0_b32 s61, 2
    v_mfma_f32_16x16x32_bf16 v[48:51], v[152:155], v[240:243], v[48:51]
    v_mfma_f32_16x16x32_bf16 v[52:55], v[156:159], v[240:243], v[52:55]
    v_mfma_f32_16x16x32_bf16 v[32:35], v[144:147], v[240:243], v[32:35]
    v_mfma_f32_16x16x32_bf16 v[36:39], v[148:151], v[240:243], v[36:39]
    v_mfma_f32_16x16x32_bf16 v[56:59], v[152:155], v[244:247], v[56:59]
    v_mfma_f32_16x16x32_bf16 v[60:63], v[156:159], v[244:247], v[60:63]
    v_mfma_f32_16x16x32_bf16 v[40:43], v[144:147], v[244:247], v[40:43]
    v_mfma_f32_16x16x32_bf16 v[44:47], v[148:151], v[244:247], v[44:47]
    v_mfma_f32_16x16x32_bf16 v[48:51], v[168:171], v[248:251], v[48:51]
    v_mfma_f32_16x16x32_bf16 v[52:55], v[172:175], v[248:251], v[52:55]
    v_mfma_f32_16x16x32_bf16 v[32:35], v[160:163], v[248:251], v[32:35]
    v_mfma_f32_16x16x32_bf16 v[36:39], v[164:167], v[248:251], v[36:39]
    v_mfma_f32_16x16x32_bf16 v[56:59], v[168:171], v[252:255], v[56:59]
    v_mfma_f32_16x16x32_bf16 v[60:63], v[172:175], v[252:255], v[60:63]
    v_mfma_f32_16x16x32_bf16 v[40:43], v[160:163], v[252:255], v[40:43]
    v_mfma_f32_16x16x32_bf16 v[44:47], v[164:167], v[252:255], v[44:47]
    s_cmp_eq_u32 s61, 0
    s_cbranch_scc1 L_odone
L_onext_7007:
    s_bitcmp1_b32 s61, 3
    s_cbranch_scc0 L_onext_7010
    s_bcnt1_i32_b32 s63, s61
    s_cmp_eq_u32 s63, 4
    s_waitcnt vmcnt(12)
    s_cbranch_scc1 L_owaited_7012
    s_cmp_eq_u32 s63, 3
    s_waitcnt vmcnt(8)
    s_cbranch_scc1 L_owaited_7012
    s_cmp_eq_u32 s63, 2
    s_waitcnt vmcnt(4)
    s_cbranch_scc1 L_owaited_7012
    s_waitcnt vmcnt(0)
L_owaited_7012:
    v_max3_u32 v5, v64, v68, v72
    v_max_u32 v5, v5, v76
    v_cmp_eq_u32 vcc, -1, v5
    s_sub_u32 s62, s62, 1
    s_cmp_le_i32 s62, 0
    s_nop 2
    s_cbranch_vccz L_ogo_7011
    s_cbranch_scc1 L_ogo_7011
    buffer_load_dwordx4 v[64:67], v6, s[40:43], s59 offen offset:0 sc1
    buffer_load_dwordx4 v[68:71], v6, s[40:43], s59 offen offset:256 sc1
    buffer_load_dwordx4 v[72:75], v6, s[40:43], s59 offen offset:2048 sc1
    buffer_load_dwordx4 v[76:79], v6, s[40:43], s59 offen offset:2304 sc1
    s_branch L_onext_7010
L_ogo_7011:
    s_bitset0_b32 s61, 3
    v_mfma_f32_16x16x32_bf16 v[48:51], v[184:187], v[64:67], v[48:51]
    v_mfma_f32_16x16x32_bf16 v[52:55], v[188:191], v[64:67], v[52:55]
    v_mfma_f32_16x16x32_bf16 v[32:35], v[176:179], v[64:67], v[32:35]
    v_mfma_f32_16x16x32_bf16 v[36:39], v[180:183], v[64:67], v[36:39]
    v_mfma_f32_16x16x32_bf16 v[56:59], v[184:187], v[68:71], v[56:59]
    v_mfma_f32_16x16x32_bf16 v[60:63], v[188:191], v[68:71], v[60:63]
    v_mfma_f32_16x16x32_bf16 v[40:43], v[176:179], v[68:71], v[40:43]
    v_mfma_f32_16x16x32_bf16 v[44:47], v[180:183], v[68:71], v[44:47]
    v_mfma_f32_16x16x32_bf16 v[48:51], v[200:203], v[72:75], v[48:51]
    v_mfma_f32_16x16x32_bf16 v[52:55], v[204:207], v[72:75], v[52:55]
    v_mfma_f32_16x16x32_bf16 v[32:35], v[192:195], v[72:75], v[32:35]
    v_mfma_f32_16x16x32_bf16 v[36:39], v[196:199], v[72:75], v[36:39]
    v_mfma_f32_16x16x32_bf16 v[56:59], v[200:203], v[76:79], v[56:59]
    v_mfma_f32_16x16x32_bf16 v[60:63], v[204:207], v[76:79], v[60:63]
    v_mfma_f32_16x16x32_bf16 v[40:43], v[192:195], v[76:79], v[40:43]
    v_mfma_f32_16x16x32_bf16 v[44:47], v[196:199], v[76:79], v[44:47]
L_onext_7010:
    s_cmp_lg_u32 s61, 0
    s_cbranch_scc1 L_oloop
L_odone:
    s_cmp_eq_u32 s67, 0
    s_cbranch_scc1 L_od2
    v_lshlrev_b32 v96, 16, v8
    v_and_b32 v97, s64, v8
    v_lshlrev_b32 v98, 16, v9
    v_and_b32 v99, s64, v9
    v_lshlrev_b32 v100, 16, v10
    v_and_b32 v101, s64, v10
    v_lshlrev_b32 v102, 16, v11
    v_and_b32 v103, s64, v11
    v_lshlrev_b32 v104, 16, v12
    v_and_b32 v105, s64, v12
    v_lshlrev_b32 v106, 16, v13
    v_and_b32 v107, s64, v13
    v_lshlrev_b32 v108, 16, v14
    v_and_b32 v109, s64, v14
    v_lshlrev_b32 v110, 16, v15
    v_and_b32 v111, s64, v15
    v_and_b32 v88, 15, v0
    v_lshrrev_b32 v89, 4, v0
    v_mul_u32_u24 v88, 80, v88
    v_lshl_add_u32 v88, v89, 3, v88
    v_lshrrev_b32 v89, 2, v0
    v_and_b32 v90, 3, v0
    v_add_u32 v88, s65, v88
    v_lshlrev_b32 v90, 4, v90
    v_lshl_add_u32 v91, v89, 10, v90
    v_mul_u32_u24 v89, 80, v89
    v_add3_u32 v89, v89, v90, s65
L_od2:
    s_nop 7
    ds_write_b128 v3, v[48:51] offset:0
    ds_write_b128 v3, v[52:55] offset:1024
    ds_write_b128 v3, v[56:59] offset:2048
    ds_write_b128 v3, v[60:63] offset:3072
    s_branch L_ofin
L_nspin_33:
    s_mov_b32 s62, 131072
L_nloop_35:
    buffer_load_dword v15, v13, s[8:11], 0 offen sc1
    s_waitcnt vmcnt(0)
    v_readfirstlane_b32 s4, v15
    s_sub_u32 s62, s62, 1
    s_nop 3
    s_cmp_lg_u32 s4, 0
    s_cbranch_scc1 L_ngot_34
    s_sleep 2
    s_cmp_lg_u32 s62, 0
    s_cbranch_scc1 L_nloop_35
    s_branch L_ngot_34
L_nspin_36:
    s_mov_b32 s62, 131072
L_nloop_38:
    buffer_load_dword v15, v13, s[8:11], 0 offen sc1
    s_waitcnt vmcnt(0)
    v_readfirstlane_b32 s4, v15
    s_sub_u32 s62, s62, 1
    s_nop 3
    s_cmp_lg_u32 s4, 0
    s_cbranch_scc1 L_ngot_37
    s_sleep 2
    s_cmp_lg_u32 s62, 0
    s_cbranch_scc1 L_nloop_38
    s_branch L_ngot_37
    s_endpgm
.section .rodata,"a"
.p2align 6
.amdhsa_kernel recurrent_scan__grouped_kv_mqa__glu_gated_geglu__prompt_kernel
  .amdhsa_next_free_vgpr 256
  .amdhsa_next_free_sgpr 102
  .amdhsa_accum_offset 256
  .amdhsa_group_segment_fixed_size 0
  .amdhsa_kernarg_size 96
  .amdhsa_user_sgpr_count 2
  .amdhsa_user_sgpr_kernarg_segment_ptr 1
  .amdhsa_system_sgpr_workgroup_id_x 1
.end_amdhsa_kernel
```
